```python
import torch

def _softmax(x, axis=-1):
    return torch.softmax(x, dim=axis)
def _gelu(x):
    return torch.nn.functional.gelu(x, approximate="tanh")
def _silu(x):
    return torch.nn.functional.silu(x)
def _sigmoid(x):
    return torch.sigmoid(x)
def _layernorm(x, axis=-1, eps=1e-5):
    m = x.mean(dim=axis, keepdim=True)
    v = x.var(dim=axis, keepdim=True, unbiased=False)
    return (x - m) / torch.sqrt(v + eps)
def _scatter_add(tgt, idx, src, axis=0):
    return tgt.clone().index_add_(axis, idx, src)
def _segment_sum(src, seg, n):
    out = torch.zeros((n,) + src.shape[1:], dtype=src.dtype)
    return out.index_add_(0, seg, src)
def _pad(x, pw):
    flat = tuple(v for pair in reversed(pw) for v in pair)
    return torch.nn.functional.pad(x, flat)

kernel_name = 'concat_heads__linear_kernel_hedgehog__sliding_local_dilated__prompt'

def setup_inputs():

    _w = (lambda a: (lambda t: t.to(torch.bfloat16) if t.is_floating_point() else t)(torch.as_tensor(a)))
    def _A_setup():
        B, S, D, H = 1, 2048, 576, 32
        Dh = D // H
        return {
            "x": _w((lambda *s: torch.randn(*s, dtype=torch.bfloat16) * 0.2)(B, S, D)),
            "wqkv": _w((lambda *s: torch.randn(*s, dtype=torch.bfloat16) * 0.8)(D, 3 * D)),
            "w_phi": _w((lambda *s: torch.randn(*s, dtype=torch.bfloat16) * 0.8)(H, Dh, Dh) * (Dh ** -0.5)),
            "wo": _w((lambda *s: torch.randn(*s, dtype=torch.bfloat16) * 0.2)(D, D)),
        }
    _A_in = _A_setup()

    def _B_setup():
        B, S, D = 1, 2048, 576
        return {
            "x": _w((lambda *s: torch.randn(*s, dtype=torch.bfloat16) * 0.2)(B, S, D)),
            "wqkv": _w((lambda *s: torch.randn(*s, dtype=torch.bfloat16) * 0.2)(D, 3 * D)),
            "wo": _w((lambda *s: torch.randn(*s, dtype=torch.bfloat16) * 0.05)(D, D)),
        }
    _B_in = _B_setup()

    return {
        "A_x": _A_in["x"],
        "A_wqkv": _A_in["wqkv"],
        "A_w_phi": _A_in["w_phi"],
        "A_wo": _A_in["wo"],
        "B_x": _B_in["x"],
        "B_wqkv": _B_in["wqkv"],
        "B_wo": _B_in["wo"],
    }

def reference(A_x, A_wqkv, A_w_phi, A_wo, B_x, B_wqkv, B_wo):
    def _A_ref(x, wqkv, w_phi, wo):
        B, S, D = x.shape
        H = 32; Dh = D // H
        qkv = (lambda x, *d: x.permute(*d))((x @ wqkv).reshape(B, S, 3, H, Dh), 2, 0, 3, 1, 4)
        q, k, v = qkv[0], qkv[1], qkv[2]
        pq = torch.einsum("bhsd,hdf->bhsf", q, w_phi)
        pk = torch.einsum("bhsd,hdf->bhsf", k, w_phi)
        phi_q = torch.concatenate([_softmax(pq, axis=-1), _softmax(-pq, axis=-1)], axis=-1)
        phi_k = torch.concatenate([_softmax(pk, axis=-1), _softmax(-pk, axis=-1)], axis=-1)
        kv = torch.einsum("bhsf,bhsd->bhfd", phi_k, v)
        z  = torch.einsum("bhsf->bhf", phi_k)
        num = torch.einsum("bhqf,bhfd->bhqd", phi_q, kv)
        den = torch.einsum("bhqf,bhf->bhq", phi_q, z)[..., None] + 1e-6
        o = num / den
        return (lambda x, *d: x.permute(*d))(o, 0, 2, 1, 3).reshape(B, S, D) @ wo

    def _B_ref(x, wqkv, wo):
        B, S, D = x.shape
        H = 32; Dh = D // H
        W, dil = 8, 2
        qkv = (lambda x, *d: x.permute(*d))((x @ wqkv).reshape(B, S, 3, H, Dh), 2, 0, 3, 1, 4)
        q, k, v = qkv[0], qkv[1], qkv[2]
        scale = Dh ** -0.5
        pos = torch.arange(S)
        off = torch.arange(W) * dil
        idx = pos[:, None] - off[None, :]
        mask = idx >= 0
        idx_c = torch.where(mask, idx, 0).reshape(-1)
        kg = k[:, :, idx_c, :].reshape(B, H, S, W, Dh)
        vg = v[:, :, idx_c, :].reshape(B, H, S, W, Dh)
        logits = torch.einsum("bhsd,bhswd->bhsw", q, kg) * scale
        logits = torch.where(mask[None, None, :, :], logits, -1e9)
        attn = _softmax(logits, axis=-1)
        o = torch.einsum("bhsw,bhswd->bhsd", attn, vg)
        return (lambda x, *d: x.permute(*d))(o, 0, 2, 1, 3).reshape(B, S, D) @ wo

    a = _A_ref(A_x, A_wqkv, A_w_phi, A_wo)
    b = _B_ref(B_x, B_wqkv, B_wo)
    return torch.concatenate([a, b], axis=-1)
```

```asm
; @launch kernel=k1_kernel grid=(256,1,1) block=(512,1,1) lds=137504
; @launch kernel=k2_kernel grid=(256,1,1) block=(512,1,1) lds=163840
.amdgcn_target "amdgcn-amd-amdhsa--gfx950"
.text
.globl k1_kernel
.p2align 8
.type k1_kernel,@function
k1_kernel:
  s_cmp_ge_u32 s2, 256
  s_cbranch_scc1 k1_end
  s_load_dwordx4 s[4:7], s[0:1], 0
  s_load_dwordx4 s[8:11], s[0:1], 32
  s_load_dwordx4 s[12:15], s[0:1], 16
  s_load_dwordx2 s[16:17], s[0:1], 72
  s_load_dwordx2 s[18:19], s[0:1], 48
  s_and_b32 s20, s2, 7
  s_lshr_b32 s21, s2, 3
  s_lshr_b32 s22, s20, 2
  s_lshr_b32 s28, s20, 1
  s_and_b32 s28, s28, 1
  s_lshl_b32 s28, s28, 3
  s_lshr_b32 s23, s21, 2
  s_add_u32 s23, s23, s28
  s_and_b32 s28, s20, 1
  s_lshl_b32 s28, s28, 2
  s_and_b32 s24, s21, 3
  s_add_u32 s24, s24, s28
  v_lshrrev_b32 v6, 6, v0
  v_and_b32 v1, 63, v0
  v_readfirstlane_b32 s25, v6
  v_and_b32 v2, 15, v0
  v_lshrrev_b32 v3, 4, v1
  v_bfe_u32 v4, v0, 2, 2
  v_and_b32 v5, 3, v0
  s_and_b32 s26, s25, 1
  s_bfe_u32 s27, s25, 0x10001
  s_lshl_b32 s48, s23, 7
  s_cmp_lt_u32 s25, 4
  s_cbranch_scc1 k1_comp
  s_sub_u32 s26, s25, 4
  v_and_b32 v6, 7, v1
  v_xor_b32 v6, v6, v3
  v_lshrrev_b32 v7, 3, v1
  v_mul_u32_u24 v7, 1152, v7
  v_lshl_add_u32 v16, v6, 4, v7
  v_xor_b32 v17, 64, v16
  s_and_b32 s28, s26, 1
  s_lshl_b32 s28, s28, 3
  s_mul_i32 s29, s24, 144
  s_sub_u32 s30, 0, s28
  v_add_u32 v6, s30, v1
  v_and_b32 v10, 0xff, v6
  v_mul_u32_u24 v7, 2185, v10
  v_lshrrev_b32 v7, 16, v7
  v_mul_u32_u24 v8, 30, v7
  v_sub_u32 v8, v10, v8
  v_mul_u32_u24 v9, 57, v8
  v_lshrrev_b32 v9, 9, v9
  v_mul_u32_u24 v10, 9, v9
  v_sub_u32 v10, v8, v10
  v_mul_u32_u24 v7, 3456, v7
  v_mul_u32_u24 v9, 1152, v9
  v_add3_u32 v7, v7, v9, s29
  v_lshl_add_u32 v7, v10, 4, v7
  v_cmp_gt_u32 vcc, 120, v6
  v_cmp_gt_u32 s[30:31], 27, v8
  v_mov_b32 v11, 0x80000000
  s_and_b64 vcc, vcc, s[30:31]
  s_nop 1
  v_cndmask_b32 v14, v11, v7, vcc
  s_sub_u32 s30, 64, s28
  v_add_u32 v6, s30, v1
  v_and_b32 v10, 0xff, v6
  v_mul_u32_u24 v7, 2185, v10
  v_lshrrev_b32 v7, 16, v7
  v_mul_u32_u24 v8, 30, v7
  v_sub_u32 v8, v10, v8
  v_mul_u32_u24 v9, 57, v8
  v_lshrrev_b32 v9, 9, v9
  v_mul_u32_u24 v10, 9, v9
  v_sub_u32 v10, v8, v10
  v_mul_u32_u24 v7, 3456, v7
  v_mul_u32_u24 v9, 1152, v9
  v_add3_u32 v7, v7, v9, s29
  v_lshl_add_u32 v7, v10, 4, v7
  v_cmp_gt_u32 vcc, 120, v6
  v_cmp_gt_u32 s[30:31], 27, v8
  v_mov_b32 v11, 0x80000000
  s_and_b64 vcc, vcc, s[30:31]
  s_nop 1
  v_cndmask_b32 v15, v11, v7, vcc
  s_lshr_b32 s28, s21, 2
  s_and_b32 s29, s21, 3
  s_lshl_b32 s29, s29, 1
  s_add_u32 s30, s28, s29
  s_sub_u32 s28, s30, 9
  s_cmp_ge_u32 s30, 9
  s_cselect_b32 s30, s28, s30
  s_mul_i32 s27, s30, 221184
  s_mul_i32 s28, s26, 27648
  s_add_u32 s27, s27, s28
  s_add_u32 s55, s28, 1990656
  s_lshl_b32 s54, s26, 12
  s_lshl_b32 s28, s26, 4
  s_add_u32 s28, s28, s48
  s_mul_i32 s53, s28, 1152
  s_sub_u32 s28, s48, 16
  s_max_i32 s28, s28, 0
  s_mul_i32 s56, s28, 1152
  s_lshl_b32 s57, s26, 11
  s_add_u32 s57, s57, 2048
  s_mov_b32 s31, 65536
  s_mov_b32 s52, 0
  s_cmp_eq_u32 s26, 0
  s_cselect_b32 s58, s22, 0
  s_waitcnt lgkmcnt(0)
  s_cmp_eq_u32 s22, 0
  s_cselect_b32 s4, s4, s8
  s_cselect_b32 s5, s5, s9
  s_cselect_b32 s6, s6, s10
  s_cselect_b32 s7, s7, s11
  s_mov_b32 s32, s4
  s_and_b32 s33, s5, 0xffff
  s_mov_b32 s34, 2359296
  s_mov_b32 s35, 0x00020000
  s_mov_b32 s36, s6
  s_and_b32 s37, s7, 0xffff
  s_mov_b32 s38, 1990656
  s_mov_b32 s39, 0x00020000
  s_mov_b32 s40, s16
  s_and_b32 s41, s17, 0xffff
  s_mov_b32 s42, 8388608
  s_mov_b32 s43, 0x00020000
  s_mov_b32 s44, s12
  s_and_b32 s45, s13, 0xffff
  s_mov_b32 s46, 20736
  s_mov_b32 s47, 0x00020000
  s_branch k1_l_i0
k1_l_loop:
  s_cmp_eq_u32 s52, 2
  s_cbranch_scc1 k1_l_first
  s_waitcnt vmcnt(8)
  s_barrier
k1_l_i0:
  s_cmp_lt_u32 s52, 18
  s_cselect_b32 s51, s27, 0x80000000
  s_add_u32 m0, s54, 0
  s_add_u32 s50, s51, 0
  buffer_load_dwordx4 v14, s[36:39], s50 offen lds
  s_add_u32 m0, s54, 1024
  s_add_u32 s50, s51, 0
  buffer_load_dwordx4 v15, s[36:39], s50 offen lds
  s_add_u32 m0, s54, 2048
  s_add_u32 s50, s51, 13824
  buffer_load_dwordx4 v14, s[36:39], s50 offen lds
  s_add_u32 m0, s54, 3072
  s_add_u32 s50, s51, 13824
  buffer_load_dwordx4 v15, s[36:39], s50 offen lds
  s_add_u32 s27, s27, 110592
  s_sub_u32 s50, s27, 1990656
  s_cmp_ge_u32 s27, s55
  s_cselect_b32 s27, s50, s27
  s_add_u32 s54, s54, 16384
  s_and_b32 s54, s54, 0xffff
  s_add_u32 s52, s52, 1
  s_cmp_lt_u32 s52, 4
  s_cbranch_scc1 k1_l_i1
  s_waitcnt vmcnt(8)
  s_barrier
k1_l_i1:
  s_cmp_lt_u32 s52, 18
  s_cselect_b32 s51, s27, 0x80000000
  s_add_u32 m0, s54, 0
  s_add_u32 s50, s51, 0
  buffer_load_dwordx4 v14, s[36:39], s50 offen lds
  s_add_u32 m0, s54, 1024
  s_add_u32 s50, s51, 0
  buffer_load_dwordx4 v15, s[36:39], s50 offen lds
  s_add_u32 m0, s54, 2048
  s_add_u32 s50, s51, 13824
  buffer_load_dwordx4 v14, s[36:39], s50 offen lds
  s_add_u32 m0, s54, 3072
  s_add_u32 s50, s51, 13824
  buffer_load_dwordx4 v15, s[36:39], s50 offen lds
  s_add_u32 s27, s27, 110592
  s_sub_u32 s50, s27, 1990656
  s_cmp_ge_u32 s27, s55
  s_cselect_b32 s27, s50, s27
  s_add_u32 s54, s54, 16384
  s_and_b32 s54, s54, 0xffff
  s_add_u32 s52, s52, 1
  s_cmp_eq_u32 s52, 4
  s_cbranch_scc1 k1_l_scat
k1_l_cont:
  s_cmp_lt_u32 s52, 22
  s_cbranch_scc1 k1_l_loop
  s_waitcnt vmcnt(0) lgkmcnt(0)
  s_barrier
  s_cmp_eq_u32 s22, 0
  s_cbranch_scc1 k1_A_epi
  s_branch k1_B_epi
k1_l_first:
  s_cmp_lg_u32 s22, 0
  s_cbranch_scc1 k1_l_first2
  v_subrev_u32 v38, 256, v0
  s_mul_i32 s28, s24, 2592
  v_add_u32 v18, 0, v38
  v_lshlrev_b32 v6, 1, v18
  buffer_load_ushort v24, v6, s[44:47], s28 offen
  v_add_u32 v19, 256, v38
  v_lshlrev_b32 v6, 1, v19
  buffer_load_ushort v25, v6, s[44:47], s28 offen
  v_add_u32 v20, 512, v38
  v_lshlrev_b32 v6, 1, v20
  buffer_load_ushort v26, v6, s[44:47], s28 offen
  v_add_u32 v21, 768, v38
  v_lshlrev_b32 v6, 1, v21
  buffer_load_ushort v27, v6, s[44:47], s28 offen
  v_add_u32 v22, 1024, v38
  v_lshlrev_b32 v6, 1, v22
  buffer_load_ushort v28, v6, s[44:47], s28 offen
  v_add_u32 v23, 1280, v38
  v_lshlrev_b32 v6, 1, v23
  v_cmp_gt_u32 vcc, 1296, v23
  v_mov_b32 v7, 0x80000000
  s_nop 1
  v_cndmask_b32 v6, v7, v6, vcc
  buffer_load_ushort v29, v6, s[44:47], s28 offen
  v_mov_b32 v30, 0
  v_mov_b32 v31, 0
  v_mov_b32 v32, 0
  v_mov_b32 v33, 0
  v_lshlrev_b32 v34, 4, v38
  v_add_u32 v34, 120832, v34
  ds_write_b128 v34, v[30:33] offset:0
  ds_write_b128 v34, v[30:33] offset:4096
  ds_write_b128 v34, v[30:33] offset:8192
  ds_write_b128 v34, v[30:33] offset:12288
  v_min_u32 v35, 121072, v34
  ds_write_b128 v35, v[30:33] offset:16384
  v_mov_b32 v30, 0x3f803f80
  v_mov_b32 v31, 0x3f803f80
  v_mov_b32 v32, 137472
  ds_write_b64 v32, v[30:31]
  s_waitcnt vmcnt(10) lgkmcnt(0)
  s_barrier
  s_branch k1_l_i0
k1_l_first2:
  s_waitcnt vmcnt(4)
  s_barrier
  s_branch k1_l_i0
k1_l_scat:
  s_cmp_lg_u32 s22, 0
  s_cbranch_scc1 k1_l_cont
  s_waitcnt vmcnt(8)
  v_mul_u32_u24 v30, 3237, v18
  v_lshrrev_b32 v30, 20, v30
  v_mul_u32_u24 v31, 324, v30
  v_sub_u32 v31, v18, v31
  v_mul_u32_u24 v32, 3641, v31
  v_lshrrev_b32 v32, 16, v32
  v_mul_u32_u24 v33, 18, v32
  v_sub_u32 v33, v31, v33
  v_lshrrev_b32 v34, 2, v33
  v_lshlrev_b32 v34, 4, v34
  v_lshl_add_u32 v34, v30, 2, v34
  v_and_b32 v33, 3, v33
  v_add_u32 v34, v34, v33
  v_mul_u32_u24 v34, 208, v34
  v_mul_u32_u24 v30, 18, v30
  v_add_u32 v30, v30, v32
  v_lshl_add_u32 v34, v30, 1, v34
  v_add_u32 v34, 120832, v34
  ds_write_b16 v34, v24
  v_mul_u32_u24 v30, 3237, v19
  v_lshrrev_b32 v30, 20, v30
  v_mul_u32_u24 v31, 324, v30
  v_sub_u32 v31, v19, v31
  v_mul_u32_u24 v32, 3641, v31
  v_lshrrev_b32 v32, 16, v32
  v_mul_u32_u24 v33, 18, v32
  v_sub_u32 v33, v31, v33
  v_lshrrev_b32 v34, 2, v33
  v_lshlrev_b32 v34, 4, v34
  v_lshl_add_u32 v34, v30, 2, v34
  v_and_b32 v33, 3, v33
  v_add_u32 v34, v34, v33
  v_mul_u32_u24 v34, 208, v34
  v_mul_u32_u24 v30, 18, v30
  v_add_u32 v30, v30, v32
  v_lshl_add_u32 v34, v30, 1, v34
  v_add_u32 v34, 120832, v34
  ds_write_b16 v34, v25
  v_mul_u32_u24 v30, 3237, v20
  v_lshrrev_b32 v30, 20, v30
  v_mul_u32_u24 v31, 324, v30
  v_sub_u32 v31, v20, v31
  v_mul_u32_u24 v32, 3641, v31
  v_lshrrev_b32 v32, 16, v32
  v_mul_u32_u24 v33, 18, v32
  v_sub_u32 v33, v31, v33
  v_lshrrev_b32 v34, 2, v33
  v_lshlrev_b32 v34, 4, v34
  v_lshl_add_u32 v34, v30, 2, v34
  v_and_b32 v33, 3, v33
  v_add_u32 v34, v34, v33
  v_mul_u32_u24 v34, 208, v34
  v_mul_u32_u24 v30, 18, v30
  v_add_u32 v30, v30, v32
  v_lshl_add_u32 v34, v30, 1, v34
  v_add_u32 v34, 120832, v34
  ds_write_b16 v34, v26
  v_mul_u32_u24 v30, 3237, v21
  v_lshrrev_b32 v30, 20, v30
  v_mul_u32_u24 v31, 324, v30
  v_sub_u32 v31, v21, v31
  v_mul_u32_u24 v32, 3641, v31
  v_lshrrev_b32 v32, 16, v32
  v_mul_u32_u24 v33, 18, v32
  v_sub_u32 v33, v31, v33
  v_lshrrev_b32 v34, 2, v33
  v_lshlrev_b32 v34, 4, v34
  v_lshl_add_u32 v34, v30, 2, v34
  v_and_b32 v33, 3, v33
  v_add_u32 v34, v34, v33
  v_mul_u32_u24 v34, 208, v34
  v_mul_u32_u24 v30, 18, v30
  v_add_u32 v30, v30, v32
  v_lshl_add_u32 v34, v30, 1, v34
  v_add_u32 v34, 120832, v34
  ds_write_b16 v34, v27
  v_mul_u32_u24 v30, 3237, v22
  v_lshrrev_b32 v30, 20, v30
  v_mul_u32_u24 v31, 324, v30
  v_sub_u32 v31, v22, v31
  v_mul_u32_u24 v32, 3641, v31
  v_lshrrev_b32 v32, 16, v32
  v_mul_u32_u24 v33, 18, v32
  v_sub_u32 v33, v31, v33
  v_lshrrev_b32 v34, 2, v33
  v_lshlrev_b32 v34, 4, v34
  v_lshl_add_u32 v34, v30, 2, v34
  v_and_b32 v33, 3, v33
  v_add_u32 v34, v34, v33
  v_mul_u32_u24 v34, 208, v34
  v_mul_u32_u24 v30, 18, v30
  v_add_u32 v30, v30, v32
  v_lshl_add_u32 v34, v30, 1, v34
  v_add_u32 v34, 120832, v34
  ds_write_b16 v34, v28
  v_mul_u32_u24 v30, 3237, v23
  v_lshrrev_b32 v30, 20, v30
  v_mul_u32_u24 v31, 324, v30
  v_sub_u32 v31, v23, v31
  v_mul_u32_u24 v32, 3641, v31
  v_lshrrev_b32 v32, 16, v32
  v_mul_u32_u24 v33, 18, v32
  v_sub_u32 v33, v31, v33
  v_lshrrev_b32 v34, 2, v33
  v_lshlrev_b32 v34, 4, v34
  v_lshl_add_u32 v34, v30, 2, v34
  v_and_b32 v33, 3, v33
  v_add_u32 v34, v34, v33
  v_mul_u32_u24 v34, 208, v34
  v_mul_u32_u24 v30, 18, v30
  v_add_u32 v30, v30, v32
  v_lshl_add_u32 v34, v30, 1, v34
  v_cmp_gt_u32 vcc, 1296, v23
  v_mov_b32 v30, 16656
  s_nop 1
  v_cndmask_b32 v34, v30, v34, vcc
  v_add_u32 v34, 120832, v34
  ds_write_b16 v34, v29
  s_branch k1_l_cont
k1_comp:
  s_and_b32 s28, s21, 7
  s_cmp_lg_u32 s28, 0
  s_cbranch_scc1 k1_nopf
  s_getpc_b64 s[32:33]
k1_pc:
  s_sub_u32 s32, s32, k1_pc - k1_kernel
  s_subb_u32 s33, s33, 0
  s_and_b32 s33, s33, 0xffff
  s_mov_b32 s34, code_end - k1_kernel
  s_mov_b32 s35, 0x00020000
  v_lshlrev_b32 v6, 7, v0
  buffer_load_dword v248, v6, s[32:35], 0 offen
  s_mov_b32 s28, 32768
  buffer_load_dword v248, v6, s[32:35], s28 offen
k1_nopf:
  s_waitcnt lgkmcnt(0)
  s_cmp_eq_u32 s22, 0
  s_cselect_b32 s4, s4, s8
  s_cselect_b32 s5, s5, s9
  s_cselect_b32 s6, s6, s10
  s_cselect_b32 s7, s7, s11
  s_mov_b32 s32, s4
  s_and_b32 s33, s5, 0xffff
  s_mov_b32 s34, 2359296
  s_mov_b32 s35, 0x00020000
  s_mov_b32 s36, s6
  s_and_b32 s37, s7, 0xffff
  s_mov_b32 s38, 1990656
  s_mov_b32 s39, 0x00020000
  s_mov_b32 s40, s16
  s_and_b32 s41, s17, 0xffff
  s_mov_b32 s42, 8388608
  s_mov_b32 s43, 0x00020000
  s_mov_b32 s44, s12
  s_and_b32 s45, s13, 0xffff
  s_mov_b32 s46, 20736
  s_mov_b32 s47, 0x00020000
  s_cmp_eq_u32 s22, 1
  s_cbranch_scc1 k1_B
  v_and_b32 v6, 7, v1
  v_xor_b32 v6, v6, v3
  v_lshrrev_b32 v7, 3, v1
  v_mul_u32_u24 v7, 1152, v7
  v_lshl_add_u32 v250, v6, 4, v7
  v_xor_b32 v251, 64, v250
  s_lshr_b32 s28, s21, 2
  s_and_b32 s29, s21, 3
  s_lshl_b32 s29, s29, 1
  s_add_u32 s54, s28, s29
  s_sub_u32 s28, s54, 9
  s_cmp_ge_u32 s54, 9
  s_cselect_b32 s54, s28, s54
  s_lshl_b32 s54, s54, 7
  s_lshl_b32 s28, s25, 4
  s_add_u32 s28, s28, s48
  s_mul_i32 s53, s28, 1152
  s_sub_u32 s28, s48, 16
  s_max_i32 s28, s28, 0
  s_mul_i32 s56, s28, 1152
  s_cmp_eq_u32 s25, 0
  s_cselect_b32 s56, s56, 0x80000000
  s_lshl_b32 s57, s25, 11
  s_add_u32 s57, s57, 67584
  s_add_u32 m0, s57, 0
  s_add_u32 s28, s54, s53
  buffer_load_dwordx4 v250, s[32:35], s28 offen lds
  s_add_u32 m0, s57, 1024
  s_add_u32 s28, s54, s53
  s_add_u32 s28, s28, 9216
  buffer_load_dwordx4 v251, s[32:35], s28 offen lds
  s_add_u32 m0, s57, 8192
  s_add_u32 s28, s54, s53
  s_add_u32 s28, s28, 73728
  buffer_load_dwordx4 v250, s[32:35], s28 offen lds
  s_add_u32 m0, s57, 9216
  s_add_u32 s28, s54, s53
  s_add_u32 s28, s28, 82944
  buffer_load_dwordx4 v251, s[32:35], s28 offen lds
  s_add_u32 s54, s54, 128
  s_cmp_eq_u32 s54, 1152
  s_cselect_b32 s54, 0, s54
  s_add_u32 m0, s57, 18432
  s_add_u32 s28, s54, s53
  buffer_load_dwordx4 v250, s[32:35], s28 offen lds
  s_add_u32 m0, s57, 19456
  s_add_u32 s28, s54, s53
  s_add_u32 s28, s28, 9216
  buffer_load_dwordx4 v251, s[32:35], s28 offen lds
  v_lshlrev_b32 v12, 12, v3
  v_and_b32 v6, 1, v3
  v_lshl_add_u32 v12, v6, 7, v12
  v_mul_u32_u24 v6, 480, v4
  s_mul_i32 s30, s27, 72
  v_add3_u32 v12, v12, v6, s30
  v_lshlrev_b32 v7, 3, v5
  s_mov_b32 s28, 0x15141312
  v_bfe_u32 v6, s28, v7, 8
  v_lshl_add_u32 v236, v6, 3, v12
  s_mov_b32 s28, 0x19181716
  v_bfe_u32 v6, s28, v7, 8
  v_lshl_add_u32 v237, v6, 3, v12
  s_mov_b32 s28, 0x2625241a
  v_bfe_u32 v6, s28, v7, 8
  v_lshl_add_u32 v238, v6, 3, v12
  s_mov_b32 s28, 0x2a292827
  v_bfe_u32 v6, s28, v7, 8
  v_lshl_add_u32 v239, v6, 3, v12
  s_mov_b32 s28, 0x1002c2b
  v_bfe_u32 v6, s28, v7, 8
  v_lshl_add_u32 v240, v6, 3, v12
  s_mov_b32 s28, 0x5040302
  v_bfe_u32 v6, s28, v7, 8
  v_lshl_add_u32 v241, v6, 3, v12
  s_mov_b32 s28, 0x8080706
  v_bfe_u32 v6, s28, v7, 8
  v_lshl_add_u32 v242, v6, 3, v12
  v_lshrrev_b32 v6, 1, v2
  v_xor_b32 v6, v6, v3
  v_lshlrev_b32 v7, 7, v2
  v_lshl_add_u32 v6, v6, 4, v7
  v_add_u32 v245, 65536, v6
  v_xor_b32 v246, 64, v245
  s_lshl_b32 s28, s26, 13
  s_add_u32 s28, s28, 2048
  v_add_u32 v243, s28, v245
  v_add_u32 v244, s28, v246
  s_waitcnt vmcnt(2)
  s_barrier
  ds_read_b128 v[196:199], v243 offset:0
  ds_read_b128 v[200:203], v243 offset:2048
  ds_read_b128 v[204:207], v243 offset:4096
  ds_read_b128 v[208:211], v243 offset:6144
  ds_read_b64_tr_b16 v[140:141], v236 offset:0
  ds_read_b64_tr_b16 v[142:143], v236 offset:2048
  ds_read_b64_tr_b16 v[144:145], v237 offset:0
  ds_read_b64_tr_b16 v[146:147], v237 offset:2048
  ds_read_b64_tr_b16 v[148:149], v238 offset:0
  ds_read_b64_tr_b16 v[150:151], v238 offset:2048
  ds_read_b64_tr_b16 v[152:153], v239 offset:0
  ds_read_b64_tr_b16 v[154:155], v239 offset:2048
  ds_read_b64_tr_b16 v[156:157], v240 offset:0
  ds_read_b64_tr_b16 v[158:159], v240 offset:2048
  ds_read_b64_tr_b16 v[160:161], v241 offset:0
  ds_read_b64_tr_b16 v[162:163], v241 offset:2048
  ds_read_b64_tr_b16 v[164:165], v242 offset:0
  ds_read_b64_tr_b16 v[166:167], v242 offset:2048
  s_add_u32 m0, s57, 26624
  s_add_u32 s28, s54, s53
  s_add_u32 s28, s28, 73728
  buffer_load_dwordx4 v250, s[32:35], s28 offen lds
  s_add_u32 m0, s57, 27648
  s_add_u32 s28, s54, s53
  s_add_u32 s28, s28, 82944
  buffer_load_dwordx4 v251, s[32:35], s28 offen lds
  s_add_u32 s54, s54, 128
  s_cmp_eq_u32 s54, 1152
  s_cselect_b32 s54, 0, s54
  s_add_u32 m0, s57, 36864
  s_add_u32 s28, s54, s53
  buffer_load_dwordx4 v250, s[32:35], s28 offen lds
  s_add_u32 m0, s57, 37888
  s_add_u32 s28, s54, s53
  s_add_u32 s28, s28, 9216
  buffer_load_dwordx4 v251, s[32:35], s28 offen lds
  s_waitcnt vmcnt(4) lgkmcnt(0)
  s_barrier
  v_mfma_f32_16x16x32_bf16 v[16:19], v[140:143], v[196:199], 0
  ds_read_b128 v[216:219], v244 offset:0
  v_mfma_f32_16x16x32_bf16 v[20:23], v[140:143], v[200:203], 0
  ds_read_b128 v[220:223], v244 offset:2048
  v_mfma_f32_16x16x32_bf16 v[24:27], v[140:143], v[204:207], 0
  ds_read_b128 v[224:227], v244 offset:4096
  v_mfma_f32_16x16x32_bf16 v[28:31], v[140:143], v[208:211], 0
  ds_read_b128 v[228:231], v244 offset:6144
  v_mfma_f32_16x16x32_bf16 v[32:35], v[144:147], v[196:199], 0
  ds_read_b64_tr_b16 v[168:169], v236 offset:16384
  v_mfma_f32_16x16x32_bf16 v[36:39], v[144:147], v[200:203], 0
  ds_read_b64_tr_b16 v[170:171], v236 offset:18432
  v_mfma_f32_16x16x32_bf16 v[40:43], v[144:147], v[204:207], 0
  ds_read_b64_tr_b16 v[172:173], v237 offset:16384
  v_mfma_f32_16x16x32_bf16 v[44:47], v[144:147], v[208:211], 0
  ds_read_b64_tr_b16 v[174:175], v237 offset:18432
  v_mfma_f32_16x16x32_bf16 v[48:51], v[148:151], v[196:199], 0
  ds_read_b64_tr_b16 v[176:177], v238 offset:16384
  v_mfma_f32_16x16x32_bf16 v[52:55], v[148:151], v[200:203], 0
  ds_read_b64_tr_b16 v[178:179], v238 offset:18432
  v_mfma_f32_16x16x32_bf16 v[56:59], v[148:151], v[204:207], 0
  ds_read_b64_tr_b16 v[180:181], v239 offset:16384
  v_mfma_f32_16x16x32_bf16 v[60:63], v[148:151], v[208:211], 0
  ds_read_b64_tr_b16 v[182:183], v239 offset:18432
  v_mfma_f32_16x16x32_bf16 v[64:67], v[152:155], v[196:199], 0
  ds_read_b64_tr_b16 v[184:185], v240 offset:16384
  v_mfma_f32_16x16x32_bf16 v[68:71], v[152:155], v[200:203], 0
  ds_read_b64_tr_b16 v[186:187], v240 offset:18432
  v_mfma_f32_16x16x32_bf16 v[72:75], v[152:155], v[204:207], 0
  ds_read_b64_tr_b16 v[188:189], v241 offset:16384
  v_mfma_f32_16x16x32_bf16 v[76:79], v[152:155], v[208:211], 0
  ds_read_b64_tr_b16 v[190:191], v241 offset:18432
  v_mfma_f32_16x16x32_bf16 v[80:83], v[156:159], v[196:199], 0
  ds_read_b64_tr_b16 v[192:193], v242 offset:16384
  v_mfma_f32_16x16x32_bf16 v[84:87], v[156:159], v[200:203], 0
  ds_read_b64_tr_b16 v[194:195], v242 offset:18432
  v_mfma_f32_16x16x32_bf16 v[88:91], v[156:159], v[204:207], 0
  s_add_u32 m0, s57, 45056
  s_add_u32 s28, s54, s53
  s_add_u32 s28, s28, 73728
  buffer_load_dwordx4 v250, s[32:35], s28 offen lds
  s_add_u32 m0, s57, 46080
  s_add_u32 s28, s54, s53
  s_add_u32 s28, s28, 82944
  buffer_load_dwordx4 v251, s[32:35], s28 offen lds
  s_add_u32 s54, s54, 128
  s_cmp_eq_u32 s54, 1152
  s_cselect_b32 s54, 0, s54
  v_mfma_f32_16x16x32_bf16 v[92:95], v[156:159], v[208:211], 0
  v_mfma_f32_16x16x32_bf16 v[96:99], v[160:163], v[196:199], 0
  v_mfma_f32_16x16x32_bf16 v[100:103], v[160:163], v[200:203], 0
  v_mfma_f32_16x16x32_bf16 v[104:107], v[160:163], v[204:207], 0
  v_mfma_f32_16x16x32_bf16 v[108:111], v[160:163], v[208:211], 0
  v_mfma_f32_16x16x32_bf16 v[112:115], v[164:167], v[196:199], 0
  v_mfma_f32_16x16x32_bf16 v[116:119], v[164:167], v[200:203], 0
  v_mfma_f32_16x16x32_bf16 v[120:123], v[164:167], v[204:207], 0
  v_mfma_f32_16x16x32_bf16 v[124:127], v[164:167], v[208:211], 0
  s_waitcnt vmcnt(4) lgkmcnt(0)
  s_barrier
  v_mfma_f32_16x16x32_bf16 v[16:19], v[168:171], v[216:219], v[16:19]
  ds_read_b128 v[196:199], v243 offset:18432
  v_mfma_f32_16x16x32_bf16 v[20:23], v[168:171], v[220:223], v[20:23]
  ds_read_b128 v[200:203], v243 offset:20480
  v_mfma_f32_16x16x32_bf16 v[24:27], v[168:171], v[224:227], v[24:27]
  ds_read_b128 v[204:207], v243 offset:22528
  v_mfma_f32_16x16x32_bf16 v[28:31], v[168:171], v[228:231], v[28:31]
  ds_read_b128 v[208:211], v243 offset:24576
  v_mfma_f32_16x16x32_bf16 v[32:35], v[172:175], v[216:219], v[32:35]
  ds_read_b64_tr_b16 v[140:141], v236 offset:32768
  v_mfma_f32_16x16x32_bf16 v[36:39], v[172:175], v[220:223], v[36:39]
  ds_read_b64_tr_b16 v[142:143], v236 offset:34816
  v_mfma_f32_16x16x32_bf16 v[40:43], v[172:175], v[224:227], v[40:43]
  ds_read_b64_tr_b16 v[144:145], v237 offset:32768
  v_mfma_f32_16x16x32_bf16 v[44:47], v[172:175], v[228:231], v[44:47]
  ds_read_b64_tr_b16 v[146:147], v237 offset:34816
  v_mfma_f32_16x16x32_bf16 v[48:51], v[176:179], v[216:219], v[48:51]
  ds_read_b64_tr_b16 v[148:149], v238 offset:32768
  v_mfma_f32_16x16x32_bf16 v[52:55], v[176:179], v[220:223], v[52:55]
  ds_read_b64_tr_b16 v[150:151], v238 offset:34816
  v_mfma_f32_16x16x32_bf16 v[56:59], v[176:179], v[224:227], v[56:59]
  ds_read_b64_tr_b16 v[152:153], v239 offset:32768
  v_mfma_f32_16x16x32_bf16 v[60:63], v[176:179], v[228:231], v[60:63]
  ds_read_b64_tr_b16 v[154:155], v239 offset:34816
  v_mfma_f32_16x16x32_bf16 v[64:67], v[180:183], v[216:219], v[64:67]
  ds_read_b64_tr_b16 v[156:157], v240 offset:32768
  v_mfma_f32_16x16x32_bf16 v[68:71], v[180:183], v[220:223], v[68:71]
  ds_read_b64_tr_b16 v[158:159], v240 offset:34816
  v_mfma_f32_16x16x32_bf16 v[72:75], v[180:183], v[224:227], v[72:75]
  ds_read_b64_tr_b16 v[160:161], v241 offset:32768
  v_mfma_f32_16x16x32_bf16 v[76:79], v[180:183], v[228:231], v[76:79]
  ds_read_b64_tr_b16 v[162:163], v241 offset:34816
  v_mfma_f32_16x16x32_bf16 v[80:83], v[184:187], v[216:219], v[80:83]
  ds_read_b64_tr_b16 v[164:165], v242 offset:32768
  v_mfma_f32_16x16x32_bf16 v[84:87], v[184:187], v[220:223], v[84:87]
  ds_read_b64_tr_b16 v[166:167], v242 offset:34816
  v_mfma_f32_16x16x32_bf16 v[88:91], v[184:187], v[224:227], v[88:91]
  s_add_u32 m0, s57, 0
  s_add_u32 s28, s54, s53
  buffer_load_dwordx4 v250, s[32:35], s28 offen lds
  s_add_u32 m0, s57, 1024
  s_add_u32 s28, s54, s53
  s_add_u32 s28, s28, 9216
  buffer_load_dwordx4 v251, s[32:35], s28 offen lds
  v_mfma_f32_16x16x32_bf16 v[92:95], v[184:187], v[228:231], v[92:95]
  v_mfma_f32_16x16x32_bf16 v[96:99], v[188:191], v[216:219], v[96:99]
  v_mfma_f32_16x16x32_bf16 v[100:103], v[188:191], v[220:223], v[100:103]
  v_mfma_f32_16x16x32_bf16 v[104:107], v[188:191], v[224:227], v[104:107]
  v_mfma_f32_16x16x32_bf16 v[108:111], v[188:191], v[228:231], v[108:111]
  v_mfma_f32_16x16x32_bf16 v[112:115], v[192:195], v[216:219], v[112:115]
  v_mfma_f32_16x16x32_bf16 v[116:119], v[192:195], v[220:223], v[116:119]
  v_mfma_f32_16x16x32_bf16 v[120:123], v[192:195], v[224:227], v[120:123]
  v_mfma_f32_16x16x32_bf16 v[124:127], v[192:195], v[228:231], v[124:127]
  s_waitcnt vmcnt(4) lgkmcnt(0)
  s_barrier
  v_mfma_f32_16x16x32_bf16 v[16:19], v[140:143], v[196:199], v[16:19]
  ds_read_b128 v[216:219], v244 offset:18432
  v_mfma_f32_16x16x32_bf16 v[20:23], v[140:143], v[200:203], v[20:23]
  ds_read_b128 v[220:223], v244 offset:20480
  v_mfma_f32_16x16x32_bf16 v[24:27], v[140:143], v[204:207], v[24:27]
  ds_read_b128 v[224:227], v244 offset:22528
  v_mfma_f32_16x16x32_bf16 v[28:31], v[140:143], v[208:211], v[28:31]
  ds_read_b128 v[228:231], v244 offset:24576
  v_mfma_f32_16x16x32_bf16 v[32:35], v[144:147], v[196:199], v[32:35]
  ds_read_b64_tr_b16 v[168:169], v236 offset:49152
  v_mfma_f32_16x16x32_bf16 v[36:39], v[144:147], v[200:203], v[36:39]
  ds_read_b64_tr_b16 v[170:171], v236 offset:51200
  v_mfma_f32_16x16x32_bf16 v[40:43], v[144:147], v[204:207], v[40:43]
  ds_read_b64_tr_b16 v[172:173], v237 offset:49152
  v_mfma_f32_16x16x32_bf16 v[44:47], v[144:147], v[208:211], v[44:47]
  ds_read_b64_tr_b16 v[174:175], v237 offset:51200
  v_mfma_f32_16x16x32_bf16 v[48:51], v[148:151], v[196:199], v[48:51]
  ds_read_b64_tr_b16 v[176:177], v238 offset:49152
  v_mfma_f32_16x16x32_bf16 v[52:55], v[148:151], v[200:203], v[52:55]
  ds_read_b64_tr_b16 v[178:179], v238 offset:51200
  v_mfma_f32_16x16x32_bf16 v[56:59], v[148:151], v[204:207], v[56:59]
  ds_read_b64_tr_b16 v[180:181], v239 offset:49152
  v_mfma_f32_16x16x32_bf16 v[60:63], v[148:151], v[208:211], v[60:63]
  ds_read_b64_tr_b16 v[182:183], v239 offset:51200
  v_mfma_f32_16x16x32_bf16 v[64:67], v[152:155], v[196:199], v[64:67]
  ds_read_b64_tr_b16 v[184:185], v240 offset:49152
  v_mfma_f32_16x16x32_bf16 v[68:71], v[152:155], v[200:203], v[68:71]
  ds_read_b64_tr_b16 v[186:187], v240 offset:51200
  v_mfma_f32_16x16x32_bf16 v[72:75], v[152:155], v[204:207], v[72:75]
  ds_read_b64_tr_b16 v[188:189], v241 offset:49152
  v_mfma_f32_16x16x32_bf16 v[76:79], v[152:155], v[208:211], v[76:79]
  ds_read_b64_tr_b16 v[190:191], v241 offset:51200
  v_mfma_f32_16x16x32_bf16 v[80:83], v[156:159], v[196:199], v[80:83]
  ds_read_b64_tr_b16 v[192:193], v242 offset:49152
  v_mfma_f32_16x16x32_bf16 v[84:87], v[156:159], v[200:203], v[84:87]
  ds_read_b64_tr_b16 v[194:195], v242 offset:51200
  v_mfma_f32_16x16x32_bf16 v[88:91], v[156:159], v[204:207], v[88:91]
  s_add_u32 m0, s57, 8192
  s_add_u32 s28, s54, s53
  s_add_u32 s28, s28, 73728
  buffer_load_dwordx4 v250, s[32:35], s28 offen lds
  s_add_u32 m0, s57, 9216
  s_add_u32 s28, s54, s53
  s_add_u32 s28, s28, 82944
  buffer_load_dwordx4 v251, s[32:35], s28 offen lds
  s_add_u32 s54, s54, 128
  s_cmp_eq_u32 s54, 1152
  s_cselect_b32 s54, 0, s54
  v_mfma_f32_16x16x32_bf16 v[92:95], v[156:159], v[208:211], v[92:95]
  v_mfma_f32_16x16x32_bf16 v[96:99], v[160:163], v[196:199], v[96:99]
  v_mfma_f32_16x16x32_bf16 v[100:103], v[160:163], v[200:203], v[100:103]
  v_mfma_f32_16x16x32_bf16 v[104:107], v[160:163], v[204:207], v[104:107]
  v_mfma_f32_16x16x32_bf16 v[108:111], v[160:163], v[208:211], v[108:111]
  v_mfma_f32_16x16x32_bf16 v[112:115], v[164:167], v[196:199], v[112:115]
  v_mfma_f32_16x16x32_bf16 v[116:119], v[164:167], v[200:203], v[116:119]
  v_mfma_f32_16x16x32_bf16 v[120:123], v[164:167], v[204:207], v[120:123]
  v_mfma_f32_16x16x32_bf16 v[124:127], v[164:167], v[208:211], v[124:127]
  s_waitcnt vmcnt(4) lgkmcnt(0)
  s_barrier
  v_mfma_f32_16x16x32_bf16 v[16:19], v[168:171], v[216:219], v[16:19]
  ds_read_b128 v[196:199], v243 offset:36864
  v_mfma_f32_16x16x32_bf16 v[20:23], v[168:171], v[220:223], v[20:23]
  ds_read_b128 v[200:203], v243 offset:38912
  v_mfma_f32_16x16x32_bf16 v[24:27], v[168:171], v[224:227], v[24:27]
  ds_read_b128 v[204:207], v243 offset:40960
  v_mfma_f32_16x16x32_bf16 v[28:31], v[168:171], v[228:231], v[28:31]
  ds_read_b128 v[208:211], v243 offset:43008
  v_mfma_f32_16x16x32_bf16 v[32:35], v[172:175], v[216:219], v[32:35]
  ds_read_b64_tr_b16 v[140:141], v236 offset:0
  v_mfma_f32_16x16x32_bf16 v[36:39], v[172:175], v[220:223], v[36:39]
  ds_read_b64_tr_b16 v[142:143], v236 offset:2048
  v_mfma_f32_16x16x32_bf16 v[40:43], v[172:175], v[224:227], v[40:43]
  ds_read_b64_tr_b16 v[144:145], v237 offset:0
  v_mfma_f32_16x16x32_bf16 v[44:47], v[172:175], v[228:231], v[44:47]
  ds_read_b64_tr_b16 v[146:147], v237 offset:2048
  v_mfma_f32_16x16x32_bf16 v[48:51], v[176:179], v[216:219], v[48:51]
  ds_read_b64_tr_b16 v[148:149], v238 offset:0
  v_mfma_f32_16x16x32_bf16 v[52:55], v[176:179], v[220:223], v[52:55]
  ds_read_b64_tr_b16 v[150:151], v238 offset:2048
  v_mfma_f32_16x16x32_bf16 v[56:59], v[176:179], v[224:227], v[56:59]
  ds_read_b64_tr_b16 v[152:153], v239 offset:0
  v_mfma_f32_16x16x32_bf16 v[60:63], v[176:179], v[228:231], v[60:63]
  ds_read_b64_tr_b16 v[154:155], v239 offset:2048
  v_mfma_f32_16x16x32_bf16 v[64:67], v[180:183], v[216:219], v[64:67]
  ds_read_b64_tr_b16 v[156:157], v240 offset:0
  v_mfma_f32_16x16x32_bf16 v[68:71], v[180:183], v[220:223], v[68:71]
  ds_read_b64_tr_b16 v[158:159], v240 offset:2048
  v_mfma_f32_16x16x32_bf16 v[72:75], v[180:183], v[224:227], v[72:75]
  ds_read_b64_tr_b16 v[160:161], v241 offset:0
  v_mfma_f32_16x16x32_bf16 v[76:79], v[180:183], v[228:231], v[76:79]
  ds_read_b64_tr_b16 v[162:163], v241 offset:2048
  v_mfma_f32_16x16x32_bf16 v[80:83], v[184:187], v[216:219], v[80:83]
  ds_read_b64_tr_b16 v[164:165], v242 offset:0
  v_mfma_f32_16x16x32_bf16 v[84:87], v[184:187], v[220:223], v[84:87]
  ds_read_b64_tr_b16 v[166:167], v242 offset:2048
  v_mfma_f32_16x16x32_bf16 v[88:91], v[184:187], v[224:227], v[88:91]
  s_add_u32 m0, s57, 18432
  s_add_u32 s28, s54, s53
  buffer_load_dwordx4 v250, s[32:35], s28 offen lds
  s_add_u32 m0, s57, 19456
  s_add_u32 s28, s54, s53
  s_add_u32 s28, s28, 9216
  buffer_load_dwordx4 v251, s[32:35], s28 offen lds
  v_mfma_f32_16x16x32_bf16 v[92:95], v[184:187], v[228:231], v[92:95]
  v_mfma_f32_16x16x32_bf16 v[96:99], v[188:191], v[216:219], v[96:99]
  v_mfma_f32_16x16x32_bf16 v[100:103], v[188:191], v[220:223], v[100:103]
  v_mfma_f32_16x16x32_bf16 v[104:107], v[188:191], v[224:227], v[104:107]
  v_mfma_f32_16x16x32_bf16 v[108:111], v[188:191], v[228:231], v[108:111]
  v_mfma_f32_16x16x32_bf16 v[112:115], v[192:195], v[216:219], v[112:115]
  v_mfma_f32_16x16x32_bf16 v[116:119], v[192:195], v[220:223], v[116:119]
  v_mfma_f32_16x16x32_bf16 v[120:123], v[192:195], v[224:227], v[120:123]
  v_mfma_f32_16x16x32_bf16 v[124:127], v[192:195], v[228:231], v[124:127]
  s_waitcnt vmcnt(4) lgkmcnt(0)
  s_barrier
  v_mfma_f32_16x16x32_bf16 v[16:19], v[140:143], v[196:199], v[16:19]
  ds_read_b128 v[216:219], v244 offset:36864
  v_mfma_f32_16x16x32_bf16 v[20:23], v[140:143], v[200:203], v[20:23]
  ds_read_b128 v[220:223], v244 offset:38912
  v_mfma_f32_16x16x32_bf16 v[24:27], v[140:143], v[204:207], v[24:27]
  ds_read_b128 v[224:227], v244 offset:40960
  v_mfma_f32_16x16x32_bf16 v[28:31], v[140:143], v[208:211], v[28:31]
  ds_read_b128 v[228:231], v244 offset:43008
  v_mfma_f32_16x16x32_bf16 v[32:35], v[144:147], v[196:199], v[32:35]
  ds_read_b64_tr_b16 v[168:169], v236 offset:16384
  v_mfma_f32_16x16x32_bf16 v[36:39], v[144:147], v[200:203], v[36:39]
  ds_read_b64_tr_b16 v[170:171], v236 offset:18432
  v_mfma_f32_16x16x32_bf16 v[40:43], v[144:147], v[204:207], v[40:43]
  ds_read_b64_tr_b16 v[172:173], v237 offset:16384
  v_mfma_f32_16x16x32_bf16 v[44:47], v[144:147], v[208:211], v[44:47]
  ds_read_b64_tr_b16 v[174:175], v237 offset:18432
  v_mfma_f32_16x16x32_bf16 v[48:51], v[148:151], v[196:199], v[48:51]
  ds_read_b64_tr_b16 v[176:177], v238 offset:16384
  v_mfma_f32_16x16x32_bf16 v[52:55], v[148:151], v[200:203], v[52:55]
  ds_read_b64_tr_b16 v[178:179], v238 offset:18432
  v_mfma_f32_16x16x32_bf16 v[56:59], v[148:151], v[204:207], v[56:59]
  ds_read_b64_tr_b16 v[180:181], v239 offset:16384
  v_mfma_f32_16x16x32_bf16 v[60:63], v[148:151], v[208:211], v[60:63]
  ds_read_b64_tr_b16 v[182:183], v239 offset:18432
  v_mfma_f32_16x16x32_bf16 v[64:67], v[152:155], v[196:199], v[64:67]
  ds_read_b64_tr_b16 v[184:185], v240 offset:16384
  v_mfma_f32_16x16x32_bf16 v[68:71], v[152:155], v[200:203], v[68:71]
  ds_read_b64_tr_b16 v[186:187], v240 offset:18432
  v_mfma_f32_16x16x32_bf16 v[72:75], v[152:155], v[204:207], v[72:75]
  ds_read_b64_tr_b16 v[188:189], v241 offset:16384
  v_mfma_f32_16x16x32_bf16 v[76:79], v[152:155], v[208:211], v[76:79]
  ds_read_b64_tr_b16 v[190:191], v241 offset:18432
  v_mfma_f32_16x16x32_bf16 v[80:83], v[156:159], v[196:199], v[80:83]
  ds_read_b64_tr_b16 v[192:193], v242 offset:16384
  v_mfma_f32_16x16x32_bf16 v[84:87], v[156:159], v[200:203], v[84:87]
  ds_read_b64_tr_b16 v[194:195], v242 offset:18432
  v_mfma_f32_16x16x32_bf16 v[88:91], v[156:159], v[204:207], v[88:91]
  s_add_u32 m0, s57, 26624
  s_add_u32 s28, s54, s53
  s_add_u32 s28, s28, 73728
  buffer_load_dwordx4 v250, s[32:35], s28 offen lds
  s_add_u32 m0, s57, 27648
  s_add_u32 s28, s54, s53
  s_add_u32 s28, s28, 82944
  buffer_load_dwordx4 v251, s[32:35], s28 offen lds
  s_add_u32 s54, s54, 128
  s_cmp_eq_u32 s54, 1152
  s_cselect_b32 s54, 0, s54
  v_mfma_f32_16x16x32_bf16 v[92:95], v[156:159], v[208:211], v[92:95]
  v_mfma_f32_16x16x32_bf16 v[96:99], v[160:163], v[196:199], v[96:99]
  v_mfma_f32_16x16x32_bf16 v[100:103], v[160:163], v[200:203], v[100:103]
  v_mfma_f32_16x16x32_bf16 v[104:107], v[160:163], v[204:207], v[104:107]
  v_mfma_f32_16x16x32_bf16 v[108:111], v[160:163], v[208:211], v[108:111]
  v_mfma_f32_16x16x32_bf16 v[112:115], v[164:167], v[196:199], v[112:115]
  v_mfma_f32_16x16x32_bf16 v[116:119], v[164:167], v[200:203], v[116:119]
  v_mfma_f32_16x16x32_bf16 v[120:123], v[164:167], v[204:207], v[120:123]
  v_mfma_f32_16x16x32_bf16 v[124:127], v[164:167], v[208:211], v[124:127]
  s_waitcnt vmcnt(4) lgkmcnt(0)
  s_barrier
  v_mfma_f32_16x16x32_bf16 v[16:19], v[168:171], v[216:219], v[16:19]
  ds_read_b128 v[196:199], v243 offset:0
  v_mfma_f32_16x16x32_bf16 v[20:23], v[168:171], v[220:223], v[20:23]
  ds_read_b128 v[200:203], v243 offset:2048
  v_mfma_f32_16x16x32_bf16 v[24:27], v[168:171], v[224:227], v[24:27]
  ds_read_b128 v[204:207], v243 offset:4096
  v_mfma_f32_16x16x32_bf16 v[28:31], v[168:171], v[228:231], v[28:31]
  ds_read_b128 v[208:211], v243 offset:6144
  v_mfma_f32_16x16x32_bf16 v[32:35], v[172:175], v[216:219], v[32:35]
  ds_read_b64_tr_b16 v[140:141], v236 offset:32768
  v_mfma_f32_16x16x32_bf16 v[36:39], v[172:175], v[220:223], v[36:39]
  ds_read_b64_tr_b16 v[142:143], v236 offset:34816
  v_mfma_f32_16x16x32_bf16 v[40:43], v[172:175], v[224:227], v[40:43]
  ds_read_b64_tr_b16 v[144:145], v237 offset:32768
  v_mfma_f32_16x16x32_bf16 v[44:47], v[172:175], v[228:231], v[44:47]
  ds_read_b64_tr_b16 v[146:147], v237 offset:34816
  v_mfma_f32_16x16x32_bf16 v[48:51], v[176:179], v[216:219], v[48:51]
  ds_read_b64_tr_b16 v[148:149], v238 offset:32768
  v_mfma_f32_16x16x32_bf16 v[52:55], v[176:179], v[220:223], v[52:55]
  ds_read_b64_tr_b16 v[150:151], v238 offset:34816
  v_mfma_f32_16x16x32_bf16 v[56:59], v[176:179], v[224:227], v[56:59]
  ds_read_b64_tr_b16 v[152:153], v239 offset:32768
  v_mfma_f32_16x16x32_bf16 v[60:63], v[176:179], v[228:231], v[60:63]
  ds_read_b64_tr_b16 v[154:155], v239 offset:34816
  v_mfma_f32_16x16x32_bf16 v[64:67], v[180:183], v[216:219], v[64:67]
  ds_read_b64_tr_b16 v[156:157], v240 offset:32768
  v_mfma_f32_16x16x32_bf16 v[68:71], v[180:183], v[220:223], v[68:71]
  ds_read_b64_tr_b16 v[158:159], v240 offset:34816
  v_mfma_f32_16x16x32_bf16 v[72:75], v[180:183], v[224:227], v[72:75]
  ds_read_b64_tr_b16 v[160:161], v241 offset:32768
  v_mfma_f32_16x16x32_bf16 v[76:79], v[180:183], v[228:231], v[76:79]
  ds_read_b64_tr_b16 v[162:163], v241 offset:34816
  v_mfma_f32_16x16x32_bf16 v[80:83], v[184:187], v[216:219], v[80:83]
  ds_read_b64_tr_b16 v[164:165], v242 offset:32768
  v_mfma_f32_16x16x32_bf16 v[84:87], v[184:187], v[220:223], v[84:87]
  ds_read_b64_tr_b16 v[166:167], v242 offset:34816
  v_mfma_f32_16x16x32_bf16 v[88:91], v[184:187], v[224:227], v[88:91]
  s_add_u32 m0, s57, 36864
  s_add_u32 s28, s54, s53
  buffer_load_dwordx4 v250, s[32:35], s28 offen lds
  s_add_u32 m0, s57, 37888
  s_add_u32 s28, s54, s53
  s_add_u32 s28, s28, 9216
  buffer_load_dwordx4 v251, s[32:35], s28 offen lds
  v_mfma_f32_16x16x32_bf16 v[92:95], v[184:187], v[228:231], v[92:95]
  v_mfma_f32_16x16x32_bf16 v[96:99], v[188:191], v[216:219], v[96:99]
  v_mfma_f32_16x16x32_bf16 v[100:103], v[188:191], v[220:223], v[100:103]
  v_mfma_f32_16x16x32_bf16 v[104:107], v[188:191], v[224:227], v[104:107]
  v_mfma_f32_16x16x32_bf16 v[108:111], v[188:191], v[228:231], v[108:111]
  v_mfma_f32_16x16x32_bf16 v[112:115], v[192:195], v[216:219], v[112:115]
  v_mfma_f32_16x16x32_bf16 v[116:119], v[192:195], v[220:223], v[116:119]
  v_mfma_f32_16x16x32_bf16 v[120:123], v[192:195], v[224:227], v[120:123]
  v_mfma_f32_16x16x32_bf16 v[124:127], v[192:195], v[228:231], v[124:127]
  s_waitcnt vmcnt(4) lgkmcnt(0)
  s_barrier
  v_mfma_f32_16x16x32_bf16 v[16:19], v[140:143], v[196:199], v[16:19]
  ds_read_b128 v[216:219], v244 offset:0
  v_mfma_f32_16x16x32_bf16 v[20:23], v[140:143], v[200:203], v[20:23]
  ds_read_b128 v[220:223], v244 offset:2048
  v_mfma_f32_16x16x32_bf16 v[24:27], v[140:143], v[204:207], v[24:27]
  ds_read_b128 v[224:227], v244 offset:4096
  v_mfma_f32_16x16x32_bf16 v[28:31], v[140:143], v[208:211], v[28:31]
  ds_read_b128 v[228:231], v244 offset:6144
  v_mfma_f32_16x16x32_bf16 v[32:35], v[144:147], v[196:199], v[32:35]
  ds_read_b64_tr_b16 v[168:169], v236 offset:49152
  v_mfma_f32_16x16x32_bf16 v[36:39], v[144:147], v[200:203], v[36:39]
  ds_read_b64_tr_b16 v[170:171], v236 offset:51200
  v_mfma_f32_16x16x32_bf16 v[40:43], v[144:147], v[204:207], v[40:43]
  ds_read_b64_tr_b16 v[172:173], v237 offset:49152
  v_mfma_f32_16x16x32_bf16 v[44:47], v[144:147], v[208:211], v[44:47]
  ds_read_b64_tr_b16 v[174:175], v237 offset:51200
  v_mfma_f32_16x16x32_bf16 v[48:51], v[148:151], v[196:199], v[48:51]
  ds_read_b64_tr_b16 v[176:177], v238 offset:49152
  v_mfma_f32_16x16x32_bf16 v[52:55], v[148:151], v[200:203], v[52:55]
  ds_read_b64_tr_b16 v[178:179], v238 offset:51200
  v_mfma_f32_16x16x32_bf16 v[56:59], v[148:151], v[204:207], v[56:59]
  ds_read_b64_tr_b16 v[180:181], v239 offset:49152
  v_mfma_f32_16x16x32_bf16 v[60:63], v[148:151], v[208:211], v[60:63]
  ds_read_b64_tr_b16 v[182:183], v239 offset:51200
  v_mfma_f32_16x16x32_bf16 v[64:67], v[152:155], v[196:199], v[64:67]
  ds_read_b64_tr_b16 v[184:185], v240 offset:49152
  v_mfma_f32_16x16x32_bf16 v[68:71], v[152:155], v[200:203], v[68:71]
  ds_read_b64_tr_b16 v[186:187], v240 offset:51200
  v_mfma_f32_16x16x32_bf16 v[72:75], v[152:155], v[204:207], v[72:75]
  ds_read_b64_tr_b16 v[188:189], v241 offset:49152
  v_mfma_f32_16x16x32_bf16 v[76:79], v[152:155], v[208:211], v[76:79]
  ds_read_b64_tr_b16 v[190:191], v241 offset:51200
  v_mfma_f32_16x16x32_bf16 v[80:83], v[156:159], v[196:199], v[80:83]
  ds_read_b64_tr_b16 v[192:193], v242 offset:49152
  v_mfma_f32_16x16x32_bf16 v[84:87], v[156:159], v[200:203], v[84:87]
  ds_read_b64_tr_b16 v[194:195], v242 offset:51200
  v_mfma_f32_16x16x32_bf16 v[88:91], v[156:159], v[204:207], v[88:91]
  s_add_u32 m0, s57, 45056
  s_add_u32 s28, s54, s53
  s_add_u32 s28, s28, 73728
  buffer_load_dwordx4 v250, s[32:35], s28 offen lds
  s_add_u32 m0, s57, 46080
  s_add_u32 s28, s54, s53
  s_add_u32 s28, s28, 82944
  buffer_load_dwordx4 v251, s[32:35], s28 offen lds
  s_add_u32 s54, s54, 128
  s_cmp_eq_u32 s54, 1152
  s_cselect_b32 s54, 0, s54
  v_mfma_f32_16x16x32_bf16 v[92:95], v[156:159], v[208:211], v[92:95]
  v_mfma_f32_16x16x32_bf16 v[96:99], v[160:163], v[196:199], v[96:99]
  v_mfma_f32_16x16x32_bf16 v[100:103], v[160:163], v[200:203], v[100:103]
  v_mfma_f32_16x16x32_bf16 v[104:107], v[160:163], v[204:207], v[104:107]
  v_mfma_f32_16x16x32_bf16 v[108:111], v[160:163], v[208:211], v[108:111]
  v_mfma_f32_16x16x32_bf16 v[112:115], v[164:167], v[196:199], v[112:115]
  v_mfma_f32_16x16x32_bf16 v[116:119], v[164:167], v[200:203], v[116:119]
  v_mfma_f32_16x16x32_bf16 v[120:123], v[164:167], v[204:207], v[120:123]
  v_mfma_f32_16x16x32_bf16 v[124:127], v[164:167], v[208:211], v[124:127]
  s_waitcnt vmcnt(4) lgkmcnt(0)
  s_barrier
  v_mfma_f32_16x16x32_bf16 v[16:19], v[168:171], v[216:219], v[16:19]
  ds_read_b128 v[196:199], v243 offset:18432
  v_mfma_f32_16x16x32_bf16 v[20:23], v[168:171], v[220:223], v[20:23]
  ds_read_b128 v[200:203], v243 offset:20480
  v_mfma_f32_16x16x32_bf16 v[24:27], v[168:171], v[224:227], v[24:27]
  ds_read_b128 v[204:207], v243 offset:22528
  v_mfma_f32_16x16x32_bf16 v[28:31], v[168:171], v[228:231], v[28:31]
  ds_read_b128 v[208:211], v243 offset:24576
  v_mfma_f32_16x16x32_bf16 v[32:35], v[172:175], v[216:219], v[32:35]
  ds_read_b64_tr_b16 v[140:141], v236 offset:0
  v_mfma_f32_16x16x32_bf16 v[36:39], v[172:175], v[220:223], v[36:39]
  ds_read_b64_tr_b16 v[142:143], v236 offset:2048
  v_mfma_f32_16x16x32_bf16 v[40:43], v[172:175], v[224:227], v[40:43]
  ds_read_b64_tr_b16 v[144:145], v237 offset:0
  v_mfma_f32_16x16x32_bf16 v[44:47], v[172:175], v[228:231], v[44:47]
  ds_read_b64_tr_b16 v[146:147], v237 offset:2048
  v_mfma_f32_16x16x32_bf16 v[48:51], v[176:179], v[216:219], v[48:51]
  ds_read_b64_tr_b16 v[148:149], v238 offset:0
  v_mfma_f32_16x16x32_bf16 v[52:55], v[176:179], v[220:223], v[52:55]
  ds_read_b64_tr_b16 v[150:151], v238 offset:2048
  v_mfma_f32_16x16x32_bf16 v[56:59], v[176:179], v[224:227], v[56:59]
  ds_read_b64_tr_b16 v[152:153], v239 offset:0
  v_mfma_f32_16x16x32_bf16 v[60:63], v[176:179], v[228:231], v[60:63]
  ds_read_b64_tr_b16 v[154:155], v239 offset:2048
  v_mfma_f32_16x16x32_bf16 v[64:67], v[180:183], v[216:219], v[64:67]
  ds_read_b64_tr_b16 v[156:157], v240 offset:0
  v_mfma_f32_16x16x32_bf16 v[68:71], v[180:183], v[220:223], v[68:71]
  ds_read_b64_tr_b16 v[158:159], v240 offset:2048
  v_mfma_f32_16x16x32_bf16 v[72:75], v[180:183], v[224:227], v[72:75]
  ds_read_b64_tr_b16 v[160:161], v241 offset:0
  v_mfma_f32_16x16x32_bf16 v[76:79], v[180:183], v[228:231], v[76:79]
  ds_read_b64_tr_b16 v[162:163], v241 offset:2048
  v_mfma_f32_16x16x32_bf16 v[80:83], v[184:187], v[216:219], v[80:83]
  ds_read_b64_tr_b16 v[164:165], v242 offset:0
  v_mfma_f32_16x16x32_bf16 v[84:87], v[184:187], v[220:223], v[84:87]
  ds_read_b64_tr_b16 v[166:167], v242 offset:2048
  v_mfma_f32_16x16x32_bf16 v[88:91], v[184:187], v[224:227], v[88:91]
  s_add_u32 m0, s57, 0
  s_add_u32 s28, s54, s53
  buffer_load_dwordx4 v250, s[32:35], s28 offen lds
  s_add_u32 m0, s57, 1024
  s_add_u32 s28, s54, s53
  s_add_u32 s28, s28, 9216
  buffer_load_dwordx4 v251, s[32:35], s28 offen lds
  v_mfma_f32_16x16x32_bf16 v[92:95], v[184:187], v[228:231], v[92:95]
  v_mfma_f32_16x16x32_bf16 v[96:99], v[188:191], v[216:219], v[96:99]
  v_mfma_f32_16x16x32_bf16 v[100:103], v[188:191], v[220:223], v[100:103]
  v_mfma_f32_16x16x32_bf16 v[104:107], v[188:191], v[224:227], v[104:107]
  v_mfma_f32_16x16x32_bf16 v[108:111], v[188:191], v[228:231], v[108:111]
  v_mfma_f32_16x16x32_bf16 v[112:115], v[192:195], v[216:219], v[112:115]
  v_mfma_f32_16x16x32_bf16 v[116:119], v[192:195], v[220:223], v[116:119]
  v_mfma_f32_16x16x32_bf16 v[120:123], v[192:195], v[224:227], v[120:123]
  v_mfma_f32_16x16x32_bf16 v[124:127], v[192:195], v[228:231], v[124:127]
  s_waitcnt vmcnt(4) lgkmcnt(0)
  s_barrier
  v_mfma_f32_16x16x32_bf16 v[16:19], v[140:143], v[196:199], v[16:19]
  ds_read_b128 v[216:219], v244 offset:18432
  v_mfma_f32_16x16x32_bf16 v[20:23], v[140:143], v[200:203], v[20:23]
  ds_read_b128 v[220:223], v244 offset:20480
  v_mfma_f32_16x16x32_bf16 v[24:27], v[140:143], v[204:207], v[24:27]
  ds_read_b128 v[224:227], v244 offset:22528
  v_mfma_f32_16x16x32_bf16 v[28:31], v[140:143], v[208:211], v[28:31]
  ds_read_b128 v[228:231], v244 offset:24576
  v_mfma_f32_16x16x32_bf16 v[32:35], v[144:147], v[196:199], v[32:35]
  ds_read_b64_tr_b16 v[168:169], v236 offset:16384
  v_mfma_f32_16x16x32_bf16 v[36:39], v[144:147], v[200:203], v[36:39]
  ds_read_b64_tr_b16 v[170:171], v236 offset:18432
  v_mfma_f32_16x16x32_bf16 v[40:43], v[144:147], v[204:207], v[40:43]
  ds_read_b64_tr_b16 v[172:173], v237 offset:16384
  v_mfma_f32_16x16x32_bf16 v[44:47], v[144:147], v[208:211], v[44:47]
  ds_read_b64_tr_b16 v[174:175], v237 offset:18432
  v_mfma_f32_16x16x32_bf16 v[48:51], v[148:151], v[196:199], v[48:51]
  ds_read_b64_tr_b16 v[176:177], v238 offset:16384
  v_mfma_f32_16x16x32_bf16 v[52:55], v[148:151], v[200:203], v[52:55]
  ds_read_b64_tr_b16 v[178:179], v238 offset:18432
  v_mfma_f32_16x16x32_bf16 v[56:59], v[148:151], v[204:207], v[56:59]
  ds_read_b64_tr_b16 v[180:181], v239 offset:16384
  v_mfma_f32_16x16x32_bf16 v[60:63], v[148:151], v[208:211], v[60:63]
  ds_read_b64_tr_b16 v[182:183], v239 offset:18432
  v_mfma_f32_16x16x32_bf16 v[64:67], v[152:155], v[196:199], v[64:67]
  ds_read_b64_tr_b16 v[184:185], v240 offset:16384
  v_mfma_f32_16x16x32_bf16 v[68:71], v[152:155], v[200:203], v[68:71]
  ds_read_b64_tr_b16 v[186:187], v240 offset:18432
  v_mfma_f32_16x16x32_bf16 v[72:75], v[152:155], v[204:207], v[72:75]
  ds_read_b64_tr_b16 v[188:189], v241 offset:16384
  v_mfma_f32_16x16x32_bf16 v[76:79], v[152:155], v[208:211], v[76:79]
  ds_read_b64_tr_b16 v[190:191], v241 offset:18432
  v_mfma_f32_16x16x32_bf16 v[80:83], v[156:159], v[196:199], v[80:83]
  ds_read_b64_tr_b16 v[192:193], v242 offset:16384
  v_mfma_f32_16x16x32_bf16 v[84:87], v[156:159], v[200:203], v[84:87]
  ds_read_b64_tr_b16 v[194:195], v242 offset:18432
  v_mfma_f32_16x16x32_bf16 v[88:91], v[156:159], v[204:207], v[88:91]
  s_add_u32 m0, s57, 8192
  s_add_u32 s28, s54, s53
  s_add_u32 s28, s28, 73728
  buffer_load_dwordx4 v250, s[32:35], s28 offen lds
  s_add_u32 m0, s57, 9216
  s_add_u32 s28, s54, s53
  s_add_u32 s28, s28, 82944
  buffer_load_dwordx4 v251, s[32:35], s28 offen lds
  s_add_u32 s54, s54, 128
  s_cmp_eq_u32 s54, 1152
  s_cselect_b32 s54, 0, s54
  v_mfma_f32_16x16x32_bf16 v[92:95], v[156:159], v[208:211], v[92:95]
  v_mfma_f32_16x16x32_bf16 v[96:99], v[160:163], v[196:199], v[96:99]
  v_mfma_f32_16x16x32_bf16 v[100:103], v[160:163], v[200:203], v[100:103]
  v_mfma_f32_16x16x32_bf16 v[104:107], v[160:163], v[204:207], v[104:107]
  v_mfma_f32_16x16x32_bf16 v[108:111], v[160:163], v[208:211], v[108:111]
  v_mfma_f32_16x16x32_bf16 v[112:115], v[164:167], v[196:199], v[112:115]
  v_mfma_f32_16x16x32_bf16 v[116:119], v[164:167], v[200:203], v[116:119]
  v_mfma_f32_16x16x32_bf16 v[120:123], v[164:167], v[204:207], v[120:123]
  v_mfma_f32_16x16x32_bf16 v[124:127], v[164:167], v[208:211], v[124:127]
  s_waitcnt vmcnt(4) lgkmcnt(0)
  s_barrier
  v_mfma_f32_16x16x32_bf16 v[16:19], v[168:171], v[216:219], v[16:19]
  ds_read_b128 v[196:199], v243 offset:36864
  v_mfma_f32_16x16x32_bf16 v[20:23], v[168:171], v[220:223], v[20:23]
  ds_read_b128 v[200:203], v243 offset:38912
  v_mfma_f32_16x16x32_bf16 v[24:27], v[168:171], v[224:227], v[24:27]
  ds_read_b128 v[204:207], v243 offset:40960
  v_mfma_f32_16x16x32_bf16 v[28:31], v[168:171], v[228:231], v[28:31]
  ds_read_b128 v[208:211], v243 offset:43008
  v_mfma_f32_16x16x32_bf16 v[32:35], v[172:175], v[216:219], v[32:35]
  ds_read_b64_tr_b16 v[140:141], v236 offset:32768
  v_mfma_f32_16x16x32_bf16 v[36:39], v[172:175], v[220:223], v[36:39]
  ds_read_b64_tr_b16 v[142:143], v236 offset:34816
  v_mfma_f32_16x16x32_bf16 v[40:43], v[172:175], v[224:227], v[40:43]
  ds_read_b64_tr_b16 v[144:145], v237 offset:32768
  v_mfma_f32_16x16x32_bf16 v[44:47], v[172:175], v[228:231], v[44:47]
  ds_read_b64_tr_b16 v[146:147], v237 offset:34816
  v_mfma_f32_16x16x32_bf16 v[48:51], v[176:179], v[216:219], v[48:51]
  ds_read_b64_tr_b16 v[148:149], v238 offset:32768
  v_mfma_f32_16x16x32_bf16 v[52:55], v[176:179], v[220:223], v[52:55]
  ds_read_b64_tr_b16 v[150:151], v238 offset:34816
  v_mfma_f32_16x16x32_bf16 v[56:59], v[176:179], v[224:227], v[56:59]
  ds_read_b64_tr_b16 v[152:153], v239 offset:32768
  v_mfma_f32_16x16x32_bf16 v[60:63], v[176:179], v[228:231], v[60:63]
  ds_read_b64_tr_b16 v[154:155], v239 offset:34816
  v_mfma_f32_16x16x32_bf16 v[64:67], v[180:183], v[216:219], v[64:67]
  ds_read_b64_tr_b16 v[156:157], v240 offset:32768
  v_mfma_f32_16x16x32_bf16 v[68:71], v[180:183], v[220:223], v[68:71]
  ds_read_b64_tr_b16 v[158:159], v240 offset:34816
  v_mfma_f32_16x16x32_bf16 v[72:75], v[180:183], v[224:227], v[72:75]
  ds_read_b64_tr_b16 v[160:161], v241 offset:32768
  v_mfma_f32_16x16x32_bf16 v[76:79], v[180:183], v[228:231], v[76:79]
  ds_read_b64_tr_b16 v[162:163], v241 offset:34816
  v_mfma_f32_16x16x32_bf16 v[80:83], v[184:187], v[216:219], v[80:83]
  ds_read_b64_tr_b16 v[164:165], v242 offset:32768
  v_mfma_f32_16x16x32_bf16 v[84:87], v[184:187], v[220:223], v[84:87]
  ds_read_b64_tr_b16 v[166:167], v242 offset:34816
  v_mfma_f32_16x16x32_bf16 v[88:91], v[184:187], v[224:227], v[88:91]
  s_add_u32 m0, s57, 18432
  s_add_u32 s28, s54, s53
  buffer_load_dwordx4 v250, s[32:35], s28 offen lds
  s_add_u32 m0, s57, 19456
  s_add_u32 s28, s54, s53
  s_add_u32 s28, s28, 9216
  buffer_load_dwordx4 v251, s[32:35], s28 offen lds
  v_mfma_f32_16x16x32_bf16 v[92:95], v[184:187], v[228:231], v[92:95]
  v_mfma_f32_16x16x32_bf16 v[96:99], v[188:191], v[216:219], v[96:99]
  v_mfma_f32_16x16x32_bf16 v[100:103], v[188:191], v[220:223], v[100:103]
  v_mfma_f32_16x16x32_bf16 v[104:107], v[188:191], v[224:227], v[104:107]
  v_mfma_f32_16x16x32_bf16 v[108:111], v[188:191], v[228:231], v[108:111]
  v_mfma_f32_16x16x32_bf16 v[112:115], v[192:195], v[216:219], v[112:115]
  v_mfma_f32_16x16x32_bf16 v[116:119], v[192:195], v[220:223], v[116:119]
  v_mfma_f32_16x16x32_bf16 v[120:123], v[192:195], v[224:227], v[120:123]
  v_mfma_f32_16x16x32_bf16 v[124:127], v[192:195], v[228:231], v[124:127]
  s_waitcnt vmcnt(4) lgkmcnt(0)
  s_barrier
  v_mfma_f32_16x16x32_bf16 v[16:19], v[140:143], v[196:199], v[16:19]
  ds_read_b128 v[216:219], v244 offset:36864
  v_mfma_f32_16x16x32_bf16 v[20:23], v[140:143], v[200:203], v[20:23]
  ds_read_b128 v[220:223], v244 offset:38912
  v_mfma_f32_16x16x32_bf16 v[24:27], v[140:143], v[204:207], v[24:27]
  ds_read_b128 v[224:227], v244 offset:40960
  v_mfma_f32_16x16x32_bf16 v[28:31], v[140:143], v[208:211], v[28:31]
  ds_read_b128 v[228:231], v244 offset:43008
  v_mfma_f32_16x16x32_bf16 v[32:35], v[144:147], v[196:199], v[32:35]
  ds_read_b64_tr_b16 v[168:169], v236 offset:49152
  v_mfma_f32_16x16x32_bf16 v[36:39], v[144:147], v[200:203], v[36:39]
  ds_read_b64_tr_b16 v[170:171], v236 offset:51200
  v_mfma_f32_16x16x32_bf16 v[40:43], v[144:147], v[204:207], v[40:43]
  ds_read_b64_tr_b16 v[172:173], v237 offset:49152
  v_mfma_f32_16x16x32_bf16 v[44:47], v[144:147], v[208:211], v[44:47]
  ds_read_b64_tr_b16 v[174:175], v237 offset:51200
  v_mfma_f32_16x16x32_bf16 v[48:51], v[148:151], v[196:199], v[48:51]
  ds_read_b64_tr_b16 v[176:177], v238 offset:49152
  v_mfma_f32_16x16x32_bf16 v[52:55], v[148:151], v[200:203], v[52:55]
  ds_read_b64_tr_b16 v[178:179], v238 offset:51200
  v_mfma_f32_16x16x32_bf16 v[56:59], v[148:151], v[204:207], v[56:59]
  ds_read_b64_tr_b16 v[180:181], v239 offset:49152
  v_mfma_f32_16x16x32_bf16 v[60:63], v[148:151], v[208:211], v[60:63]
  ds_read_b64_tr_b16 v[182:183], v239 offset:51200
  v_mfma_f32_16x16x32_bf16 v[64:67], v[152:155], v[196:199], v[64:67]
  ds_read_b64_tr_b16 v[184:185], v240 offset:49152
  v_mfma_f32_16x16x32_bf16 v[68:71], v[152:155], v[200:203], v[68:71]
  ds_read_b64_tr_b16 v[186:187], v240 offset:51200
  v_mfma_f32_16x16x32_bf16 v[72:75], v[152:155], v[204:207], v[72:75]
  ds_read_b64_tr_b16 v[188:189], v241 offset:49152
  v_mfma_f32_16x16x32_bf16 v[76:79], v[152:155], v[208:211], v[76:79]
  ds_read_b64_tr_b16 v[190:191], v241 offset:51200
  v_mfma_f32_16x16x32_bf16 v[80:83], v[156:159], v[196:199], v[80:83]
  ds_read_b64_tr_b16 v[192:193], v242 offset:49152
  v_mfma_f32_16x16x32_bf16 v[84:87], v[156:159], v[200:203], v[84:87]
  ds_read_b64_tr_b16 v[194:195], v242 offset:51200
  v_mfma_f32_16x16x32_bf16 v[88:91], v[156:159], v[204:207], v[88:91]
  s_add_u32 m0, s57, 26624
  s_add_u32 s28, s54, s53
  s_add_u32 s28, s28, 73728
  buffer_load_dwordx4 v250, s[32:35], s28 offen lds
  s_add_u32 m0, s57, 27648
  s_add_u32 s28, s54, s53
  s_add_u32 s28, s28, 82944
  buffer_load_dwordx4 v251, s[32:35], s28 offen lds
  s_add_u32 s54, s54, 128
  s_cmp_eq_u32 s54, 1152
  s_cselect_b32 s54, 0, s54
  v_mfma_f32_16x16x32_bf16 v[92:95], v[156:159], v[208:211], v[92:95]
  v_mfma_f32_16x16x32_bf16 v[96:99], v[160:163], v[196:199], v[96:99]
  v_mfma_f32_16x16x32_bf16 v[100:103], v[160:163], v[200:203], v[100:103]
  v_mfma_f32_16x16x32_bf16 v[104:107], v[160:163], v[204:207], v[104:107]
  v_mfma_f32_16x16x32_bf16 v[108:111], v[160:163], v[208:211], v[108:111]
  v_mfma_f32_16x16x32_bf16 v[112:115], v[164:167], v[196:199], v[112:115]
  v_mfma_f32_16x16x32_bf16 v[116:119], v[164:167], v[200:203], v[116:119]
  v_mfma_f32_16x16x32_bf16 v[120:123], v[164:167], v[204:207], v[120:123]
  v_mfma_f32_16x16x32_bf16 v[124:127], v[164:167], v[208:211], v[124:127]
  s_waitcnt vmcnt(4) lgkmcnt(0)
  s_barrier
  v_mfma_f32_16x16x32_bf16 v[16:19], v[168:171], v[216:219], v[16:19]
  ds_read_b128 v[196:199], v243 offset:0
  v_mfma_f32_16x16x32_bf16 v[20:23], v[168:171], v[220:223], v[20:23]
  ds_read_b128 v[200:203], v243 offset:2048
  v_mfma_f32_16x16x32_bf16 v[24:27], v[168:171], v[224:227], v[24:27]
  ds_read_b128 v[204:207], v243 offset:4096
  v_mfma_f32_16x16x32_bf16 v[28:31], v[168:171], v[228:231], v[28:31]
  ds_read_b128 v[208:211], v243 offset:6144
  v_mfma_f32_16x16x32_bf16 v[32:35], v[172:175], v[216:219], v[32:35]
  ds_read_b64_tr_b16 v[140:141], v236 offset:0
  v_mfma_f32_16x16x32_bf16 v[36:39], v[172:175], v[220:223], v[36:39]
  ds_read_b64_tr_b16 v[142:143], v236 offset:2048
  v_mfma_f32_16x16x32_bf16 v[40:43], v[172:175], v[224:227], v[40:43]
  ds_read_b64_tr_b16 v[144:145], v237 offset:0
  v_mfma_f32_16x16x32_bf16 v[44:47], v[172:175], v[228:231], v[44:47]
  ds_read_b64_tr_b16 v[146:147], v237 offset:2048
  v_mfma_f32_16x16x32_bf16 v[48:51], v[176:179], v[216:219], v[48:51]
  ds_read_b64_tr_b16 v[148:149], v238 offset:0
  v_mfma_f32_16x16x32_bf16 v[52:55], v[176:179], v[220:223], v[52:55]
  ds_read_b64_tr_b16 v[150:151], v238 offset:2048
  v_mfma_f32_16x16x32_bf16 v[56:59], v[176:179], v[224:227], v[56:59]
  ds_read_b64_tr_b16 v[152:153], v239 offset:0
  v_mfma_f32_16x16x32_bf16 v[60:63], v[176:179], v[228:231], v[60:63]
  ds_read_b64_tr_b16 v[154:155], v239 offset:2048
  v_mfma_f32_16x16x32_bf16 v[64:67], v[180:183], v[216:219], v[64:67]
  ds_read_b64_tr_b16 v[156:157], v240 offset:0
  v_mfma_f32_16x16x32_bf16 v[68:71], v[180:183], v[220:223], v[68:71]
  ds_read_b64_tr_b16 v[158:159], v240 offset:2048
  v_mfma_f32_16x16x32_bf16 v[72:75], v[180:183], v[224:227], v[72:75]
  ds_read_b64_tr_b16 v[160:161], v241 offset:0
  v_mfma_f32_16x16x32_bf16 v[76:79], v[180:183], v[228:231], v[76:79]
  ds_read_b64_tr_b16 v[162:163], v241 offset:2048
  v_mfma_f32_16x16x32_bf16 v[80:83], v[184:187], v[216:219], v[80:83]
  ds_read_b64_tr_b16 v[164:165], v242 offset:0
  v_mfma_f32_16x16x32_bf16 v[84:87], v[184:187], v[220:223], v[84:87]
  ds_read_b64_tr_b16 v[166:167], v242 offset:2048
  v_mfma_f32_16x16x32_bf16 v[88:91], v[184:187], v[224:227], v[88:91]
  s_add_u32 m0, s57, 36864
  s_add_u32 s28, s54, s53
  buffer_load_dwordx4 v250, s[32:35], s28 offen lds
  s_add_u32 m0, s57, 37888
  s_add_u32 s28, s54, s53
  s_add_u32 s28, s28, 9216
  buffer_load_dwordx4 v251, s[32:35], s28 offen lds
  v_mfma_f32_16x16x32_bf16 v[92:95], v[184:187], v[228:231], v[92:95]
  v_mfma_f32_16x16x32_bf16 v[96:99], v[188:191], v[216:219], v[96:99]
  v_mfma_f32_16x16x32_bf16 v[100:103], v[188:191], v[220:223], v[100:103]
  v_mfma_f32_16x16x32_bf16 v[104:107], v[188:191], v[224:227], v[104:107]
  v_mfma_f32_16x16x32_bf16 v[108:111], v[188:191], v[228:231], v[108:111]
  v_mfma_f32_16x16x32_bf16 v[112:115], v[192:195], v[216:219], v[112:115]
  v_mfma_f32_16x16x32_bf16 v[116:119], v[192:195], v[220:223], v[116:119]
  v_mfma_f32_16x16x32_bf16 v[120:123], v[192:195], v[224:227], v[120:123]
  v_mfma_f32_16x16x32_bf16 v[124:127], v[192:195], v[228:231], v[124:127]
  s_waitcnt vmcnt(4) lgkmcnt(0)
  s_barrier
  v_mfma_f32_16x16x32_bf16 v[16:19], v[140:143], v[196:199], v[16:19]
  ds_read_b128 v[216:219], v244 offset:0
  v_mfma_f32_16x16x32_bf16 v[20:23], v[140:143], v[200:203], v[20:23]
  ds_read_b128 v[220:223], v244 offset:2048
  v_mfma_f32_16x16x32_bf16 v[24:27], v[140:143], v[204:207], v[24:27]
  ds_read_b128 v[224:227], v244 offset:4096
  v_mfma_f32_16x16x32_bf16 v[28:31], v[140:143], v[208:211], v[28:31]
  ds_read_b128 v[228:231], v244 offset:6144
  v_mfma_f32_16x16x32_bf16 v[32:35], v[144:147], v[196:199], v[32:35]
  ds_read_b64_tr_b16 v[168:169], v236 offset:16384
  v_mfma_f32_16x16x32_bf16 v[36:39], v[144:147], v[200:203], v[36:39]
  ds_read_b64_tr_b16 v[170:171], v236 offset:18432
  v_mfma_f32_16x16x32_bf16 v[40:43], v[144:147], v[204:207], v[40:43]
  ds_read_b64_tr_b16 v[172:173], v237 offset:16384
  v_mfma_f32_16x16x32_bf16 v[44:47], v[144:147], v[208:211], v[44:47]
  ds_read_b64_tr_b16 v[174:175], v237 offset:18432
  v_mfma_f32_16x16x32_bf16 v[48:51], v[148:151], v[196:199], v[48:51]
  ds_read_b64_tr_b16 v[176:177], v238 offset:16384
  v_mfma_f32_16x16x32_bf16 v[52:55], v[148:151], v[200:203], v[52:55]
  ds_read_b64_tr_b16 v[178:179], v238 offset:18432
  v_mfma_f32_16x16x32_bf16 v[56:59], v[148:151], v[204:207], v[56:59]
  ds_read_b64_tr_b16 v[180:181], v239 offset:16384
  v_mfma_f32_16x16x32_bf16 v[60:63], v[148:151], v[208:211], v[60:63]
  ds_read_b64_tr_b16 v[182:183], v239 offset:18432
  v_mfma_f32_16x16x32_bf16 v[64:67], v[152:155], v[196:199], v[64:67]
  ds_read_b64_tr_b16 v[184:185], v240 offset:16384
  v_mfma_f32_16x16x32_bf16 v[68:71], v[152:155], v[200:203], v[68:71]
  ds_read_b64_tr_b16 v[186:187], v240 offset:18432
  v_mfma_f32_16x16x32_bf16 v[72:75], v[152:155], v[204:207], v[72:75]
  ds_read_b64_tr_b16 v[188:189], v241 offset:16384
  v_mfma_f32_16x16x32_bf16 v[76:79], v[152:155], v[208:211], v[76:79]
  ds_read_b64_tr_b16 v[190:191], v241 offset:18432
  v_mfma_f32_16x16x32_bf16 v[80:83], v[156:159], v[196:199], v[80:83]
  ds_read_b64_tr_b16 v[192:193], v242 offset:16384
  v_mfma_f32_16x16x32_bf16 v[84:87], v[156:159], v[200:203], v[84:87]
  ds_read_b64_tr_b16 v[194:195], v242 offset:18432
  v_mfma_f32_16x16x32_bf16 v[88:91], v[156:159], v[204:207], v[88:91]
  s_add_u32 m0, s57, 45056
  s_add_u32 s28, s54, s53
  s_add_u32 s28, s28, 73728
  buffer_load_dwordx4 v250, s[32:35], s28 offen lds
  s_add_u32 m0, s57, 46080
  s_add_u32 s28, s54, s53
  s_add_u32 s28, s28, 82944
  buffer_load_dwordx4 v251, s[32:35], s28 offen lds
  s_add_u32 s54, s54, 128
  s_cmp_eq_u32 s54, 1152
  s_cselect_b32 s54, 0, s54
  v_mfma_f32_16x16x32_bf16 v[92:95], v[156:159], v[208:211], v[92:95]
  v_mfma_f32_16x16x32_bf16 v[96:99], v[160:163], v[196:199], v[96:99]
  v_mfma_f32_16x16x32_bf16 v[100:103], v[160:163], v[200:203], v[100:103]
  v_mfma_f32_16x16x32_bf16 v[104:107], v[160:163], v[204:207], v[104:107]
  v_mfma_f32_16x16x32_bf16 v[108:111], v[160:163], v[208:211], v[108:111]
  v_mfma_f32_16x16x32_bf16 v[112:115], v[164:167], v[196:199], v[112:115]
  v_mfma_f32_16x16x32_bf16 v[116:119], v[164:167], v[200:203], v[116:119]
  v_mfma_f32_16x16x32_bf16 v[120:123], v[164:167], v[204:207], v[120:123]
  v_mfma_f32_16x16x32_bf16 v[124:127], v[164:167], v[208:211], v[124:127]
  s_waitcnt vmcnt(4) lgkmcnt(0)
  s_barrier
  v_mfma_f32_16x16x32_bf16 v[16:19], v[168:171], v[216:219], v[16:19]
  ds_read_b128 v[196:199], v243 offset:18432
  v_mfma_f32_16x16x32_bf16 v[20:23], v[168:171], v[220:223], v[20:23]
  ds_read_b128 v[200:203], v243 offset:20480
  v_mfma_f32_16x16x32_bf16 v[24:27], v[168:171], v[224:227], v[24:27]
  ds_read_b128 v[204:207], v243 offset:22528
  v_mfma_f32_16x16x32_bf16 v[28:31], v[168:171], v[228:231], v[28:31]
  ds_read_b128 v[208:211], v243 offset:24576
  v_mfma_f32_16x16x32_bf16 v[32:35], v[172:175], v[216:219], v[32:35]
  ds_read_b64_tr_b16 v[140:141], v236 offset:32768
  v_mfma_f32_16x16x32_bf16 v[36:39], v[172:175], v[220:223], v[36:39]
  ds_read_b64_tr_b16 v[142:143], v236 offset:34816
  v_mfma_f32_16x16x32_bf16 v[40:43], v[172:175], v[224:227], v[40:43]
  ds_read_b64_tr_b16 v[144:145], v237 offset:32768
  v_mfma_f32_16x16x32_bf16 v[44:47], v[172:175], v[228:231], v[44:47]
  ds_read_b64_tr_b16 v[146:147], v237 offset:34816
  v_mfma_f32_16x16x32_bf16 v[48:51], v[176:179], v[216:219], v[48:51]
  ds_read_b64_tr_b16 v[148:149], v238 offset:32768
  v_mfma_f32_16x16x32_bf16 v[52:55], v[176:179], v[220:223], v[52:55]
  ds_read_b64_tr_b16 v[150:151], v238 offset:34816
  v_mfma_f32_16x16x32_bf16 v[56:59], v[176:179], v[224:227], v[56:59]
  ds_read_b64_tr_b16 v[152:153], v239 offset:32768
  v_mfma_f32_16x16x32_bf16 v[60:63], v[176:179], v[228:231], v[60:63]
  ds_read_b64_tr_b16 v[154:155], v239 offset:34816
  v_mfma_f32_16x16x32_bf16 v[64:67], v[180:183], v[216:219], v[64:67]
  ds_read_b64_tr_b16 v[156:157], v240 offset:32768
  v_mfma_f32_16x16x32_bf16 v[68:71], v[180:183], v[220:223], v[68:71]
  ds_read_b64_tr_b16 v[158:159], v240 offset:34816
  v_mfma_f32_16x16x32_bf16 v[72:75], v[180:183], v[224:227], v[72:75]
  ds_read_b64_tr_b16 v[160:161], v241 offset:32768
  v_mfma_f32_16x16x32_bf16 v[76:79], v[180:183], v[228:231], v[76:79]
  ds_read_b64_tr_b16 v[162:163], v241 offset:34816
  v_mfma_f32_16x16x32_bf16 v[80:83], v[184:187], v[216:219], v[80:83]
  ds_read_b64_tr_b16 v[164:165], v242 offset:32768
  v_mfma_f32_16x16x32_bf16 v[84:87], v[184:187], v[220:223], v[84:87]
  ds_read_b64_tr_b16 v[166:167], v242 offset:34816
  v_mfma_f32_16x16x32_bf16 v[88:91], v[184:187], v[224:227], v[88:91]
  v_mfma_f32_16x16x32_bf16 v[92:95], v[184:187], v[228:231], v[92:95]
  v_mfma_f32_16x16x32_bf16 v[96:99], v[188:191], v[216:219], v[96:99]
  v_mfma_f32_16x16x32_bf16 v[100:103], v[188:191], v[220:223], v[100:103]
  v_mfma_f32_16x16x32_bf16 v[104:107], v[188:191], v[224:227], v[104:107]
  v_mfma_f32_16x16x32_bf16 v[108:111], v[188:191], v[228:231], v[108:111]
  v_mfma_f32_16x16x32_bf16 v[112:115], v[192:195], v[216:219], v[112:115]
  v_mfma_f32_16x16x32_bf16 v[116:119], v[192:195], v[220:223], v[116:119]
  v_mfma_f32_16x16x32_bf16 v[120:123], v[192:195], v[224:227], v[120:123]
  v_mfma_f32_16x16x32_bf16 v[124:127], v[192:195], v[228:231], v[124:127]
  s_waitcnt vmcnt(2) lgkmcnt(0)
  s_barrier
  v_mfma_f32_16x16x32_bf16 v[16:19], v[140:143], v[196:199], v[16:19]
  ds_read_b128 v[216:219], v244 offset:18432
  v_mfma_f32_16x16x32_bf16 v[20:23], v[140:143], v[200:203], v[20:23]
  ds_read_b128 v[220:223], v244 offset:20480
  v_mfma_f32_16x16x32_bf16 v[24:27], v[140:143], v[204:207], v[24:27]
  ds_read_b128 v[224:227], v244 offset:22528
  v_mfma_f32_16x16x32_bf16 v[28:31], v[140:143], v[208:211], v[28:31]
  ds_read_b128 v[228:231], v244 offset:24576
  v_mfma_f32_16x16x32_bf16 v[32:35], v[144:147], v[196:199], v[32:35]
  ds_read_b64_tr_b16 v[168:169], v236 offset:49152
  v_mfma_f32_16x16x32_bf16 v[36:39], v[144:147], v[200:203], v[36:39]
  ds_read_b64_tr_b16 v[170:171], v236 offset:51200
  v_mfma_f32_16x16x32_bf16 v[40:43], v[144:147], v[204:207], v[40:43]
  ds_read_b64_tr_b16 v[172:173], v237 offset:49152
  v_mfma_f32_16x16x32_bf16 v[44:47], v[144:147], v[208:211], v[44:47]
  ds_read_b64_tr_b16 v[174:175], v237 offset:51200
  v_mfma_f32_16x16x32_bf16 v[48:51], v[148:151], v[196:199], v[48:51]
  ds_read_b64_tr_b16 v[176:177], v238 offset:49152
  v_mfma_f32_16x16x32_bf16 v[52:55], v[148:151], v[200:203], v[52:55]
  ds_read_b64_tr_b16 v[178:179], v238 offset:51200
  v_mfma_f32_16x16x32_bf16 v[56:59], v[148:151], v[204:207], v[56:59]
  ds_read_b64_tr_b16 v[180:181], v239 offset:49152
  v_mfma_f32_16x16x32_bf16 v[60:63], v[148:151], v[208:211], v[60:63]
  ds_read_b64_tr_b16 v[182:183], v239 offset:51200
  v_mfma_f32_16x16x32_bf16 v[64:67], v[152:155], v[196:199], v[64:67]
  ds_read_b64_tr_b16 v[184:185], v240 offset:49152
  v_mfma_f32_16x16x32_bf16 v[68:71], v[152:155], v[200:203], v[68:71]
  ds_read_b64_tr_b16 v[186:187], v240 offset:51200
  v_mfma_f32_16x16x32_bf16 v[72:75], v[152:155], v[204:207], v[72:75]
  ds_read_b64_tr_b16 v[188:189], v241 offset:49152
  v_mfma_f32_16x16x32_bf16 v[76:79], v[152:155], v[208:211], v[76:79]
  ds_read_b64_tr_b16 v[190:191], v241 offset:51200
  v_mfma_f32_16x16x32_bf16 v[80:83], v[156:159], v[196:199], v[80:83]
  ds_read_b64_tr_b16 v[192:193], v242 offset:49152
  v_mfma_f32_16x16x32_bf16 v[84:87], v[156:159], v[200:203], v[84:87]
  ds_read_b64_tr_b16 v[194:195], v242 offset:51200
  v_mfma_f32_16x16x32_bf16 v[88:91], v[156:159], v[204:207], v[88:91]
  v_mfma_f32_16x16x32_bf16 v[92:95], v[156:159], v[208:211], v[92:95]
  v_mfma_f32_16x16x32_bf16 v[96:99], v[160:163], v[196:199], v[96:99]
  v_mfma_f32_16x16x32_bf16 v[100:103], v[160:163], v[200:203], v[100:103]
  v_mfma_f32_16x16x32_bf16 v[104:107], v[160:163], v[204:207], v[104:107]
  v_mfma_f32_16x16x32_bf16 v[108:111], v[160:163], v[208:211], v[108:111]
  v_mfma_f32_16x16x32_bf16 v[112:115], v[164:167], v[196:199], v[112:115]
  v_mfma_f32_16x16x32_bf16 v[116:119], v[164:167], v[200:203], v[116:119]
  v_mfma_f32_16x16x32_bf16 v[120:123], v[164:167], v[204:207], v[120:123]
  v_mfma_f32_16x16x32_bf16 v[124:127], v[164:167], v[208:211], v[124:127]
  s_waitcnt vmcnt(0) lgkmcnt(0)
  s_barrier
  v_mfma_f32_16x16x32_bf16 v[16:19], v[168:171], v[216:219], v[16:19]
  ds_read_b128 v[196:199], v243 offset:36864
  v_mfma_f32_16x16x32_bf16 v[20:23], v[168:171], v[220:223], v[20:23]
  ds_read_b128 v[200:203], v243 offset:38912
  v_mfma_f32_16x16x32_bf16 v[24:27], v[168:171], v[224:227], v[24:27]
  ds_read_b128 v[204:207], v243 offset:40960
  v_mfma_f32_16x16x32_bf16 v[28:31], v[168:171], v[228:231], v[28:31]
  ds_read_b128 v[208:211], v243 offset:43008
  v_mfma_f32_16x16x32_bf16 v[32:35], v[172:175], v[216:219], v[32:35]
  ds_read_b64_tr_b16 v[140:141], v236 offset:0
  v_mfma_f32_16x16x32_bf16 v[36:39], v[172:175], v[220:223], v[36:39]
  ds_read_b64_tr_b16 v[142:143], v236 offset:2048
  v_mfma_f32_16x16x32_bf16 v[40:43], v[172:175], v[224:227], v[40:43]
  ds_read_b64_tr_b16 v[144:145], v237 offset:0
  v_mfma_f32_16x16x32_bf16 v[44:47], v[172:175], v[228:231], v[44:47]
  ds_read_b64_tr_b16 v[146:147], v237 offset:2048
  v_mfma_f32_16x16x32_bf16 v[48:51], v[176:179], v[216:219], v[48:51]
  ds_read_b64_tr_b16 v[148:149], v238 offset:0
  v_mfma_f32_16x16x32_bf16 v[52:55], v[176:179], v[220:223], v[52:55]
  ds_read_b64_tr_b16 v[150:151], v238 offset:2048
  v_mfma_f32_16x16x32_bf16 v[56:59], v[176:179], v[224:227], v[56:59]
  ds_read_b64_tr_b16 v[152:153], v239 offset:0
  v_mfma_f32_16x16x32_bf16 v[60:63], v[176:179], v[228:231], v[60:63]
  ds_read_b64_tr_b16 v[154:155], v239 offset:2048
  v_mfma_f32_16x16x32_bf16 v[64:67], v[180:183], v[216:219], v[64:67]
  ds_read_b64_tr_b16 v[156:157], v240 offset:0
  v_mfma_f32_16x16x32_bf16 v[68:71], v[180:183], v[220:223], v[68:71]
  ds_read_b64_tr_b16 v[158:159], v240 offset:2048
  v_mfma_f32_16x16x32_bf16 v[72:75], v[180:183], v[224:227], v[72:75]
  ds_read_b64_tr_b16 v[160:161], v241 offset:0
  v_mfma_f32_16x16x32_bf16 v[76:79], v[180:183], v[228:231], v[76:79]
  ds_read_b64_tr_b16 v[162:163], v241 offset:2048
  v_mfma_f32_16x16x32_bf16 v[80:83], v[184:187], v[216:219], v[80:83]
  ds_read_b64_tr_b16 v[164:165], v242 offset:0
  v_mfma_f32_16x16x32_bf16 v[84:87], v[184:187], v[220:223], v[84:87]
  ds_read_b64_tr_b16 v[166:167], v242 offset:2048
  v_mfma_f32_16x16x32_bf16 v[88:91], v[184:187], v[224:227], v[88:91]
  v_mfma_f32_16x16x32_bf16 v[92:95], v[184:187], v[228:231], v[92:95]
  v_mfma_f32_16x16x32_bf16 v[96:99], v[188:191], v[216:219], v[96:99]
  v_mfma_f32_16x16x32_bf16 v[100:103], v[188:191], v[220:223], v[100:103]
  v_mfma_f32_16x16x32_bf16 v[104:107], v[188:191], v[224:227], v[104:107]
  v_mfma_f32_16x16x32_bf16 v[108:111], v[188:191], v[228:231], v[108:111]
  v_mfma_f32_16x16x32_bf16 v[112:115], v[192:195], v[216:219], v[112:115]
  v_mfma_f32_16x16x32_bf16 v[116:119], v[192:195], v[220:223], v[116:119]
  v_mfma_f32_16x16x32_bf16 v[120:123], v[192:195], v[224:227], v[120:123]
  v_mfma_f32_16x16x32_bf16 v[124:127], v[192:195], v[228:231], v[124:127]
  s_waitcnt vmcnt(0) lgkmcnt(0)
  s_barrier
  v_mfma_f32_16x16x32_bf16 v[16:19], v[140:143], v[196:199], v[16:19]
  ds_read_b128 v[216:219], v244 offset:36864
  v_mfma_f32_16x16x32_bf16 v[20:23], v[140:143], v[200:203], v[20:23]
  ds_read_b128 v[220:223], v244 offset:38912
  v_mfma_f32_16x16x32_bf16 v[24:27], v[140:143], v[204:207], v[24:27]
  ds_read_b128 v[224:227], v244 offset:40960
  v_mfma_f32_16x16x32_bf16 v[28:31], v[140:143], v[208:211], v[28:31]
  ds_read_b128 v[228:231], v244 offset:43008
  v_mfma_f32_16x16x32_bf16 v[32:35], v[144:147], v[196:199], v[32:35]
  ds_read_b64_tr_b16 v[168:169], v236 offset:16384
  v_mfma_f32_16x16x32_bf16 v[36:39], v[144:147], v[200:203], v[36:39]
  ds_read_b64_tr_b16 v[170:171], v236 offset:18432
  v_mfma_f32_16x16x32_bf16 v[40:43], v[144:147], v[204:207], v[40:43]
  ds_read_b64_tr_b16 v[172:173], v237 offset:16384
  v_mfma_f32_16x16x32_bf16 v[44:47], v[144:147], v[208:211], v[44:47]
  ds_read_b64_tr_b16 v[174:175], v237 offset:18432
  v_mfma_f32_16x16x32_bf16 v[48:51], v[148:151], v[196:199], v[48:51]
  ds_read_b64_tr_b16 v[176:177], v238 offset:16384
  v_mfma_f32_16x16x32_bf16 v[52:55], v[148:151], v[200:203], v[52:55]
  ds_read_b64_tr_b16 v[178:179], v238 offset:18432
  v_mfma_f32_16x16x32_bf16 v[56:59], v[148:151], v[204:207], v[56:59]
  ds_read_b64_tr_b16 v[180:181], v239 offset:16384
  v_mfma_f32_16x16x32_bf16 v[60:63], v[148:151], v[208:211], v[60:63]
  ds_read_b64_tr_b16 v[182:183], v239 offset:18432
  v_mfma_f32_16x16x32_bf16 v[64:67], v[152:155], v[196:199], v[64:67]
  ds_read_b64_tr_b16 v[184:185], v240 offset:16384
  v_mfma_f32_16x16x32_bf16 v[68:71], v[152:155], v[200:203], v[68:71]
  ds_read_b64_tr_b16 v[186:187], v240 offset:18432
  v_mfma_f32_16x16x32_bf16 v[72:75], v[152:155], v[204:207], v[72:75]
  ds_read_b64_tr_b16 v[188:189], v241 offset:16384
  v_mfma_f32_16x16x32_bf16 v[76:79], v[152:155], v[208:211], v[76:79]
  ds_read_b64_tr_b16 v[190:191], v241 offset:18432
  v_mfma_f32_16x16x32_bf16 v[80:83], v[156:159], v[196:199], v[80:83]
  ds_read_b64_tr_b16 v[192:193], v242 offset:16384
  v_mfma_f32_16x16x32_bf16 v[84:87], v[156:159], v[200:203], v[84:87]
  ds_read_b64_tr_b16 v[194:195], v242 offset:18432
  v_mfma_f32_16x16x32_bf16 v[88:91], v[156:159], v[204:207], v[88:91]
  v_mfma_f32_16x16x32_bf16 v[92:95], v[156:159], v[208:211], v[92:95]
  v_mfma_f32_16x16x32_bf16 v[96:99], v[160:163], v[196:199], v[96:99]
  v_mfma_f32_16x16x32_bf16 v[100:103], v[160:163], v[200:203], v[100:103]
  v_mfma_f32_16x16x32_bf16 v[104:107], v[160:163], v[204:207], v[104:107]
  v_mfma_f32_16x16x32_bf16 v[108:111], v[160:163], v[208:211], v[108:111]
  v_mfma_f32_16x16x32_bf16 v[112:115], v[164:167], v[196:199], v[112:115]
  v_mfma_f32_16x16x32_bf16 v[116:119], v[164:167], v[200:203], v[116:119]
  v_mfma_f32_16x16x32_bf16 v[120:123], v[164:167], v[204:207], v[120:123]
  v_mfma_f32_16x16x32_bf16 v[124:127], v[164:167], v[208:211], v[124:127]
  s_waitcnt vmcnt(0) lgkmcnt(0)
  s_barrier
  v_mfma_f32_16x16x32_bf16 v[16:19], v[168:171], v[216:219], v[16:19]
  v_mfma_f32_16x16x32_bf16 v[20:23], v[168:171], v[220:223], v[20:23]
  v_mfma_f32_16x16x32_bf16 v[24:27], v[168:171], v[224:227], v[24:27]
  v_mfma_f32_16x16x32_bf16 v[28:31], v[168:171], v[228:231], v[28:31]
  v_mfma_f32_16x16x32_bf16 v[32:35], v[172:175], v[216:219], v[32:35]
  v_mfma_f32_16x16x32_bf16 v[36:39], v[172:175], v[220:223], v[36:39]
  v_mfma_f32_16x16x32_bf16 v[40:43], v[172:175], v[224:227], v[40:43]
  v_mfma_f32_16x16x32_bf16 v[44:47], v[172:175], v[228:231], v[44:47]
  v_mfma_f32_16x16x32_bf16 v[48:51], v[176:179], v[216:219], v[48:51]
  v_mfma_f32_16x16x32_bf16 v[52:55], v[176:179], v[220:223], v[52:55]
  v_mfma_f32_16x16x32_bf16 v[56:59], v[176:179], v[224:227], v[56:59]
  v_mfma_f32_16x16x32_bf16 v[60:63], v[176:179], v[228:231], v[60:63]
  v_mfma_f32_16x16x32_bf16 v[64:67], v[180:183], v[216:219], v[64:67]
  v_mfma_f32_16x16x32_bf16 v[68:71], v[180:183], v[220:223], v[68:71]
  v_mfma_f32_16x16x32_bf16 v[72:75], v[180:183], v[224:227], v[72:75]
  v_mfma_f32_16x16x32_bf16 v[76:79], v[180:183], v[228:231], v[76:79]
  v_mfma_f32_16x16x32_bf16 v[80:83], v[184:187], v[216:219], v[80:83]
  v_mfma_f32_16x16x32_bf16 v[84:87], v[184:187], v[220:223], v[84:87]
  v_mfma_f32_16x16x32_bf16 v[88:91], v[184:187], v[224:227], v[88:91]
  v_mfma_f32_16x16x32_bf16 v[92:95], v[184:187], v[228:231], v[92:95]
  v_mfma_f32_16x16x32_bf16 v[96:99], v[188:191], v[216:219], v[96:99]
  v_mfma_f32_16x16x32_bf16 v[100:103], v[188:191], v[220:223], v[100:103]
  v_mfma_f32_16x16x32_bf16 v[104:107], v[188:191], v[224:227], v[104:107]
  v_mfma_f32_16x16x32_bf16 v[108:111], v[188:191], v[228:231], v[108:111]
  v_mfma_f32_16x16x32_bf16 v[112:115], v[192:195], v[216:219], v[112:115]
  v_mfma_f32_16x16x32_bf16 v[116:119], v[192:195], v[220:223], v[116:119]
  v_mfma_f32_16x16x32_bf16 v[120:123], v[192:195], v[224:227], v[120:123]
  v_mfma_f32_16x16x32_bf16 v[124:127], v[192:195], v[228:231], v[124:127]
  s_waitcnt lgkmcnt(0)
  s_barrier
  v_cvt_pk_bf16_f32 v140, v16, v17
  v_cvt_pk_bf16_f32 v141, v18, v19
  v_cvt_pk_bf16_f32 v142, v20, v21
  v_cvt_pk_bf16_f32 v143, v22, v23
  v_cvt_pk_bf16_f32 v144, v24, v25
  v_cvt_pk_bf16_f32 v145, v26, v27
  v_cvt_pk_bf16_f32 v146, v28, v29
  v_cvt_pk_bf16_f32 v147, v30, v31
  v_cvt_pk_bf16_f32 v148, v32, v33
  v_cvt_pk_bf16_f32 v149, v34, v35
  v_cvt_pk_bf16_f32 v150, v36, v37
  v_cvt_pk_bf16_f32 v151, v38, v39
  v_cvt_pk_bf16_f32 v152, v40, v41
  v_cvt_pk_bf16_f32 v153, v42, v43
  v_cvt_pk_bf16_f32 v154, v44, v45
  v_cvt_pk_bf16_f32 v155, v46, v47
  v_cvt_pk_bf16_f32 v156, v48, v49
  v_cvt_pk_bf16_f32 v157, v50, v51
  v_cvt_pk_bf16_f32 v158, v52, v53
  v_cvt_pk_bf16_f32 v159, v54, v55
  v_cvt_pk_bf16_f32 v160, v56, v57
  v_cvt_pk_bf16_f32 v161, v58, v59
  v_cvt_pk_bf16_f32 v162, v60, v61
  v_cvt_pk_bf16_f32 v163, v62, v63
  v_cvt_pk_bf16_f32 v164, v64, v65
  v_cvt_pk_bf16_f32 v165, v66, v67
  v_cvt_pk_bf16_f32 v166, v68, v69
  v_cvt_pk_bf16_f32 v167, v70, v71
  v_cvt_pk_bf16_f32 v168, v72, v73
  v_cvt_pk_bf16_f32 v169, v74, v75
  v_cvt_pk_bf16_f32 v170, v76, v77
  v_cvt_pk_bf16_f32 v171, v78, v79
  v_cvt_pk_bf16_f32 v172, v80, v81
  v_cvt_pk_bf16_f32 v173, v82, v83
  v_cvt_pk_bf16_f32 v174, v84, v85
  v_cvt_pk_bf16_f32 v175, v86, v87
  v_cvt_pk_bf16_f32 v176, v88, v89
  v_cvt_pk_bf16_f32 v177, v90, v91
  v_cvt_pk_bf16_f32 v178, v92, v93
  v_cvt_pk_bf16_f32 v179, v94, v95
  v_cvt_pk_bf16_f32 v180, v96, v97
  v_cvt_pk_bf16_f32 v181, v98, v99
  v_cvt_pk_bf16_f32 v182, v100, v101
  v_cvt_pk_bf16_f32 v183, v102, v103
  v_cvt_pk_bf16_f32 v184, v104, v105
  v_cvt_pk_bf16_f32 v185, v106, v107
  v_cvt_pk_bf16_f32 v186, v108, v109
  v_cvt_pk_bf16_f32 v187, v110, v111
  v_cvt_pk_bf16_f32 v188, v112, v113
  v_cvt_pk_bf16_f32 v189, v114, v115
  v_cvt_pk_bf16_f32 v190, v116, v117
  v_cvt_pk_bf16_f32 v191, v118, v119
  v_cvt_pk_bf16_f32 v192, v120, v121
  v_cvt_pk_bf16_f32 v193, v122, v123
  v_cvt_pk_bf16_f32 v194, v124, v125
  v_cvt_pk_bf16_f32 v195, v126, v127
  s_lshl_b32 s30, s26, 6
  v_add_u32 v6, s30, v2
  v_mul_u32_u24 v12, 304, v6
  s_mul_i32 s31, s27, 72
  v_add_u32 v12, s31, v12
  v_lshlrev_b32 v13, 3, v3
  s_mov_b32 s28, 0x3020100
  v_bfe_u32 v6, s28, v13, 8
  v_lshl_add_u32 v6, v6, 3, v12
  ds_write_b64 v6, v[140:141] offset:0
  ds_write_b64 v6, v[142:143] offset:4864
  ds_write_b64 v6, v[144:145] offset:9728
  ds_write_b64 v6, v[146:147] offset:14592
  s_mov_b32 s28, 0x7060504
  v_bfe_u32 v6, s28, v13, 8
  v_lshl_add_u32 v6, v6, 3, v12
  ds_write_b64 v6, v[148:149] offset:0
  ds_write_b64 v6, v[150:151] offset:4864
  ds_write_b64 v6, v[152:153] offset:9728
  ds_write_b64 v6, v[154:155] offset:14592
  s_mov_b32 s28, 0x14131208
  v_bfe_u32 v6, s28, v13, 8
  v_lshl_add_u32 v6, v6, 3, v12
  ds_write_b64 v6, v[156:157] offset:0
  ds_write_b64 v6, v[158:159] offset:4864
  ds_write_b64 v6, v[160:161] offset:9728
  ds_write_b64 v6, v[162:163] offset:14592
  s_mov_b32 s28, 0x18171615
  v_bfe_u32 v6, s28, v13, 8
  v_lshl_add_u32 v6, v6, 3, v12
  ds_write_b64 v6, v[164:165] offset:0
  ds_write_b64 v6, v[166:167] offset:4864
  ds_write_b64 v6, v[168:169] offset:9728
  ds_write_b64 v6, v[170:171] offset:14592
  s_mov_b32 s28, 0x24241a19
  v_bfe_u32 v6, s28, v13, 8
  v_lshl_add_u32 v6, v6, 3, v12
  v_cmp_lt_u32 vcc, 1, v3
  v_subrev_u32 v7, s31, v6
  s_nop 0
  v_cndmask_b32 v6, v6, v7, vcc
  ds_write_b64 v6, v[172:173] offset:0
  ds_write_b64 v6, v[174:175] offset:4864
  ds_write_b64 v6, v[176:177] offset:9728
  ds_write_b64 v6, v[178:179] offset:14592
  s_lshl_b32 s28, s23, 3
  s_lshl_b32 s29, s26, 2
  s_add_u32 s28, s28, s29
  s_mul_i32 s28, s28, 72
  s_mul_i32 s29, s24, 9
  s_add_u32 s28, s28, s29
  s_lshl_b32 s28, s28, 8
  s_add_u32 s28, s28, 0
  s_mul_i32 s30, s27, 9
  s_mov_b32 s29, 0x100ffff
  v_bfe_u32 v6, s29, v13, 8
  v_cmp_ne_u32 vcc, 255, v6
  v_add_u32 v6, s30, v6
  v_lshrrev_b32 v7, 1, v6
  v_and_b32 v6, 1, v6
  v_lshlrev_b32 v7, 8, v7
  v_lshl_add_u32 v7, v6, 3, v7
  v_lshl_add_u32 v7, v2, 4, v7
  v_mov_b32 v8, 0x80000000
  v_cndmask_b32 v9, v8, v7, vcc
  s_mov_b32 s29, 0x5040302
  v_bfe_u32 v6, s29, v13, 8
  v_cmp_ne_u32 vcc, 255, v6
  v_add_u32 v6, s30, v6
  v_lshrrev_b32 v7, 1, v6
  v_and_b32 v6, 1, v6
  v_lshlrev_b32 v7, 8, v7
  v_lshl_add_u32 v7, v6, 3, v7
  v_lshl_add_u32 v7, v2, 4, v7
  v_mov_b32 v8, 0x80000000
  v_cndmask_b32 v10, v8, v7, vcc
  s_mov_b32 s29, 0xff080706
  v_bfe_u32 v6, s29, v13, 8
  v_cmp_ne_u32 vcc, 255, v6
  v_add_u32 v6, s30, v6
  v_lshrrev_b32 v7, 1, v6
  v_and_b32 v6, 1, v6
  v_lshlrev_b32 v7, 8, v7
  v_lshl_add_u32 v7, v6, 3, v7
  v_lshl_add_u32 v7, v2, 4, v7
  v_mov_b32 v8, 0x80000000
  v_cndmask_b32 v11, v8, v7, vcc
  s_add_u32 s29, s28, 0
  buffer_store_dwordx2 v[172:173], v9, s[40:43], s29 offen
  buffer_store_dwordx2 v[180:181], v10, s[40:43], s29 offen
  buffer_store_dwordx2 v[188:189], v11, s[40:43], s29 offen
  s_add_u32 s29, s28, 18432
  buffer_store_dwordx2 v[174:175], v9, s[40:43], s29 offen
  buffer_store_dwordx2 v[182:183], v10, s[40:43], s29 offen
  buffer_store_dwordx2 v[190:191], v11, s[40:43], s29 offen
  s_add_u32 s29, s28, 36864
  buffer_store_dwordx2 v[176:177], v9, s[40:43], s29 offen
  buffer_store_dwordx2 v[184:185], v10, s[40:43], s29 offen
  buffer_store_dwordx2 v[192:193], v11, s[40:43], s29 offen
  s_add_u32 s29, s28, 55296
  buffer_store_dwordx2 v[178:179], v9, s[40:43], s29 offen
  buffer_store_dwordx2 v[186:187], v10, s[40:43], s29 offen
  buffer_store_dwordx2 v[194:195], v11, s[40:43], s29 offen
k1_A_epi:
  s_cmp_lt_u32 s21, 16
  s_cselect_b32 s8, s14, s18
  s_cselect_b32 s9, s15, s19
  s_and_b32 s51, s21, 15
  s_mul_i32 s51, s51, 324
  s_mul_i32 s50, s25, 41
  s_add_u32 s51, s51, s50
  v_min_u32 v6, 40, v1
  v_add_u32 v6, s51, v6
  v_lshlrev_b32 v6, 7, v6
  s_mov_b32 s32, s8
  s_and_b32 s33, s9, 0xffff
  s_mov_b32 s34, 663552
  s_mov_b32 s35, 0x00020000
  buffer_load_dword v248, v6, s[32:35], 0 offen
  s_cmp_lg_u32 s23, 0
  s_cbranch_scc1 k1_A_nodump
  s_cmp_lg_u32 s24, 0
  s_cbranch_scc1 k1_A_nodump
  v_lshlrev_b32 v10, 3, v0
  v_mov_b32 v8, 0
  v_mov_b32 v9, 0
  s_mov_b32 s50, 7929856
  buffer_store_dwordx2 v[8:9], v10, s[40:43], s50 offen
k1_A_nodump:
  s_waitcnt lgkmcnt(0)
  s_barrier
  s_lshl_b32 s28, s25, 4
  v_add_u32 v6, s28, v2
  v_mul_u32_u24 v7, 304, v6
  v_lshl_add_u32 v7, v3, 4, v7
  ds_read_b128 v[196:199], v7 offset:0
  ds_read_b128 v[200:203], v7 offset:64
  ds_read_b128 v[204:207], v7 offset:128
  v_mul_u32_u24 v8, 208, v2
  v_lshl_add_u32 v8, v3, 4, v8
  v_add_u32 v9, 120832, v8
  ds_read_b128 v[16:19], v9 offset:0
  ds_read_b128 v[20:23], v9 offset:64
  ds_read_b128 v[24:27], v9 offset:128
  ds_read_b128 v[28:31], v9 offset:3328
  ds_read_b128 v[32:35], v9 offset:3392
  ds_read_b128 v[36:39], v9 offset:3456
  ds_read_b128 v[40:43], v9 offset:6656
  ds_read_b128 v[44:47], v9 offset:6720
  ds_read_b128 v[48:51], v9 offset:6784
  ds_read_b128 v[52:55], v9 offset:9984
  ds_read_b128 v[56:59], v9 offset:10048
  ds_read_b128 v[60:63], v9 offset:10112
  ds_read_b128 v[64:67], v9 offset:13312
  ds_read_b128 v[68:71], v9 offset:13376
  ds_read_b128 v[72:75], v9 offset:13440
  s_mov_b32 s60, 0x3fb8aa3b
  s_mov_b32 s61, 0x3fb8aa3b
  s_waitcnt lgkmcnt(12)
  v_mfma_f32_16x16x32_bf16 v[208:211], v[16:19], v[196:199], 0
  v_mfma_f32_16x16x32_bf16 v[208:211], v[20:23], v[200:203], v[208:211]
  v_mfma_f32_16x16x32_bf16 v[208:211], v[24:27], v[204:207], v[208:211]
  s_waitcnt lgkmcnt(9)
  v_mfma_f32_16x16x32_bf16 v[212:215], v[28:31], v[196:199], 0
  v_mfma_f32_16x16x32_bf16 v[212:215], v[32:35], v[200:203], v[212:215]
  v_mfma_f32_16x16x32_bf16 v[212:215], v[36:39], v[204:207], v[212:215]
  s_waitcnt lgkmcnt(6)
  v_mfma_f32_16x16x32_bf16 v[216:219], v[40:43], v[196:199], 0
  v_mfma_f32_16x16x32_bf16 v[216:219], v[44:47], v[200:203], v[216:219]
  v_mfma_f32_16x16x32_bf16 v[216:219], v[48:51], v[204:207], v[216:219]
  s_waitcnt lgkmcnt(3)
  v_mfma_f32_16x16x32_bf16 v[220:223], v[52:55], v[196:199], 0
  v_mfma_f32_16x16x32_bf16 v[220:223], v[56:59], v[200:203], v[220:223]
  v_mfma_f32_16x16x32_bf16 v[220:223], v[60:63], v[204:207], v[220:223]
  s_waitcnt lgkmcnt(0)
  v_mfma_f32_16x16x32_bf16 v[224:227], v[64:67], v[196:199], 0
  v_mfma_f32_16x16x32_bf16 v[224:227], v[68:71], v[200:203], v[224:227]
  v_mfma_f32_16x16x32_bf16 v[224:227], v[72:75], v[204:207], v[224:227]
  s_lshl_b32 s50, s23, 3
  s_add_u32 s50, s50, s25
  s_cmp_lg_u32 s50, 7
  s_cbranch_scc1 k1_A_nofd
  v_lshlrev_b32 v10, 4, v1
  s_mul_i32 s50, s24, 15360
  s_add_u32 s50, s50, 7798784
  buffer_store_dwordx4 v[16:19], v10, s[40:43], s50 offen offset:0
  buffer_store_dwordx4 v[20:23], v10, s[40:43], s50 offen offset:1024
  buffer_store_dwordx4 v[24:27], v10, s[40:43], s50 offen offset:2048
  buffer_store_dwordx4 v[28:31], v10, s[40:43], s50 offen offset:3072
  s_add_u32 s50, s50, 4096
  buffer_store_dwordx4 v[32:35], v10, s[40:43], s50 offen offset:0
  buffer_store_dwordx4 v[36:39], v10, s[40:43], s50 offen offset:1024
  buffer_store_dwordx4 v[40:43], v10, s[40:43], s50 offen offset:2048
  buffer_store_dwordx4 v[44:47], v10, s[40:43], s50 offen offset:3072
  s_add_u32 s50, s50, 4096
  buffer_store_dwordx4 v[48:51], v10, s[40:43], s50 offen offset:0
  buffer_store_dwordx4 v[52:55], v10, s[40:43], s50 offen offset:1024
  buffer_store_dwordx4 v[56:59], v10, s[40:43], s50 offen offset:2048
  buffer_store_dwordx4 v[60:63], v10, s[40:43], s50 offen offset:3072
  s_add_u32 s50, s50, 4096
  buffer_store_dwordx4 v[64:67], v10, s[40:43], s50 offen offset:0
  buffer_store_dwordx4 v[68:71], v10, s[40:43], s50 offen offset:1024
  buffer_store_dwordx4 v[72:75], v10, s[40:43], s50 offen offset:2048
k1_A_nofd:
  s_nop 7
  v_max3_f32 v140, v208, v209, v210
  v_min3_f32 v141, v208, v209, v210
  v_max3_f32 v140, v140, v211, v212
  v_min3_f32 v141, v141, v211, v212
  v_max3_f32 v140, v140, v213, v214
  v_min3_f32 v141, v141, v213, v214
  v_max3_f32 v140, v140, v215, v216
  v_min3_f32 v141, v141, v215, v216
  v_max3_f32 v140, v140, v217, v218
  v_min3_f32 v141, v141, v217, v218
  v_max3_f32 v140, v140, v219, v220
  v_min3_f32 v141, v141, v219, v220
  v_max3_f32 v140, v140, v221, v222
  v_min3_f32 v141, v141, v221, v222
  v_max3_f32 v140, v140, v223, v224
  v_min3_f32 v141, v141, v223, v224
  v_max_f32 v140, v140, v225
  v_min_f32 v141, v141, v225
  v_mul_f32 v142, s60, v140
  v_mul_f32 v144, s60, v141
  v_pk_fma_f32 v[80:81], v[208:209], s[60:61], v[142:143] op_sel_hi:[1,1,0] neg_lo:[0,0,1] neg_hi:[0,0,1]
  v_pk_fma_f32 v[98:99], v[208:209], s[60:61], v[144:145] op_sel_hi:[1,1,0] neg_lo:[1,0,0] neg_hi:[1,0,0]
  v_pk_fma_f32 v[82:83], v[210:211], s[60:61], v[142:143] op_sel_hi:[1,1,0] neg_lo:[0,0,1] neg_hi:[0,0,1]
  v_pk_fma_f32 v[100:101], v[210:211], s[60:61], v[144:145] op_sel_hi:[1,1,0] neg_lo:[1,0,0] neg_hi:[1,0,0]
  v_pk_fma_f32 v[84:85], v[212:213], s[60:61], v[142:143] op_sel_hi:[1,1,0] neg_lo:[0,0,1] neg_hi:[0,0,1]
  v_pk_fma_f32 v[102:103], v[212:213], s[60:61], v[144:145] op_sel_hi:[1,1,0] neg_lo:[1,0,0] neg_hi:[1,0,0]
  v_pk_fma_f32 v[86:87], v[214:215], s[60:61], v[142:143] op_sel_hi:[1,1,0] neg_lo:[0,0,1] neg_hi:[0,0,1]
  v_pk_fma_f32 v[104:105], v[214:215], s[60:61], v[144:145] op_sel_hi:[1,1,0] neg_lo:[1,0,0] neg_hi:[1,0,0]
  v_pk_fma_f32 v[88:89], v[216:217], s[60:61], v[142:143] op_sel_hi:[1,1,0] neg_lo:[0,0,1] neg_hi:[0,0,1]
  v_pk_fma_f32 v[106:107], v[216:217], s[60:61], v[144:145] op_sel_hi:[1,1,0] neg_lo:[1,0,0] neg_hi:[1,0,0]
  v_pk_fma_f32 v[90:91], v[218:219], s[60:61], v[142:143] op_sel_hi:[1,1,0] neg_lo:[0,0,1] neg_hi:[0,0,1]
  v_pk_fma_f32 v[108:109], v[218:219], s[60:61], v[144:145] op_sel_hi:[1,1,0] neg_lo:[1,0,0] neg_hi:[1,0,0]
  v_pk_fma_f32 v[92:93], v[220:221], s[60:61], v[142:143] op_sel_hi:[1,1,0] neg_lo:[0,0,1] neg_hi:[0,0,1]
  v_pk_fma_f32 v[110:111], v[220:221], s[60:61], v[144:145] op_sel_hi:[1,1,0] neg_lo:[1,0,0] neg_hi:[1,0,0]
  v_pk_fma_f32 v[94:95], v[222:223], s[60:61], v[142:143] op_sel_hi:[1,1,0] neg_lo:[0,0,1] neg_hi:[0,0,1]
  v_pk_fma_f32 v[112:113], v[222:223], s[60:61], v[144:145] op_sel_hi:[1,1,0] neg_lo:[1,0,0] neg_hi:[1,0,0]
  v_pk_fma_f32 v[96:97], v[224:225], s[60:61], v[142:143] op_sel_hi:[1,1,0] neg_lo:[0,0,1] neg_hi:[0,0,1]
  v_pk_fma_f32 v[114:115], v[224:225], s[60:61], v[144:145] op_sel_hi:[1,1,0] neg_lo:[1,0,0] neg_hi:[1,0,0]
  v_exp_f32 v80, v80
  v_exp_f32 v98, v98
  v_exp_f32 v81, v81
  v_exp_f32 v99, v99
  v_exp_f32 v82, v82
  v_exp_f32 v100, v100
  v_exp_f32 v83, v83
  v_exp_f32 v101, v101
  v_exp_f32 v84, v84
  v_exp_f32 v102, v102
  v_exp_f32 v85, v85
  v_exp_f32 v103, v103
  v_exp_f32 v86, v86
  v_exp_f32 v104, v104
  v_exp_f32 v87, v87
  v_exp_f32 v105, v105
  v_exp_f32 v88, v88
  v_exp_f32 v106, v106
  v_exp_f32 v89, v89
  v_exp_f32 v107, v107
  v_exp_f32 v90, v90
  v_exp_f32 v108, v108
  v_exp_f32 v91, v91
  v_exp_f32 v109, v109
  v_exp_f32 v92, v92
  v_exp_f32 v110, v110
  v_exp_f32 v93, v93
  v_exp_f32 v111, v111
  v_exp_f32 v94, v94
  v_exp_f32 v112, v112
  v_exp_f32 v95, v95
  v_exp_f32 v113, v113
  v_exp_f32 v96, v96
  v_exp_f32 v114, v114
  v_exp_f32 v97, v97
  v_exp_f32 v115, v115
  v_pk_add_f32 v[142:143], v[80:81], v[82:83]
  v_pk_add_f32 v[144:145], v[98:99], v[100:101]
  v_pk_add_f32 v[142:143], v[142:143], v[84:85]
  v_pk_add_f32 v[144:145], v[144:145], v[102:103]
  v_pk_add_f32 v[142:143], v[142:143], v[86:87]
  v_pk_add_f32 v[144:145], v[144:145], v[104:105]
  v_pk_add_f32 v[142:143], v[142:143], v[88:89]
  v_pk_add_f32 v[144:145], v[144:145], v[106:107]
  v_pk_add_f32 v[142:143], v[142:143], v[90:91]
  v_pk_add_f32 v[144:145], v[144:145], v[108:109]
  v_pk_add_f32 v[142:143], v[142:143], v[92:93]
  v_pk_add_f32 v[144:145], v[144:145], v[110:111]
  v_pk_add_f32 v[142:143], v[142:143], v[94:95]
  v_pk_add_f32 v[144:145], v[144:145], v[112:113]
  v_pk_add_f32 v[142:143], v[142:143], v[96:97]
  v_pk_add_f32 v[144:145], v[144:145], v[114:115]
  v_add_f32 v142, v142, v143
  v_add_f32 v144, v144, v145
  v_rcp_f32 v142, v142
  v_rcp_f32 v144, v144
  s_nop 0
  v_pk_mul_f32 v[80:81], v[80:81], v[142:143] op_sel_hi:[1,0]
  v_pk_mul_f32 v[98:99], v[98:99], v[144:145] op_sel_hi:[1,0]
  v_pk_mul_f32 v[82:83], v[82:83], v[142:143] op_sel_hi:[1,0]
  v_pk_mul_f32 v[100:101], v[100:101], v[144:145] op_sel_hi:[1,0]
  v_pk_mul_f32 v[84:85], v[84:85], v[142:143] op_sel_hi:[1,0]
  v_pk_mul_f32 v[102:103], v[102:103], v[144:145] op_sel_hi:[1,0]
  v_pk_mul_f32 v[86:87], v[86:87], v[142:143] op_sel_hi:[1,0]
  v_pk_mul_f32 v[104:105], v[104:105], v[144:145] op_sel_hi:[1,0]
  v_pk_mul_f32 v[88:89], v[88:89], v[142:143] op_sel_hi:[1,0]
  v_pk_mul_f32 v[106:107], v[106:107], v[144:145] op_sel_hi:[1,0]
  v_pk_mul_f32 v[90:91], v[90:91], v[142:143] op_sel_hi:[1,0]
  v_pk_mul_f32 v[108:109], v[108:109], v[144:145] op_sel_hi:[1,0]
  v_pk_mul_f32 v[92:93], v[92:93], v[142:143] op_sel_hi:[1,0]
  v_pk_mul_f32 v[110:111], v[110:111], v[144:145] op_sel_hi:[1,0]
  v_pk_mul_f32 v[94:95], v[94:95], v[142:143] op_sel_hi:[1,0]
  v_pk_mul_f32 v[112:113], v[112:113], v[144:145] op_sel_hi:[1,0]
  v_pk_mul_f32 v[96:97], v[96:97], v[142:143] op_sel_hi:[1,0]
  v_pk_mul_f32 v[114:115], v[114:115], v[144:145] op_sel_hi:[1,0]
  v_cvt_pk_bf16_f32 v116, v80, v81
  v_cvt_pk_bf16_f32 v125, v98, v99
  v_cvt_pk_bf16_f32 v117, v82, v83
  v_cvt_pk_bf16_f32 v126, v100, v101
  v_cvt_pk_bf16_f32 v118, v84, v85
  v_cvt_pk_bf16_f32 v127, v102, v103
  v_cvt_pk_bf16_f32 v119, v86, v87
  v_cvt_pk_bf16_f32 v128, v104, v105
  v_cvt_pk_bf16_f32 v120, v88, v89
  v_cvt_pk_bf16_f32 v129, v106, v107
  v_cvt_pk_bf16_f32 v121, v90, v91
  v_cvt_pk_bf16_f32 v130, v108, v109
  v_cvt_pk_bf16_f32 v122, v92, v93
  v_cvt_pk_bf16_f32 v131, v110, v111
  v_cvt_pk_bf16_f32 v123, v94, v95
  v_cvt_pk_bf16_f32 v132, v112, v113
  v_cvt_pk_bf16_f32 v124, v96, v97
  v_cvt_pk_bf16_f32 v133, v114, v115
  v_mul_u32_u24 v7, 336, v6
  v_mul_u32_u24 v8, 80, v3
  v_add_u32 v7, v7, v8
  ds_write_b128 v7, v[116:119] offset:40960
  ds_write_b128 v7, v[120:123] offset:40976
  ds_write_b128 v7, v[124:127] offset:40992
  ds_write_b128 v7, v[128:131] offset:41008
  ds_write_b64 v7, v[132:133] offset:41024
  s_lshr_b32 s30, s25, 1
  s_and_b32 s31, s25, 1
  v_lshl_add_u32 v6, v3, 3, v4
  v_mul_u32_u24 v7, 336, v6
  v_lshl_add_u32 v7, v5, 3, v7
  s_mul_i32 s28, s30, 80
  s_add_u32 s28, s28, 40960
  v_add_u32 v7, s28, v7
  v_mul_u32_u24 v8, 304, v6
  s_lshr_b32 s28, s30, 1
  s_mul_i32 s28, s28, 72
  s_add_u32 s28, s28, 144
  s_and_b32 s29, s30, 1
  s_mul_i32 s29, s29, 40
  s_cmp_eq_u32 s31, 0
  s_cselect_b32 s29, s29, 32
  s_add_u32 s28, s28, s29
  v_lshl_add_u32 v9, v5, 3, v8
  v_add_u32 v9, s28, v9
  v_cmp_lt_u32 s[62:63], 0, v5
  s_cmp_eq_u32 s31, 0
  s_cselect_b64 s[62:63], 0, s[62:63]
  v_mov_b32 v10, 137472
  v_add_u32 v148, 0, v9
  v_cndmask_b32 v148, v148, v10, s[62:63]
  v_add_u32 v149, 1216, v9
  v_cndmask_b32 v149, v149, v10, s[62:63]
  v_add_u32 v150, 9728, v9
  v_cndmask_b32 v150, v150, v10, s[62:63]
  v_add_u32 v151, 10944, v9
  v_cndmask_b32 v151, v151, v10, s[62:63]
  v_add_u32 v152, 19456, v9
  v_cndmask_b32 v152, v152, v10, s[62:63]
  v_add_u32 v153, 20672, v9
  v_cndmask_b32 v153, v153, v10, s[62:63]
  v_add_u32 v154, 29184, v9
  v_cndmask_b32 v154, v154, v10, s[62:63]
  v_add_u32 v155, 30400, v9
  v_cndmask_b32 v155, v155, v10, s[62:63]
  s_waitcnt lgkmcnt(0)
  s_barrier
  ds_read_b64_tr_b16 v[64:65], v148
  ds_read_b64_tr_b16 v[16:17], v7 offset:0
  ds_read_b64_tr_b16 v[20:21], v7 offset:32
  ds_read_b64_tr_b16 v[24:25], v7 offset:64
  ds_read_b64_tr_b16 v[66:67], v149
  ds_read_b64_tr_b16 v[18:19], v7 offset:1344
  ds_read_b64_tr_b16 v[22:23], v7 offset:1376
  ds_read_b64_tr_b16 v[26:27], v7 offset:1408
  ds_read_b64_tr_b16 v[68:69], v150
  ds_read_b64_tr_b16 v[28:29], v7 offset:10752
  ds_read_b64_tr_b16 v[32:33], v7 offset:10784
  ds_read_b64_tr_b16 v[36:37], v7 offset:10816
  ds_read_b64_tr_b16 v[70:71], v151
  ds_read_b64_tr_b16 v[30:31], v7 offset:12096
  ds_read_b64_tr_b16 v[34:35], v7 offset:12128
  ds_read_b64_tr_b16 v[38:39], v7 offset:12160
  ds_read_b64_tr_b16 v[72:73], v152
  ds_read_b64_tr_b16 v[40:41], v7 offset:21504
  ds_read_b64_tr_b16 v[44:45], v7 offset:21536
  ds_read_b64_tr_b16 v[48:49], v7 offset:21568
  ds_read_b64_tr_b16 v[74:75], v153
  ds_read_b64_tr_b16 v[42:43], v7 offset:22848
  ds_read_b64_tr_b16 v[46:47], v7 offset:22880
  ds_read_b64_tr_b16 v[50:51], v7 offset:22912
  ds_read_b64_tr_b16 v[76:77], v154
  ds_read_b64_tr_b16 v[52:53], v7 offset:32256
  ds_read_b64_tr_b16 v[56:57], v7 offset:32288
  ds_read_b64_tr_b16 v[60:61], v7 offset:32320
  ds_read_b64_tr_b16 v[78:79], v155
  ds_read_b64_tr_b16 v[54:55], v7 offset:33600
  ds_read_b64_tr_b16 v[58:59], v7 offset:33632
  ds_read_b64_tr_b16 v[62:63], v7 offset:33664
  s_and_b32 s29, s30, 1
  s_lshl_b32 s28, s29, 1
  v_add_u32 v6, s28, v2
  v_subrev_u32 v7, s28, v2
  s_xor_b32 s29, s29, 1
  s_lshl_b32 s29, s29, 4
  v_cmp_gt_u32 vcc, 2, v7
  v_add_u32 v7, s29, v7
  v_mov_b32 v8, 0x40000
  s_nop 0
  v_cndmask_b32 v7, v8, v7, vcc
  v_cmp_eq_u32 vcc, 4, v2
  s_nop 1
  v_cndmask_b32 v7, v7, 18, vcc
  s_cmp_eq_u32 s31, 0
  s_cselect_b64 vcc, -1, 0
  s_nop 1
  v_cndmask_b32 v6, v7, v6, vcc
  v_mul_u32_u24 v6, 72, v6
  v_lshl_add_u32 v6, v3, 3, v6
  s_lshl_b32 s28, s23, 5
  s_lshl_b32 s29, s24, 2
  s_add_u32 s28, s28, s29
  s_add_u32 s28, s28, s30
  s_mul_i32 s28, s28, 1368
  s_add_u32 s28, s28, 7077888
  v_cmp_eq_u32 vcc, 0, v3
  v_mov_b32 v8, 0x80000000
  s_nop 1
  v_cndmask_b32 v7, v8, v6, vcc
  s_waitcnt lgkmcnt(15)
  v_mfma_f32_16x16x32_bf16 v[196:199], v[16:19], v[64:67], 0
  v_mfma_f32_16x16x32_bf16 v[200:203], v[20:23], v[64:67], 0
  v_mfma_f32_16x16x32_bf16 v[204:207], v[24:27], v[64:67], 0
  s_waitcnt lgkmcnt(15)
  v_mfma_f32_16x16x32_bf16 v[196:199], v[28:31], v[68:71], v[196:199]
  v_mfma_f32_16x16x32_bf16 v[200:203], v[32:35], v[68:71], v[200:203]
  v_mfma_f32_16x16x32_bf16 v[204:207], v[36:39], v[68:71], v[204:207]
  s_waitcnt lgkmcnt(8)
  v_mfma_f32_16x16x32_bf16 v[196:199], v[40:43], v[72:75], v[196:199]
  v_mfma_f32_16x16x32_bf16 v[200:203], v[44:47], v[72:75], v[200:203]
  v_mfma_f32_16x16x32_bf16 v[204:207], v[48:51], v[72:75], v[204:207]
  s_waitcnt lgkmcnt(0)
  v_mfma_f32_16x16x32_bf16 v[196:199], v[52:55], v[76:79], v[196:199]
  v_mfma_f32_16x16x32_bf16 v[200:203], v[56:59], v[76:79], v[200:203]
  v_mfma_f32_16x16x32_bf16 v[204:207], v[60:63], v[76:79], v[204:207]
  s_nop 7
  s_nop 1
  v_cvt_pk_bf16_f32 v208, v196, v197
  v_cvt_pk_bf16_f32 v209, v198, v199
  v_cvt_pk_bf16_f32 v210, v200, v201
  v_cvt_pk_bf16_f32 v211, v202, v203
  v_cvt_pk_bf16_f32 v212, v204, v205
  v_cvt_pk_bf16_f32 v213, v206, v207
  buffer_store_dwordx2 v[208:209], v6, s[40:43], s28 offen
  buffer_store_dwordx2 v[210:211], v6, s[40:43], s28 offen offset:32
  buffer_store_dwordx2 v[212:213], v7, s[40:43], s28 offen offset:64
  s_endpgm
k1_B:
  v_and_b32 v6, 7, v1
  v_xor_b32 v6, v6, v3
  v_lshrrev_b32 v7, 3, v1
  v_mul_u32_u24 v7, 1152, v7
  v_lshl_add_u32 v250, v6, 4, v7
  v_xor_b32 v251, 64, v250
  s_lshr_b32 s28, s21, 2
  s_and_b32 s29, s21, 3
  s_lshl_b32 s29, s29, 1
  s_add_u32 s54, s28, s29
  s_sub_u32 s28, s54, 9
  s_cmp_ge_u32 s54, 9
  s_cselect_b32 s54, s28, s54
  s_lshl_b32 s54, s54, 7
  s_lshl_b32 s28, s25, 4
  s_add_u32 s28, s28, s48
  s_mul_i32 s53, s28, 1152
  s_sub_u32 s28, s48, 16
  s_max_i32 s28, s28, 0
  s_mul_i32 s56, s28, 1152
  s_cmp_eq_u32 s25, 0
  s_cselect_b32 s56, s56, 0x80000000
  s_lshl_b32 s57, s25, 11
  s_add_u32 s57, s57, 67584
  s_add_u32 m0, s57, 0
  s_add_u32 s28, s54, s53
  buffer_load_dwordx4 v250, s[32:35], s28 offen lds
  s_add_u32 m0, s57, 1024
  s_add_u32 s28, s54, s53
  s_add_u32 s28, s28, 9216
  buffer_load_dwordx4 v251, s[32:35], s28 offen lds
  s_cmp_lg_u32 s25, 0
  s_cbranch_scc1 k1c_1
  s_mov_b32 m0, 65536
  s_add_u32 s28, s54, s56
  buffer_load_dwordx4 v250, s[32:35], s28 offen lds
  k1c_1:
  s_add_u32 m0, s57, 8192
  s_add_u32 s28, s54, s53
  s_add_u32 s28, s28, 73728
  buffer_load_dwordx4 v250, s[32:35], s28 offen lds
  s_add_u32 m0, s57, 9216
  s_add_u32 s28, s54, s53
  s_add_u32 s28, s28, 82944
  buffer_load_dwordx4 v251, s[32:35], s28 offen lds
  s_cmp_lg_u32 s25, 0
  s_cbranch_scc1 k1c_2
  s_mov_b32 m0, 66560
  s_add_u32 s28, s54, s56
  s_add_u32 s28, s28, 9216
  buffer_load_dwordx4 v251, s[32:35], s28 offen lds
  k1c_2:
  s_add_u32 s54, s54, 128
  s_cmp_eq_u32 s54, 1152
  s_cselect_b32 s54, 0, s54
  s_add_u32 m0, s57, 18432
  s_add_u32 s28, s54, s53
  buffer_load_dwordx4 v250, s[32:35], s28 offen lds
  s_add_u32 m0, s57, 19456
  s_add_u32 s28, s54, s53
  s_add_u32 s28, s28, 9216
  buffer_load_dwordx4 v251, s[32:35], s28 offen lds
  s_cmp_lg_u32 s25, 0
  s_cbranch_scc1 k1c_3
  s_mov_b32 m0, 83968
  s_add_u32 s28, s54, s56
  buffer_load_dwordx4 v250, s[32:35], s28 offen lds
  k1c_3:
  v_lshlrev_b32 v12, 12, v3
  v_and_b32 v6, 1, v3
  v_lshl_add_u32 v12, v6, 7, v12
  v_mul_u32_u24 v6, 480, v4
  s_mul_i32 s30, s27, 72
  v_add3_u32 v12, v12, v6, s30
  v_lshlrev_b32 v7, 3, v5
  s_cmp_eq_u32 s26, 0
  s_mov_b32 s28, 0x15141312
  s_mov_b32 s29, 0x2a292827
  s_cselect_b32 s28, s28, s29
  v_bfe_u32 v6, s28, v7, 8
  v_lshl_add_u32 v236, v6, 3, v12
  s_cmp_eq_u32 s26, 0
  s_mov_b32 s28, 0x19181716
  s_mov_b32 s29, 0x1002c2b
  s_cselect_b32 s28, s28, s29
  v_bfe_u32 v6, s28, v7, 8
  v_lshl_add_u32 v237, v6, 3, v12
  s_cmp_eq_u32 s26, 0
  s_mov_b32 s28, 0x2625241a
  s_mov_b32 s29, 0x5040302
  s_cselect_b32 s28, s28, s29
  v_bfe_u32 v6, s28, v7, 8
  v_lshl_add_u32 v238, v6, 3, v12
  s_cmp_eq_u32 s26, 0
  s_mov_b32 s28, 0x2a292827
  s_mov_b32 s29, 0x8080706
  s_cselect_b32 s28, s28, s29
  v_bfe_u32 v6, s28, v7, 8
  v_lshl_add_u32 v239, v6, 3, v12
  s_cmp_eq_u32 s26, 0
  s_mov_b32 s28, 0x1002c2b
  s_mov_b32 s29, 0x15141312
  s_cselect_b32 s28, s28, s29
  v_bfe_u32 v6, s28, v7, 8
  v_lshl_add_u32 v240, v6, 3, v12
  s_cmp_eq_u32 s26, 0
  s_mov_b32 s28, 0x5040302
  s_mov_b32 s29, 0x19181716
  s_cselect_b32 s28, s28, s29
  v_bfe_u32 v6, s28, v7, 8
  v_lshl_add_u32 v241, v6, 3, v12
  s_cmp_eq_u32 s26, 0
  s_mov_b32 s28, 0x8080706
  s_mov_b32 s29, 0x2625241a
  s_cselect_b32 s28, s28, s29
  v_bfe_u32 v6, s28, v7, 8
  v_lshl_add_u32 v242, v6, 3, v12
  v_lshrrev_b32 v6, 1, v2
  v_xor_b32 v6, v6, v3
  v_lshlrev_b32 v7, 7, v2
  v_lshl_add_u32 v6, v6, 4, v7
  v_add_u32 v245, 65536, v6
  v_xor_b32 v246, 64, v245
  s_lshl_b32 s28, s26, 13
  s_add_u32 s28, s28, 2048
  v_add_u32 v243, s28, v245
  v_add_u32 v244, s28, v246
  s_waitcnt vmcnt(2)
  s_barrier
  ds_read_b128 v[196:199], v243 offset:0
  ds_read_b128 v[200:203], v243 offset:2048
  ds_read_b128 v[204:207], v243 offset:4096
  ds_read_b128 v[208:211], v243 offset:6144
  ds_read_b128 v[212:215], v245 offset:0
  ds_read_b64_tr_b16 v[140:141], v236 offset:0
  ds_read_b64_tr_b16 v[142:143], v236 offset:2048
  ds_read_b64_tr_b16 v[144:145], v237 offset:0
  ds_read_b64_tr_b16 v[146:147], v237 offset:2048
  ds_read_b64_tr_b16 v[148:149], v238 offset:0
  ds_read_b64_tr_b16 v[150:151], v238 offset:2048
  ds_read_b64_tr_b16 v[152:153], v239 offset:0
  ds_read_b64_tr_b16 v[154:155], v239 offset:2048
  ds_read_b64_tr_b16 v[156:157], v240 offset:0
  ds_read_b64_tr_b16 v[158:159], v240 offset:2048
  ds_read_b64_tr_b16 v[160:161], v241 offset:0
  ds_read_b64_tr_b16 v[162:163], v241 offset:2048
  ds_read_b64_tr_b16 v[164:165], v242 offset:0
  ds_read_b64_tr_b16 v[166:167], v242 offset:2048
  s_add_u32 m0, s57, 26624
  s_add_u32 s28, s54, s53
  s_add_u32 s28, s28, 73728
  buffer_load_dwordx4 v250, s[32:35], s28 offen lds
  s_add_u32 m0, s57, 27648
  s_add_u32 s28, s54, s53
  s_add_u32 s28, s28, 82944
  buffer_load_dwordx4 v251, s[32:35], s28 offen lds
  s_cmp_lg_u32 s25, 0
  s_cbranch_scc1 k1c_4
  s_mov_b32 m0, 84992
  s_add_u32 s28, s54, s56
  s_add_u32 s28, s28, 9216
  buffer_load_dwordx4 v251, s[32:35], s28 offen lds
  k1c_4:
  s_add_u32 s54, s54, 128
  s_cmp_eq_u32 s54, 1152
  s_cselect_b32 s54, 0, s54
  s_add_u32 m0, s57, 36864
  s_add_u32 s28, s54, s53
  buffer_load_dwordx4 v250, s[32:35], s28 offen lds
  s_add_u32 m0, s57, 37888
  s_add_u32 s28, s54, s53
  s_add_u32 s28, s28, 9216
  buffer_load_dwordx4 v251, s[32:35], s28 offen lds
  s_cmp_lg_u32 s25, 0
  s_cbranch_scc1 k1c_5
  s_mov_b32 m0, 102400
  s_add_u32 s28, s54, s56
  buffer_load_dwordx4 v250, s[32:35], s28 offen lds
  k1c_5:
  s_waitcnt vmcnt(4) lgkmcnt(0)
  s_barrier
  v_mfma_f32_16x16x32_bf16 v[16:19], v[140:143], v[196:199], 0
  ds_read_b128 v[216:219], v244 offset:0
  v_mfma_f32_16x16x32_bf16 v[20:23], v[140:143], v[200:203], 0
  ds_read_b128 v[220:223], v244 offset:2048
  v_mfma_f32_16x16x32_bf16 v[24:27], v[140:143], v[204:207], 0
  ds_read_b128 v[224:227], v244 offset:4096
  v_mfma_f32_16x16x32_bf16 v[28:31], v[140:143], v[208:211], 0
  ds_read_b128 v[228:231], v244 offset:6144
  v_mfma_f32_16x16x32_bf16 v[128:131], v[140:143], v[212:215], 0
  ds_read_b128 v[232:235], v246 offset:0
  v_mfma_f32_16x16x32_bf16 v[32:35], v[144:147], v[196:199], 0
  ds_read_b64_tr_b16 v[168:169], v236 offset:16384
  v_mfma_f32_16x16x32_bf16 v[36:39], v[144:147], v[200:203], 0
  ds_read_b64_tr_b16 v[170:171], v236 offset:18432
  v_mfma_f32_16x16x32_bf16 v[40:43], v[144:147], v[204:207], 0
  ds_read_b64_tr_b16 v[172:173], v237 offset:16384
  v_mfma_f32_16x16x32_bf16 v[44:47], v[144:147], v[208:211], 0
  ds_read_b64_tr_b16 v[174:175], v237 offset:18432
  v_mfma_f32_16x16x32_bf16 v[132:135], v[144:147], v[212:215], 0
  ds_read_b64_tr_b16 v[176:177], v238 offset:16384
  v_mfma_f32_16x16x32_bf16 v[48:51], v[148:151], v[196:199], 0
  ds_read_b64_tr_b16 v[178:179], v238 offset:18432
  v_mfma_f32_16x16x32_bf16 v[52:55], v[148:151], v[200:203], 0
  ds_read_b64_tr_b16 v[180:181], v239 offset:16384
  v_mfma_f32_16x16x32_bf16 v[56:59], v[148:151], v[204:207], 0
  ds_read_b64_tr_b16 v[182:183], v239 offset:18432
  v_mfma_f32_16x16x32_bf16 v[60:63], v[148:151], v[208:211], 0
  ds_read_b64_tr_b16 v[184:185], v240 offset:16384
  v_mfma_f32_16x16x32_bf16 v[136:139], v[148:151], v[212:215], 0
  ds_read_b64_tr_b16 v[186:187], v240 offset:18432
  v_mfma_f32_16x16x32_bf16 v[64:67], v[152:155], v[196:199], 0
  ds_read_b64_tr_b16 v[188:189], v241 offset:16384
  v_mfma_f32_16x16x32_bf16 v[68:71], v[152:155], v[200:203], 0
  ds_read_b64_tr_b16 v[190:191], v241 offset:18432
  v_mfma_f32_16x16x32_bf16 v[72:75], v[152:155], v[204:207], 0
  ds_read_b64_tr_b16 v[192:193], v242 offset:16384
  v_mfma_f32_16x16x32_bf16 v[76:79], v[152:155], v[208:211], 0
  ds_read_b64_tr_b16 v[194:195], v242 offset:18432
  v_mfma_f32_16x16x32_bf16 v[80:83], v[156:159], v[196:199], 0
  s_add_u32 m0, s57, 45056
  s_add_u32 s28, s54, s53
  s_add_u32 s28, s28, 73728
  buffer_load_dwordx4 v250, s[32:35], s28 offen lds
  s_add_u32 m0, s57, 46080
  s_add_u32 s28, s54, s53
  s_add_u32 s28, s28, 82944
  buffer_load_dwordx4 v251, s[32:35], s28 offen lds
  s_cmp_lg_u32 s25, 0
  s_cbranch_scc1 k1c_6
  s_mov_b32 m0, 103424
  s_add_u32 s28, s54, s56
  s_add_u32 s28, s28, 9216
  buffer_load_dwordx4 v251, s[32:35], s28 offen lds
  k1c_6:
  s_add_u32 s54, s54, 128
  s_cmp_eq_u32 s54, 1152
  s_cselect_b32 s54, 0, s54
  v_mfma_f32_16x16x32_bf16 v[84:87], v[156:159], v[200:203], 0
  v_mfma_f32_16x16x32_bf16 v[88:91], v[156:159], v[204:207], 0
  v_mfma_f32_16x16x32_bf16 v[92:95], v[156:159], v[208:211], 0
  v_mfma_f32_16x16x32_bf16 v[96:99], v[160:163], v[196:199], 0
  v_mfma_f32_16x16x32_bf16 v[100:103], v[160:163], v[200:203], 0
  v_mfma_f32_16x16x32_bf16 v[104:107], v[160:163], v[204:207], 0
  v_mfma_f32_16x16x32_bf16 v[108:111], v[160:163], v[208:211], 0
  v_mfma_f32_16x16x32_bf16 v[112:115], v[164:167], v[196:199], 0
  v_mfma_f32_16x16x32_bf16 v[116:119], v[164:167], v[200:203], 0
  v_mfma_f32_16x16x32_bf16 v[120:123], v[164:167], v[204:207], 0
  v_mfma_f32_16x16x32_bf16 v[124:127], v[164:167], v[208:211], 0
  s_waitcnt vmcnt(4) lgkmcnt(0)
  s_barrier
  v_mfma_f32_16x16x32_bf16 v[16:19], v[168:171], v[216:219], v[16:19]
  ds_read_b128 v[196:199], v243 offset:18432
  v_mfma_f32_16x16x32_bf16 v[20:23], v[168:171], v[220:223], v[20:23]
  ds_read_b128 v[200:203], v243 offset:20480
  v_mfma_f32_16x16x32_bf16 v[24:27], v[168:171], v[224:227], v[24:27]
  ds_read_b128 v[204:207], v243 offset:22528
  v_mfma_f32_16x16x32_bf16 v[28:31], v[168:171], v[228:231], v[28:31]
  ds_read_b128 v[208:211], v243 offset:24576
  v_mfma_f32_16x16x32_bf16 v[128:131], v[168:171], v[232:235], v[128:131]
  ds_read_b128 v[212:215], v245 offset:18432
  v_mfma_f32_16x16x32_bf16 v[32:35], v[172:175], v[216:219], v[32:35]
  ds_read_b64_tr_b16 v[140:141], v236 offset:32768
  v_mfma_f32_16x16x32_bf16 v[36:39], v[172:175], v[220:223], v[36:39]
  ds_read_b64_tr_b16 v[142:143], v236 offset:34816
  v_mfma_f32_16x16x32_bf16 v[40:43], v[172:175], v[224:227], v[40:43]
  ds_read_b64_tr_b16 v[144:145], v237 offset:32768
  v_mfma_f32_16x16x32_bf16 v[44:47], v[172:175], v[228:231], v[44:47]
  ds_read_b64_tr_b16 v[146:147], v237 offset:34816
  v_mfma_f32_16x16x32_bf16 v[132:135], v[172:175], v[232:235], v[132:135]
  ds_read_b64_tr_b16 v[148:149], v238 offset:32768
  v_mfma_f32_16x16x32_bf16 v[48:51], v[176:179], v[216:219], v[48:51]
  ds_read_b64_tr_b16 v[150:151], v238 offset:34816
  v_mfma_f32_16x16x32_bf16 v[52:55], v[176:179], v[220:223], v[52:55]
  ds_read_b64_tr_b16 v[152:153], v239 offset:32768
  v_mfma_f32_16x16x32_bf16 v[56:59], v[176:179], v[224:227], v[56:59]
  ds_read_b64_tr_b16 v[154:155], v239 offset:34816
  v_mfma_f32_16x16x32_bf16 v[60:63], v[176:179], v[228:231], v[60:63]
  ds_read_b64_tr_b16 v[156:157], v240 offset:32768
  v_mfma_f32_16x16x32_bf16 v[136:139], v[176:179], v[232:235], v[136:139]
  ds_read_b64_tr_b16 v[158:159], v240 offset:34816
  v_mfma_f32_16x16x32_bf16 v[64:67], v[180:183], v[216:219], v[64:67]
  ds_read_b64_tr_b16 v[160:161], v241 offset:32768
  v_mfma_f32_16x16x32_bf16 v[68:71], v[180:183], v[220:223], v[68:71]
  ds_read_b64_tr_b16 v[162:163], v241 offset:34816
  v_mfma_f32_16x16x32_bf16 v[72:75], v[180:183], v[224:227], v[72:75]
  ds_read_b64_tr_b16 v[164:165], v242 offset:32768
  v_mfma_f32_16x16x32_bf16 v[76:79], v[180:183], v[228:231], v[76:79]
  ds_read_b64_tr_b16 v[166:167], v242 offset:34816
  v_mfma_f32_16x16x32_bf16 v[80:83], v[184:187], v[216:219], v[80:83]
  s_add_u32 m0, s57, 0
  s_add_u32 s28, s54, s53
  buffer_load_dwordx4 v250, s[32:35], s28 offen lds
  s_add_u32 m0, s57, 1024
  s_add_u32 s28, s54, s53
  s_add_u32 s28, s28, 9216
  buffer_load_dwordx4 v251, s[32:35], s28 offen lds
  s_cmp_lg_u32 s25, 0
  s_cbranch_scc1 k1c_7
  s_mov_b32 m0, 65536
  s_add_u32 s28, s54, s56
  buffer_load_dwordx4 v250, s[32:35], s28 offen lds
  k1c_7:
  v_mfma_f32_16x16x32_bf16 v[84:87], v[184:187], v[220:223], v[84:87]
  v_mfma_f32_16x16x32_bf16 v[88:91], v[184:187], v[224:227], v[88:91]
  v_mfma_f32_16x16x32_bf16 v[92:95], v[184:187], v[228:231], v[92:95]
  v_mfma_f32_16x16x32_bf16 v[96:99], v[188:191], v[216:219], v[96:99]
  v_mfma_f32_16x16x32_bf16 v[100:103], v[188:191], v[220:223], v[100:103]
  v_mfma_f32_16x16x32_bf16 v[104:107], v[188:191], v[224:227], v[104:107]
  v_mfma_f32_16x16x32_bf16 v[108:111], v[188:191], v[228:231], v[108:111]
  v_mfma_f32_16x16x32_bf16 v[112:115], v[192:195], v[216:219], v[112:115]
  v_mfma_f32_16x16x32_bf16 v[116:119], v[192:195], v[220:223], v[116:119]
  v_mfma_f32_16x16x32_bf16 v[120:123], v[192:195], v[224:227], v[120:123]
  v_mfma_f32_16x16x32_bf16 v[124:127], v[192:195], v[228:231], v[124:127]
  s_waitcnt vmcnt(4) lgkmcnt(0)
  s_barrier
  v_mfma_f32_16x16x32_bf16 v[16:19], v[140:143], v[196:199], v[16:19]
  ds_read_b128 v[216:219], v244 offset:18432
  v_mfma_f32_16x16x32_bf16 v[20:23], v[140:143], v[200:203], v[20:23]
  ds_read_b128 v[220:223], v244 offset:20480
  v_mfma_f32_16x16x32_bf16 v[24:27], v[140:143], v[204:207], v[24:27]
  ds_read_b128 v[224:227], v244 offset:22528
  v_mfma_f32_16x16x32_bf16 v[28:31], v[140:143], v[208:211], v[28:31]
  ds_read_b128 v[228:231], v244 offset:24576
  v_mfma_f32_16x16x32_bf16 v[128:131], v[140:143], v[212:215], v[128:131]
  ds_read_b128 v[232:235], v246 offset:18432
  v_mfma_f32_16x16x32_bf16 v[32:35], v[144:147], v[196:199], v[32:35]
  ds_read_b64_tr_b16 v[168:169], v236 offset:49152
  v_mfma_f32_16x16x32_bf16 v[36:39], v[144:147], v[200:203], v[36:39]
  ds_read_b64_tr_b16 v[170:171], v236 offset:51200
  v_mfma_f32_16x16x32_bf16 v[40:43], v[144:147], v[204:207], v[40:43]
  ds_read_b64_tr_b16 v[172:173], v237 offset:49152
  v_mfma_f32_16x16x32_bf16 v[44:47], v[144:147], v[208:211], v[44:47]
  ds_read_b64_tr_b16 v[174:175], v237 offset:51200
  v_mfma_f32_16x16x32_bf16 v[132:135], v[144:147], v[212:215], v[132:135]
  ds_read_b64_tr_b16 v[176:177], v238 offset:49152
  v_mfma_f32_16x16x32_bf16 v[48:51], v[148:151], v[196:199], v[48:51]
  ds_read_b64_tr_b16 v[178:179], v238 offset:51200
  v_mfma_f32_16x16x32_bf16 v[52:55], v[148:151], v[200:203], v[52:55]
  ds_read_b64_tr_b16 v[180:181], v239 offset:49152
  v_mfma_f32_16x16x32_bf16 v[56:59], v[148:151], v[204:207], v[56:59]
  ds_read_b64_tr_b16 v[182:183], v239 offset:51200
  v_mfma_f32_16x16x32_bf16 v[60:63], v[148:151], v[208:211], v[60:63]
  ds_read_b64_tr_b16 v[184:185], v240 offset:49152
  v_mfma_f32_16x16x32_bf16 v[136:139], v[148:151], v[212:215], v[136:139]
  ds_read_b64_tr_b16 v[186:187], v240 offset:51200
  v_mfma_f32_16x16x32_bf16 v[64:67], v[152:155], v[196:199], v[64:67]
  ds_read_b64_tr_b16 v[188:189], v241 offset:49152
  v_mfma_f32_16x16x32_bf16 v[68:71], v[152:155], v[200:203], v[68:71]
  ds_read_b64_tr_b16 v[190:191], v241 offset:51200
  v_mfma_f32_16x16x32_bf16 v[72:75], v[152:155], v[204:207], v[72:75]
  ds_read_b64_tr_b16 v[192:193], v242 offset:49152
  v_mfma_f32_16x16x32_bf16 v[76:79], v[152:155], v[208:211], v[76:79]
  ds_read_b64_tr_b16 v[194:195], v242 offset:51200
  v_mfma_f32_16x16x32_bf16 v[80:83], v[156:159], v[196:199], v[80:83]
  s_add_u32 m0, s57, 8192
  s_add_u32 s28, s54, s53
  s_add_u32 s28, s28, 73728
  buffer_load_dwordx4 v250, s[32:35], s28 offen lds
  s_add_u32 m0, s57, 9216
  s_add_u32 s28, s54, s53
  s_add_u32 s28, s28, 82944
  buffer_load_dwordx4 v251, s[32:35], s28 offen lds
  s_cmp_lg_u32 s25, 0
  s_cbranch_scc1 k1c_8
  s_mov_b32 m0, 66560
  s_add_u32 s28, s54, s56
  s_add_u32 s28, s28, 9216
  buffer_load_dwordx4 v251, s[32:35], s28 offen lds
  k1c_8:
  s_add_u32 s54, s54, 128
  s_cmp_eq_u32 s54, 1152
  s_cselect_b32 s54, 0, s54
  v_mfma_f32_16x16x32_bf16 v[84:87], v[156:159], v[200:203], v[84:87]
  v_mfma_f32_16x16x32_bf16 v[88:91], v[156:159], v[204:207], v[88:91]
  v_mfma_f32_16x16x32_bf16 v[92:95], v[156:159], v[208:211], v[92:95]
  v_mfma_f32_16x16x32_bf16 v[96:99], v[160:163], v[196:199], v[96:99]
  v_mfma_f32_16x16x32_bf16 v[100:103], v[160:163], v[200:203], v[100:103]
  v_mfma_f32_16x16x32_bf16 v[104:107], v[160:163], v[204:207], v[104:107]
  v_mfma_f32_16x16x32_bf16 v[108:111], v[160:163], v[208:211], v[108:111]
  v_mfma_f32_16x16x32_bf16 v[112:115], v[164:167], v[196:199], v[112:115]
  v_mfma_f32_16x16x32_bf16 v[116:119], v[164:167], v[200:203], v[116:119]
  v_mfma_f32_16x16x32_bf16 v[120:123], v[164:167], v[204:207], v[120:123]
  v_mfma_f32_16x16x32_bf16 v[124:127], v[164:167], v[208:211], v[124:127]
  s_waitcnt vmcnt(4) lgkmcnt(0)
  s_barrier
  v_mfma_f32_16x16x32_bf16 v[16:19], v[168:171], v[216:219], v[16:19]
  ds_read_b128 v[196:199], v243 offset:36864
  v_mfma_f32_16x16x32_bf16 v[20:23], v[168:171], v[220:223], v[20:23]
  ds_read_b128 v[200:203], v243 offset:38912
  v_mfma_f32_16x16x32_bf16 v[24:27], v[168:171], v[224:227], v[24:27]
  ds_read_b128 v[204:207], v243 offset:40960
  v_mfma_f32_16x16x32_bf16 v[28:31], v[168:171], v[228:231], v[28:31]
  ds_read_b128 v[208:211], v243 offset:43008
  v_mfma_f32_16x16x32_bf16 v[128:131], v[168:171], v[232:235], v[128:131]
  ds_read_b128 v[212:215], v245 offset:36864
  v_mfma_f32_16x16x32_bf16 v[32:35], v[172:175], v[216:219], v[32:35]
  ds_read_b64_tr_b16 v[140:141], v236 offset:0
  v_mfma_f32_16x16x32_bf16 v[36:39], v[172:175], v[220:223], v[36:39]
  ds_read_b64_tr_b16 v[142:143], v236 offset:2048
  v_mfma_f32_16x16x32_bf16 v[40:43], v[172:175], v[224:227], v[40:43]
  ds_read_b64_tr_b16 v[144:145], v237 offset:0
  v_mfma_f32_16x16x32_bf16 v[44:47], v[172:175], v[228:231], v[44:47]
  ds_read_b64_tr_b16 v[146:147], v237 offset:2048
  v_mfma_f32_16x16x32_bf16 v[132:135], v[172:175], v[232:235], v[132:135]
  ds_read_b64_tr_b16 v[148:149], v238 offset:0
  v_mfma_f32_16x16x32_bf16 v[48:51], v[176:179], v[216:219], v[48:51]
  ds_read_b64_tr_b16 v[150:151], v238 offset:2048
  v_mfma_f32_16x16x32_bf16 v[52:55], v[176:179], v[220:223], v[52:55]
  ds_read_b64_tr_b16 v[152:153], v239 offset:0
  v_mfma_f32_16x16x32_bf16 v[56:59], v[176:179], v[224:227], v[56:59]
  ds_read_b64_tr_b16 v[154:155], v239 offset:2048
  v_mfma_f32_16x16x32_bf16 v[60:63], v[176:179], v[228:231], v[60:63]
  ds_read_b64_tr_b16 v[156:157], v240 offset:0
  v_mfma_f32_16x16x32_bf16 v[136:139], v[176:179], v[232:235], v[136:139]
  ds_read_b64_tr_b16 v[158:159], v240 offset:2048
  v_mfma_f32_16x16x32_bf16 v[64:67], v[180:183], v[216:219], v[64:67]
  ds_read_b64_tr_b16 v[160:161], v241 offset:0
  v_mfma_f32_16x16x32_bf16 v[68:71], v[180:183], v[220:223], v[68:71]
  ds_read_b64_tr_b16 v[162:163], v241 offset:2048
  v_mfma_f32_16x16x32_bf16 v[72:75], v[180:183], v[224:227], v[72:75]
  ds_read_b64_tr_b16 v[164:165], v242 offset:0
  v_mfma_f32_16x16x32_bf16 v[76:79], v[180:183], v[228:231], v[76:79]
  ds_read_b64_tr_b16 v[166:167], v242 offset:2048
  v_mfma_f32_16x16x32_bf16 v[80:83], v[184:187], v[216:219], v[80:83]
  s_add_u32 m0, s57, 18432
  s_add_u32 s28, s54, s53
  buffer_load_dwordx4 v250, s[32:35], s28 offen lds
  s_add_u32 m0, s57, 19456
  s_add_u32 s28, s54, s53
  s_add_u32 s28, s28, 9216
  buffer_load_dwordx4 v251, s[32:35], s28 offen lds
  s_cmp_lg_u32 s25, 0
  s_cbranch_scc1 k1c_9
  s_mov_b32 m0, 83968
  s_add_u32 s28, s54, s56
  buffer_load_dwordx4 v250, s[32:35], s28 offen lds
  k1c_9:
  v_mfma_f32_16x16x32_bf16 v[84:87], v[184:187], v[220:223], v[84:87]
  v_mfma_f32_16x16x32_bf16 v[88:91], v[184:187], v[224:227], v[88:91]
  v_mfma_f32_16x16x32_bf16 v[92:95], v[184:187], v[228:231], v[92:95]
  v_mfma_f32_16x16x32_bf16 v[96:99], v[188:191], v[216:219], v[96:99]
  v_mfma_f32_16x16x32_bf16 v[100:103], v[188:191], v[220:223], v[100:103]
  v_mfma_f32_16x16x32_bf16 v[104:107], v[188:191], v[224:227], v[104:107]
  v_mfma_f32_16x16x32_bf16 v[108:111], v[188:191], v[228:231], v[108:111]
  v_mfma_f32_16x16x32_bf16 v[112:115], v[192:195], v[216:219], v[112:115]
  v_mfma_f32_16x16x32_bf16 v[116:119], v[192:195], v[220:223], v[116:119]
  v_mfma_f32_16x16x32_bf16 v[120:123], v[192:195], v[224:227], v[120:123]
  v_mfma_f32_16x16x32_bf16 v[124:127], v[192:195], v[228:231], v[124:127]
  s_waitcnt vmcnt(4) lgkmcnt(0)
  s_barrier
  v_mfma_f32_16x16x32_bf16 v[16:19], v[140:143], v[196:199], v[16:19]
  ds_read_b128 v[216:219], v244 offset:36864
  v_mfma_f32_16x16x32_bf16 v[20:23], v[140:143], v[200:203], v[20:23]
  ds_read_b128 v[220:223], v244 offset:38912
  v_mfma_f32_16x16x32_bf16 v[24:27], v[140:143], v[204:207], v[24:27]
  ds_read_b128 v[224:227], v244 offset:40960
  v_mfma_f32_16x16x32_bf16 v[28:31], v[140:143], v[208:211], v[28:31]
  ds_read_b128 v[228:231], v244 offset:43008
  v_mfma_f32_16x16x32_bf16 v[128:131], v[140:143], v[212:215], v[128:131]
  ds_read_b128 v[232:235], v246 offset:36864
  v_mfma_f32_16x16x32_bf16 v[32:35], v[144:147], v[196:199], v[32:35]
  ds_read_b64_tr_b16 v[168:169], v236 offset:16384
  v_mfma_f32_16x16x32_bf16 v[36:39], v[144:147], v[200:203], v[36:39]
  ds_read_b64_tr_b16 v[170:171], v236 offset:18432
  v_mfma_f32_16x16x32_bf16 v[40:43], v[144:147], v[204:207], v[40:43]
  ds_read_b64_tr_b16 v[172:173], v237 offset:16384
  v_mfma_f32_16x16x32_bf16 v[44:47], v[144:147], v[208:211], v[44:47]
  ds_read_b64_tr_b16 v[174:175], v237 offset:18432
  v_mfma_f32_16x16x32_bf16 v[132:135], v[144:147], v[212:215], v[132:135]
  ds_read_b64_tr_b16 v[176:177], v238 offset:16384
  v_mfma_f32_16x16x32_bf16 v[48:51], v[148:151], v[196:199], v[48:51]
  ds_read_b64_tr_b16 v[178:179], v238 offset:18432
  v_mfma_f32_16x16x32_bf16 v[52:55], v[148:151], v[200:203], v[52:55]
  ds_read_b64_tr_b16 v[180:181], v239 offset:16384
  v_mfma_f32_16x16x32_bf16 v[56:59], v[148:151], v[204:207], v[56:59]
  ds_read_b64_tr_b16 v[182:183], v239 offset:18432
  v_mfma_f32_16x16x32_bf16 v[60:63], v[148:151], v[208:211], v[60:63]
  ds_read_b64_tr_b16 v[184:185], v240 offset:16384
  v_mfma_f32_16x16x32_bf16 v[136:139], v[148:151], v[212:215], v[136:139]
  ds_read_b64_tr_b16 v[186:187], v240 offset:18432
  v_mfma_f32_16x16x32_bf16 v[64:67], v[152:155], v[196:199], v[64:67]
  ds_read_b64_tr_b16 v[188:189], v241 offset:16384
  v_mfma_f32_16x16x32_bf16 v[68:71], v[152:155], v[200:203], v[68:71]
  ds_read_b64_tr_b16 v[190:191], v241 offset:18432
  v_mfma_f32_16x16x32_bf16 v[72:75], v[152:155], v[204:207], v[72:75]
  ds_read_b64_tr_b16 v[192:193], v242 offset:16384
  v_mfma_f32_16x16x32_bf16 v[76:79], v[152:155], v[208:211], v[76:79]
  ds_read_b64_tr_b16 v[194:195], v242 offset:18432
  v_mfma_f32_16x16x32_bf16 v[80:83], v[156:159], v[196:199], v[80:83]
  s_add_u32 m0, s57, 26624
  s_add_u32 s28, s54, s53
  s_add_u32 s28, s28, 73728
  buffer_load_dwordx4 v250, s[32:35], s28 offen lds
  s_add_u32 m0, s57, 27648
  s_add_u32 s28, s54, s53
  s_add_u32 s28, s28, 82944
  buffer_load_dwordx4 v251, s[32:35], s28 offen lds
  s_cmp_lg_u32 s25, 0
  s_cbranch_scc1 k1c_10
  s_mov_b32 m0, 84992
  s_add_u32 s28, s54, s56
  s_add_u32 s28, s28, 9216
  buffer_load_dwordx4 v251, s[32:35], s28 offen lds
  k1c_10:
  s_add_u32 s54, s54, 128
  s_cmp_eq_u32 s54, 1152
  s_cselect_b32 s54, 0, s54
  v_mfma_f32_16x16x32_bf16 v[84:87], v[156:159], v[200:203], v[84:87]
  v_mfma_f32_16x16x32_bf16 v[88:91], v[156:159], v[204:207], v[88:91]
  v_mfma_f32_16x16x32_bf16 v[92:95], v[156:159], v[208:211], v[92:95]
  v_mfma_f32_16x16x32_bf16 v[96:99], v[160:163], v[196:199], v[96:99]
  v_mfma_f32_16x16x32_bf16 v[100:103], v[160:163], v[200:203], v[100:103]
  v_mfma_f32_16x16x32_bf16 v[104:107], v[160:163], v[204:207], v[104:107]
  v_mfma_f32_16x16x32_bf16 v[108:111], v[160:163], v[208:211], v[108:111]
  v_mfma_f32_16x16x32_bf16 v[112:115], v[164:167], v[196:199], v[112:115]
  v_mfma_f32_16x16x32_bf16 v[116:119], v[164:167], v[200:203], v[116:119]
  v_mfma_f32_16x16x32_bf16 v[120:123], v[164:167], v[204:207], v[120:123]
  v_mfma_f32_16x16x32_bf16 v[124:127], v[164:167], v[208:211], v[124:127]
  s_waitcnt vmcnt(4) lgkmcnt(0)
  s_barrier
  v_mfma_f32_16x16x32_bf16 v[16:19], v[168:171], v[216:219], v[16:19]
  ds_read_b128 v[196:199], v243 offset:0
  v_mfma_f32_16x16x32_bf16 v[20:23], v[168:171], v[220:223], v[20:23]
  ds_read_b128 v[200:203], v243 offset:2048
  v_mfma_f32_16x16x32_bf16 v[24:27], v[168:171], v[224:227], v[24:27]
  ds_read_b128 v[204:207], v243 offset:4096
  v_mfma_f32_16x16x32_bf16 v[28:31], v[168:171], v[228:231], v[28:31]
  ds_read_b128 v[208:211], v243 offset:6144
  v_mfma_f32_16x16x32_bf16 v[128:131], v[168:171], v[232:235], v[128:131]
  ds_read_b128 v[212:215], v245 offset:0
  v_mfma_f32_16x16x32_bf16 v[32:35], v[172:175], v[216:219], v[32:35]
  ds_read_b64_tr_b16 v[140:141], v236 offset:32768
  v_mfma_f32_16x16x32_bf16 v[36:39], v[172:175], v[220:223], v[36:39]
  ds_read_b64_tr_b16 v[142:143], v236 offset:34816
  v_mfma_f32_16x16x32_bf16 v[40:43], v[172:175], v[224:227], v[40:43]
  ds_read_b64_tr_b16 v[144:145], v237 offset:32768
  v_mfma_f32_16x16x32_bf16 v[44:47], v[172:175], v[228:231], v[44:47]
  ds_read_b64_tr_b16 v[146:147], v237 offset:34816
  v_mfma_f32_16x16x32_bf16 v[132:135], v[172:175], v[232:235], v[132:135]
  ds_read_b64_tr_b16 v[148:149], v238 offset:32768
  v_mfma_f32_16x16x32_bf16 v[48:51], v[176:179], v[216:219], v[48:51]
  ds_read_b64_tr_b16 v[150:151], v238 offset:34816
  v_mfma_f32_16x16x32_bf16 v[52:55], v[176:179], v[220:223], v[52:55]
  ds_read_b64_tr_b16 v[152:153], v239 offset:32768
  v_mfma_f32_16x16x32_bf16 v[56:59], v[176:179], v[224:227], v[56:59]
  ds_read_b64_tr_b16 v[154:155], v239 offset:34816
  v_mfma_f32_16x16x32_bf16 v[60:63], v[176:179], v[228:231], v[60:63]
  ds_read_b64_tr_b16 v[156:157], v240 offset:32768
  v_mfma_f32_16x16x32_bf16 v[136:139], v[176:179], v[232:235], v[136:139]
  ds_read_b64_tr_b16 v[158:159], v240 offset:34816
  v_mfma_f32_16x16x32_bf16 v[64:67], v[180:183], v[216:219], v[64:67]
  ds_read_b64_tr_b16 v[160:161], v241 offset:32768
  v_mfma_f32_16x16x32_bf16 v[68:71], v[180:183], v[220:223], v[68:71]
  ds_read_b64_tr_b16 v[162:163], v241 offset:34816
  v_mfma_f32_16x16x32_bf16 v[72:75], v[180:183], v[224:227], v[72:75]
  ds_read_b64_tr_b16 v[164:165], v242 offset:32768
  v_mfma_f32_16x16x32_bf16 v[76:79], v[180:183], v[228:231], v[76:79]
  ds_read_b64_tr_b16 v[166:167], v242 offset:34816
  v_mfma_f32_16x16x32_bf16 v[80:83], v[184:187], v[216:219], v[80:83]
  s_add_u32 m0, s57, 36864
  s_add_u32 s28, s54, s53
  buffer_load_dwordx4 v250, s[32:35], s28 offen lds
  s_add_u32 m0, s57, 37888
  s_add_u32 s28, s54, s53
  s_add_u32 s28, s28, 9216
  buffer_load_dwordx4 v251, s[32:35], s28 offen lds
  s_cmp_lg_u32 s25, 0
  s_cbranch_scc1 k1c_11
  s_mov_b32 m0, 102400
  s_add_u32 s28, s54, s56
  buffer_load_dwordx4 v250, s[32:35], s28 offen lds
  k1c_11:
  v_mfma_f32_16x16x32_bf16 v[84:87], v[184:187], v[220:223], v[84:87]
  v_mfma_f32_16x16x32_bf16 v[88:91], v[184:187], v[224:227], v[88:91]
  v_mfma_f32_16x16x32_bf16 v[92:95], v[184:187], v[228:231], v[92:95]
  v_mfma_f32_16x16x32_bf16 v[96:99], v[188:191], v[216:219], v[96:99]
  v_mfma_f32_16x16x32_bf16 v[100:103], v[188:191], v[220:223], v[100:103]
  v_mfma_f32_16x16x32_bf16 v[104:107], v[188:191], v[224:227], v[104:107]
  v_mfma_f32_16x16x32_bf16 v[108:111], v[188:191], v[228:231], v[108:111]
  v_mfma_f32_16x16x32_bf16 v[112:115], v[192:195], v[216:219], v[112:115]
  v_mfma_f32_16x16x32_bf16 v[116:119], v[192:195], v[220:223], v[116:119]
  v_mfma_f32_16x16x32_bf16 v[120:123], v[192:195], v[224:227], v[120:123]
  v_mfma_f32_16x16x32_bf16 v[124:127], v[192:195], v[228:231], v[124:127]
  s_waitcnt vmcnt(4) lgkmcnt(0)
  s_barrier
  v_mfma_f32_16x16x32_bf16 v[16:19], v[140:143], v[196:199], v[16:19]
  ds_read_b128 v[216:219], v244 offset:0
  v_mfma_f32_16x16x32_bf16 v[20:23], v[140:143], v[200:203], v[20:23]
  ds_read_b128 v[220:223], v244 offset:2048
  v_mfma_f32_16x16x32_bf16 v[24:27], v[140:143], v[204:207], v[24:27]
  ds_read_b128 v[224:227], v244 offset:4096
  v_mfma_f32_16x16x32_bf16 v[28:31], v[140:143], v[208:211], v[28:31]
  ds_read_b128 v[228:231], v244 offset:6144
  v_mfma_f32_16x16x32_bf16 v[128:131], v[140:143], v[212:215], v[128:131]
  ds_read_b128 v[232:235], v246 offset:0
  v_mfma_f32_16x16x32_bf16 v[32:35], v[144:147], v[196:199], v[32:35]
  ds_read_b64_tr_b16 v[168:169], v236 offset:49152
  v_mfma_f32_16x16x32_bf16 v[36:39], v[144:147], v[200:203], v[36:39]
  ds_read_b64_tr_b16 v[170:171], v236 offset:51200
  v_mfma_f32_16x16x32_bf16 v[40:43], v[144:147], v[204:207], v[40:43]
  ds_read_b64_tr_b16 v[172:173], v237 offset:49152
  v_mfma_f32_16x16x32_bf16 v[44:47], v[144:147], v[208:211], v[44:47]
  ds_read_b64_tr_b16 v[174:175], v237 offset:51200
  v_mfma_f32_16x16x32_bf16 v[132:135], v[144:147], v[212:215], v[132:135]
  ds_read_b64_tr_b16 v[176:177], v238 offset:49152
  v_mfma_f32_16x16x32_bf16 v[48:51], v[148:151], v[196:199], v[48:51]
  ds_read_b64_tr_b16 v[178:179], v238 offset:51200
  v_mfma_f32_16x16x32_bf16 v[52:55], v[148:151], v[200:203], v[52:55]
  ds_read_b64_tr_b16 v[180:181], v239 offset:49152
  v_mfma_f32_16x16x32_bf16 v[56:59], v[148:151], v[204:207], v[56:59]
  ds_read_b64_tr_b16 v[182:183], v239 offset:51200
  v_mfma_f32_16x16x32_bf16 v[60:63], v[148:151], v[208:211], v[60:63]
  ds_read_b64_tr_b16 v[184:185], v240 offset:49152
  v_mfma_f32_16x16x32_bf16 v[136:139], v[148:151], v[212:215], v[136:139]
  ds_read_b64_tr_b16 v[186:187], v240 offset:51200
  v_mfma_f32_16x16x32_bf16 v[64:67], v[152:155], v[196:199], v[64:67]
  ds_read_b64_tr_b16 v[188:189], v241 offset:49152
  v_mfma_f32_16x16x32_bf16 v[68:71], v[152:155], v[200:203], v[68:71]
  ds_read_b64_tr_b16 v[190:191], v241 offset:51200
  v_mfma_f32_16x16x32_bf16 v[72:75], v[152:155], v[204:207], v[72:75]
  ds_read_b64_tr_b16 v[192:193], v242 offset:49152
  v_mfma_f32_16x16x32_bf16 v[76:79], v[152:155], v[208:211], v[76:79]
  ds_read_b64_tr_b16 v[194:195], v242 offset:51200
  v_mfma_f32_16x16x32_bf16 v[80:83], v[156:159], v[196:199], v[80:83]
  s_add_u32 m0, s57, 45056
  s_add_u32 s28, s54, s53
  s_add_u32 s28, s28, 73728
  buffer_load_dwordx4 v250, s[32:35], s28 offen lds
  s_add_u32 m0, s57, 46080
  s_add_u32 s28, s54, s53
  s_add_u32 s28, s28, 82944
  buffer_load_dwordx4 v251, s[32:35], s28 offen lds
  s_cmp_lg_u32 s25, 0
  s_cbranch_scc1 k1c_12
  s_mov_b32 m0, 103424
  s_add_u32 s28, s54, s56
  s_add_u32 s28, s28, 9216
  buffer_load_dwordx4 v251, s[32:35], s28 offen lds
  k1c_12:
  s_add_u32 s54, s54, 128
  s_cmp_eq_u32 s54, 1152
  s_cselect_b32 s54, 0, s54
  v_mfma_f32_16x16x32_bf16 v[84:87], v[156:159], v[200:203], v[84:87]
  v_mfma_f32_16x16x32_bf16 v[88:91], v[156:159], v[204:207], v[88:91]
  v_mfma_f32_16x16x32_bf16 v[92:95], v[156:159], v[208:211], v[92:95]
  v_mfma_f32_16x16x32_bf16 v[96:99], v[160:163], v[196:199], v[96:99]
  v_mfma_f32_16x16x32_bf16 v[100:103], v[160:163], v[200:203], v[100:103]
  v_mfma_f32_16x16x32_bf16 v[104:107], v[160:163], v[204:207], v[104:107]
  v_mfma_f32_16x16x32_bf16 v[108:111], v[160:163], v[208:211], v[108:111]
  v_mfma_f32_16x16x32_bf16 v[112:115], v[164:167], v[196:199], v[112:115]
  v_mfma_f32_16x16x32_bf16 v[116:119], v[164:167], v[200:203], v[116:119]
  v_mfma_f32_16x16x32_bf16 v[120:123], v[164:167], v[204:207], v[120:123]
  v_mfma_f32_16x16x32_bf16 v[124:127], v[164:167], v[208:211], v[124:127]
  s_waitcnt vmcnt(4) lgkmcnt(0)
  s_barrier
  v_mfma_f32_16x16x32_bf16 v[16:19], v[168:171], v[216:219], v[16:19]
  ds_read_b128 v[196:199], v243 offset:18432
  v_mfma_f32_16x16x32_bf16 v[20:23], v[168:171], v[220:223], v[20:23]
  ds_read_b128 v[200:203], v243 offset:20480
  v_mfma_f32_16x16x32_bf16 v[24:27], v[168:171], v[224:227], v[24:27]
  ds_read_b128 v[204:207], v243 offset:22528
  v_mfma_f32_16x16x32_bf16 v[28:31], v[168:171], v[228:231], v[28:31]
  ds_read_b128 v[208:211], v243 offset:24576
  v_mfma_f32_16x16x32_bf16 v[128:131], v[168:171], v[232:235], v[128:131]
  ds_read_b128 v[212:215], v245 offset:18432
  v_mfma_f32_16x16x32_bf16 v[32:35], v[172:175], v[216:219], v[32:35]
  ds_read_b64_tr_b16 v[140:141], v236 offset:0
  v_mfma_f32_16x16x32_bf16 v[36:39], v[172:175], v[220:223], v[36:39]
  ds_read_b64_tr_b16 v[142:143], v236 offset:2048
  v_mfma_f32_16x16x32_bf16 v[40:43], v[172:175], v[224:227], v[40:43]
  ds_read_b64_tr_b16 v[144:145], v237 offset:0
  v_mfma_f32_16x16x32_bf16 v[44:47], v[172:175], v[228:231], v[44:47]
  ds_read_b64_tr_b16 v[146:147], v237 offset:2048
  v_mfma_f32_16x16x32_bf16 v[132:135], v[172:175], v[232:235], v[132:135]
  ds_read_b64_tr_b16 v[148:149], v238 offset:0
  v_mfma_f32_16x16x32_bf16 v[48:51], v[176:179], v[216:219], v[48:51]
  ds_read_b64_tr_b16 v[150:151], v238 offset:2048
  v_mfma_f32_16x16x32_bf16 v[52:55], v[176:179], v[220:223], v[52:55]
  ds_read_b64_tr_b16 v[152:153], v239 offset:0
  v_mfma_f32_16x16x32_bf16 v[56:59], v[176:179], v[224:227], v[56:59]
  ds_read_b64_tr_b16 v[154:155], v239 offset:2048
  v_mfma_f32_16x16x32_bf16 v[60:63], v[176:179], v[228:231], v[60:63]
  ds_read_b64_tr_b16 v[156:157], v240 offset:0
  v_mfma_f32_16x16x32_bf16 v[136:139], v[176:179], v[232:235], v[136:139]
  ds_read_b64_tr_b16 v[158:159], v240 offset:2048
  v_mfma_f32_16x16x32_bf16 v[64:67], v[180:183], v[216:219], v[64:67]
  ds_read_b64_tr_b16 v[160:161], v241 offset:0
  v_mfma_f32_16x16x32_bf16 v[68:71], v[180:183], v[220:223], v[68:71]
  ds_read_b64_tr_b16 v[162:163], v241 offset:2048
  v_mfma_f32_16x16x32_bf16 v[72:75], v[180:183], v[224:227], v[72:75]
  ds_read_b64_tr_b16 v[164:165], v242 offset:0
  v_mfma_f32_16x16x32_bf16 v[76:79], v[180:183], v[228:231], v[76:79]
  ds_read_b64_tr_b16 v[166:167], v242 offset:2048
  v_mfma_f32_16x16x32_bf16 v[80:83], v[184:187], v[216:219], v[80:83]
  s_add_u32 m0, s57, 0
  s_add_u32 s28, s54, s53
  buffer_load_dwordx4 v250, s[32:35], s28 offen lds
  s_add_u32 m0, s57, 1024
  s_add_u32 s28, s54, s53
  s_add_u32 s28, s28, 9216
  buffer_load_dwordx4 v251, s[32:35], s28 offen lds
  s_cmp_lg_u32 s25, 0
  s_cbranch_scc1 k1c_13
  s_mov_b32 m0, 65536
  s_add_u32 s28, s54, s56
  buffer_load_dwordx4 v250, s[32:35], s28 offen lds
  k1c_13:
  v_mfma_f32_16x16x32_bf16 v[84:87], v[184:187], v[220:223], v[84:87]
  v_mfma_f32_16x16x32_bf16 v[88:91], v[184:187], v[224:227], v[88:91]
  v_mfma_f32_16x16x32_bf16 v[92:95], v[184:187], v[228:231], v[92:95]
  v_mfma_f32_16x16x32_bf16 v[96:99], v[188:191], v[216:219], v[96:99]
  v_mfma_f32_16x16x32_bf16 v[100:103], v[188:191], v[220:223], v[100:103]
  v_mfma_f32_16x16x32_bf16 v[104:107], v[188:191], v[224:227], v[104:107]
  v_mfma_f32_16x16x32_bf16 v[108:111], v[188:191], v[228:231], v[108:111]
  v_mfma_f32_16x16x32_bf16 v[112:115], v[192:195], v[216:219], v[112:115]
  v_mfma_f32_16x16x32_bf16 v[116:119], v[192:195], v[220:223], v[116:119]
  v_mfma_f32_16x16x32_bf16 v[120:123], v[192:195], v[224:227], v[120:123]
  v_mfma_f32_16x16x32_bf16 v[124:127], v[192:195], v[228:231], v[124:127]
  s_waitcnt vmcnt(4) lgkmcnt(0)
  s_barrier
  v_mfma_f32_16x16x32_bf16 v[16:19], v[140:143], v[196:199], v[16:19]
  ds_read_b128 v[216:219], v244 offset:18432
  v_mfma_f32_16x16x32_bf16 v[20:23], v[140:143], v[200:203], v[20:23]
  ds_read_b128 v[220:223], v244 offset:20480
  v_mfma_f32_16x16x32_bf16 v[24:27], v[140:143], v[204:207], v[24:27]
  ds_read_b128 v[224:227], v244 offset:22528
  v_mfma_f32_16x16x32_bf16 v[28:31], v[140:143], v[208:211], v[28:31]
  ds_read_b128 v[228:231], v244 offset:24576
  v_mfma_f32_16x16x32_bf16 v[128:131], v[140:143], v[212:215], v[128:131]
  ds_read_b128 v[232:235], v246 offset:18432
  v_mfma_f32_16x16x32_bf16 v[32:35], v[144:147], v[196:199], v[32:35]
  ds_read_b64_tr_b16 v[168:169], v236 offset:16384
  v_mfma_f32_16x16x32_bf16 v[36:39], v[144:147], v[200:203], v[36:39]
  ds_read_b64_tr_b16 v[170:171], v236 offset:18432
  v_mfma_f32_16x16x32_bf16 v[40:43], v[144:147], v[204:207], v[40:43]
  ds_read_b64_tr_b16 v[172:173], v237 offset:16384
  v_mfma_f32_16x16x32_bf16 v[44:47], v[144:147], v[208:211], v[44:47]
  ds_read_b64_tr_b16 v[174:175], v237 offset:18432
  v_mfma_f32_16x16x32_bf16 v[132:135], v[144:147], v[212:215], v[132:135]
  ds_read_b64_tr_b16 v[176:177], v238 offset:16384
  v_mfma_f32_16x16x32_bf16 v[48:51], v[148:151], v[196:199], v[48:51]
  ds_read_b64_tr_b16 v[178:179], v238 offset:18432
  v_mfma_f32_16x16x32_bf16 v[52:55], v[148:151], v[200:203], v[52:55]
  ds_read_b64_tr_b16 v[180:181], v239 offset:16384
  v_mfma_f32_16x16x32_bf16 v[56:59], v[148:151], v[204:207], v[56:59]
  ds_read_b64_tr_b16 v[182:183], v239 offset:18432
  v_mfma_f32_16x16x32_bf16 v[60:63], v[148:151], v[208:211], v[60:63]
  ds_read_b64_tr_b16 v[184:185], v240 offset:16384
  v_mfma_f32_16x16x32_bf16 v[136:139], v[148:151], v[212:215], v[136:139]
  ds_read_b64_tr_b16 v[186:187], v240 offset:18432
  v_mfma_f32_16x16x32_bf16 v[64:67], v[152:155], v[196:199], v[64:67]
  ds_read_b64_tr_b16 v[188:189], v241 offset:16384
  v_mfma_f32_16x16x32_bf16 v[68:71], v[152:155], v[200:203], v[68:71]
  ds_read_b64_tr_b16 v[190:191], v241 offset:18432
  v_mfma_f32_16x16x32_bf16 v[72:75], v[152:155], v[204:207], v[72:75]
  ds_read_b64_tr_b16 v[192:193], v242 offset:16384
  v_mfma_f32_16x16x32_bf16 v[76:79], v[152:155], v[208:211], v[76:79]
  ds_read_b64_tr_b16 v[194:195], v242 offset:18432
  v_mfma_f32_16x16x32_bf16 v[80:83], v[156:159], v[196:199], v[80:83]
  s_add_u32 m0, s57, 8192
  s_add_u32 s28, s54, s53
  s_add_u32 s28, s28, 73728
  buffer_load_dwordx4 v250, s[32:35], s28 offen lds
  s_add_u32 m0, s57, 9216
  s_add_u32 s28, s54, s53
  s_add_u32 s28, s28, 82944
  buffer_load_dwordx4 v251, s[32:35], s28 offen lds
  s_cmp_lg_u32 s25, 0
  s_cbranch_scc1 k1c_14
  s_mov_b32 m0, 66560
  s_add_u32 s28, s54, s56
  s_add_u32 s28, s28, 9216
  buffer_load_dwordx4 v251, s[32:35], s28 offen lds
  k1c_14:
  s_add_u32 s54, s54, 128
  s_cmp_eq_u32 s54, 1152
  s_cselect_b32 s54, 0, s54
  v_mfma_f32_16x16x32_bf16 v[84:87], v[156:159], v[200:203], v[84:87]
  v_mfma_f32_16x16x32_bf16 v[88:91], v[156:159], v[204:207], v[88:91]
  v_mfma_f32_16x16x32_bf16 v[92:95], v[156:159], v[208:211], v[92:95]
  v_mfma_f32_16x16x32_bf16 v[96:99], v[160:163], v[196:199], v[96:99]
  v_mfma_f32_16x16x32_bf16 v[100:103], v[160:163], v[200:203], v[100:103]
  v_mfma_f32_16x16x32_bf16 v[104:107], v[160:163], v[204:207], v[104:107]
  v_mfma_f32_16x16x32_bf16 v[108:111], v[160:163], v[208:211], v[108:111]
  v_mfma_f32_16x16x32_bf16 v[112:115], v[164:167], v[196:199], v[112:115]
  v_mfma_f32_16x16x32_bf16 v[116:119], v[164:167], v[200:203], v[116:119]
  v_mfma_f32_16x16x32_bf16 v[120:123], v[164:167], v[204:207], v[120:123]
  v_mfma_f32_16x16x32_bf16 v[124:127], v[164:167], v[208:211], v[124:127]
  s_waitcnt vmcnt(4) lgkmcnt(0)
  s_barrier
  v_mfma_f32_16x16x32_bf16 v[16:19], v[168:171], v[216:219], v[16:19]
  ds_read_b128 v[196:199], v243 offset:36864
  v_mfma_f32_16x16x32_bf16 v[20:23], v[168:171], v[220:223], v[20:23]
  ds_read_b128 v[200:203], v243 offset:38912
  v_mfma_f32_16x16x32_bf16 v[24:27], v[168:171], v[224:227], v[24:27]
  ds_read_b128 v[204:207], v243 offset:40960
  v_mfma_f32_16x16x32_bf16 v[28:31], v[168:171], v[228:231], v[28:31]
  ds_read_b128 v[208:211], v243 offset:43008
  v_mfma_f32_16x16x32_bf16 v[128:131], v[168:171], v[232:235], v[128:131]
  ds_read_b128 v[212:215], v245 offset:36864
  v_mfma_f32_16x16x32_bf16 v[32:35], v[172:175], v[216:219], v[32:35]
  ds_read_b64_tr_b16 v[140:141], v236 offset:32768
  v_mfma_f32_16x16x32_bf16 v[36:39], v[172:175], v[220:223], v[36:39]
  ds_read_b64_tr_b16 v[142:143], v236 offset:34816
  v_mfma_f32_16x16x32_bf16 v[40:43], v[172:175], v[224:227], v[40:43]
  ds_read_b64_tr_b16 v[144:145], v237 offset:32768
  v_mfma_f32_16x16x32_bf16 v[44:47], v[172:175], v[228:231], v[44:47]
  ds_read_b64_tr_b16 v[146:147], v237 offset:34816
  v_mfma_f32_16x16x32_bf16 v[132:135], v[172:175], v[232:235], v[132:135]
  ds_read_b64_tr_b16 v[148:149], v238 offset:32768
  v_mfma_f32_16x16x32_bf16 v[48:51], v[176:179], v[216:219], v[48:51]
  ds_read_b64_tr_b16 v[150:151], v238 offset:34816
  v_mfma_f32_16x16x32_bf16 v[52:55], v[176:179], v[220:223], v[52:55]
  ds_read_b64_tr_b16 v[152:153], v239 offset:32768
  v_mfma_f32_16x16x32_bf16 v[56:59], v[176:179], v[224:227], v[56:59]
  ds_read_b64_tr_b16 v[154:155], v239 offset:34816
  v_mfma_f32_16x16x32_bf16 v[60:63], v[176:179], v[228:231], v[60:63]
  ds_read_b64_tr_b16 v[156:157], v240 offset:32768
  v_mfma_f32_16x16x32_bf16 v[136:139], v[176:179], v[232:235], v[136:139]
  ds_read_b64_tr_b16 v[158:159], v240 offset:34816
  v_mfma_f32_16x16x32_bf16 v[64:67], v[180:183], v[216:219], v[64:67]
  ds_read_b64_tr_b16 v[160:161], v241 offset:32768
  v_mfma_f32_16x16x32_bf16 v[68:71], v[180:183], v[220:223], v[68:71]
  ds_read_b64_tr_b16 v[162:163], v241 offset:34816
  v_mfma_f32_16x16x32_bf16 v[72:75], v[180:183], v[224:227], v[72:75]
  ds_read_b64_tr_b16 v[164:165], v242 offset:32768
  v_mfma_f32_16x16x32_bf16 v[76:79], v[180:183], v[228:231], v[76:79]
  ds_read_b64_tr_b16 v[166:167], v242 offset:34816
  v_mfma_f32_16x16x32_bf16 v[80:83], v[184:187], v[216:219], v[80:83]
  s_add_u32 m0, s57, 18432
  s_add_u32 s28, s54, s53
  buffer_load_dwordx4 v250, s[32:35], s28 offen lds
  s_add_u32 m0, s57, 19456
  s_add_u32 s28, s54, s53
  s_add_u32 s28, s28, 9216
  buffer_load_dwordx4 v251, s[32:35], s28 offen lds
  s_cmp_lg_u32 s25, 0
  s_cbranch_scc1 k1c_15
  s_mov_b32 m0, 83968
  s_add_u32 s28, s54, s56
  buffer_load_dwordx4 v250, s[32:35], s28 offen lds
  k1c_15:
  v_mfma_f32_16x16x32_bf16 v[84:87], v[184:187], v[220:223], v[84:87]
  v_mfma_f32_16x16x32_bf16 v[88:91], v[184:187], v[224:227], v[88:91]
  v_mfma_f32_16x16x32_bf16 v[92:95], v[184:187], v[228:231], v[92:95]
  v_mfma_f32_16x16x32_bf16 v[96:99], v[188:191], v[216:219], v[96:99]
  v_mfma_f32_16x16x32_bf16 v[100:103], v[188:191], v[220:223], v[100:103]
  v_mfma_f32_16x16x32_bf16 v[104:107], v[188:191], v[224:227], v[104:107]
  v_mfma_f32_16x16x32_bf16 v[108:111], v[188:191], v[228:231], v[108:111]
  v_mfma_f32_16x16x32_bf16 v[112:115], v[192:195], v[216:219], v[112:115]
  v_mfma_f32_16x16x32_bf16 v[116:119], v[192:195], v[220:223], v[116:119]
  v_mfma_f32_16x16x32_bf16 v[120:123], v[192:195], v[224:227], v[120:123]
  v_mfma_f32_16x16x32_bf16 v[124:127], v[192:195], v[228:231], v[124:127]
  s_waitcnt vmcnt(4) lgkmcnt(0)
  s_barrier
  v_mfma_f32_16x16x32_bf16 v[16:19], v[140:143], v[196:199], v[16:19]
  ds_read_b128 v[216:219], v244 offset:36864
  v_mfma_f32_16x16x32_bf16 v[20:23], v[140:143], v[200:203], v[20:23]
  ds_read_b128 v[220:223], v244 offset:38912
  v_mfma_f32_16x16x32_bf16 v[24:27], v[140:143], v[204:207], v[24:27]
  ds_read_b128 v[224:227], v244 offset:40960
  v_mfma_f32_16x16x32_bf16 v[28:31], v[140:143], v[208:211], v[28:31]
  ds_read_b128 v[228:231], v244 offset:43008
  v_mfma_f32_16x16x32_bf16 v[128:131], v[140:143], v[212:215], v[128:131]
  ds_read_b128 v[232:235], v246 offset:36864
  v_mfma_f32_16x16x32_bf16 v[32:35], v[144:147], v[196:199], v[32:35]
  ds_read_b64_tr_b16 v[168:169], v236 offset:49152
  v_mfma_f32_16x16x32_bf16 v[36:39], v[144:147], v[200:203], v[36:39]
  ds_read_b64_tr_b16 v[170:171], v236 offset:51200
  v_mfma_f32_16x16x32_bf16 v[40:43], v[144:147], v[204:207], v[40:43]
  ds_read_b64_tr_b16 v[172:173], v237 offset:49152
  v_mfma_f32_16x16x32_bf16 v[44:47], v[144:147], v[208:211], v[44:47]
  ds_read_b64_tr_b16 v[174:175], v237 offset:51200
  v_mfma_f32_16x16x32_bf16 v[132:135], v[144:147], v[212:215], v[132:135]
  ds_read_b64_tr_b16 v[176:177], v238 offset:49152
  v_mfma_f32_16x16x32_bf16 v[48:51], v[148:151], v[196:199], v[48:51]
  ds_read_b64_tr_b16 v[178:179], v238 offset:51200
  v_mfma_f32_16x16x32_bf16 v[52:55], v[148:151], v[200:203], v[52:55]
  ds_read_b64_tr_b16 v[180:181], v239 offset:49152
  v_mfma_f32_16x16x32_bf16 v[56:59], v[148:151], v[204:207], v[56:59]
  ds_read_b64_tr_b16 v[182:183], v239 offset:51200
  v_mfma_f32_16x16x32_bf16 v[60:63], v[148:151], v[208:211], v[60:63]
  ds_read_b64_tr_b16 v[184:185], v240 offset:49152
  v_mfma_f32_16x16x32_bf16 v[136:139], v[148:151], v[212:215], v[136:139]
  ds_read_b64_tr_b16 v[186:187], v240 offset:51200
  v_mfma_f32_16x16x32_bf16 v[64:67], v[152:155], v[196:199], v[64:67]
  ds_read_b64_tr_b16 v[188:189], v241 offset:49152
  v_mfma_f32_16x16x32_bf16 v[68:71], v[152:155], v[200:203], v[68:71]
  ds_read_b64_tr_b16 v[190:191], v241 offset:51200
  v_mfma_f32_16x16x32_bf16 v[72:75], v[152:155], v[204:207], v[72:75]
  ds_read_b64_tr_b16 v[192:193], v242 offset:49152
  v_mfma_f32_16x16x32_bf16 v[76:79], v[152:155], v[208:211], v[76:79]
  ds_read_b64_tr_b16 v[194:195], v242 offset:51200
  v_mfma_f32_16x16x32_bf16 v[80:83], v[156:159], v[196:199], v[80:83]
  s_add_u32 m0, s57, 26624
  s_add_u32 s28, s54, s53
  s_add_u32 s28, s28, 73728
  buffer_load_dwordx4 v250, s[32:35], s28 offen lds
  s_add_u32 m0, s57, 27648
  s_add_u32 s28, s54, s53
  s_add_u32 s28, s28, 82944
  buffer_load_dwordx4 v251, s[32:35], s28 offen lds
  s_cmp_lg_u32 s25, 0
  s_cbranch_scc1 k1c_16
  s_mov_b32 m0, 84992
  s_add_u32 s28, s54, s56
  s_add_u32 s28, s28, 9216
  buffer_load_dwordx4 v251, s[32:35], s28 offen lds
  k1c_16:
  s_add_u32 s54, s54, 128
  s_cmp_eq_u32 s54, 1152
  s_cselect_b32 s54, 0, s54
  v_mfma_f32_16x16x32_bf16 v[84:87], v[156:159], v[200:203], v[84:87]
  v_mfma_f32_16x16x32_bf16 v[88:91], v[156:159], v[204:207], v[88:91]
  v_mfma_f32_16x16x32_bf16 v[92:95], v[156:159], v[208:211], v[92:95]
  v_mfma_f32_16x16x32_bf16 v[96:99], v[160:163], v[196:199], v[96:99]
  v_mfma_f32_16x16x32_bf16 v[100:103], v[160:163], v[200:203], v[100:103]
  v_mfma_f32_16x16x32_bf16 v[104:107], v[160:163], v[204:207], v[104:107]
  v_mfma_f32_16x16x32_bf16 v[108:111], v[160:163], v[208:211], v[108:111]
  v_mfma_f32_16x16x32_bf16 v[112:115], v[164:167], v[196:199], v[112:115]
  v_mfma_f32_16x16x32_bf16 v[116:119], v[164:167], v[200:203], v[116:119]
  v_mfma_f32_16x16x32_bf16 v[120:123], v[164:167], v[204:207], v[120:123]
  v_mfma_f32_16x16x32_bf16 v[124:127], v[164:167], v[208:211], v[124:127]
  s_waitcnt vmcnt(4) lgkmcnt(0)
  s_barrier
  v_mfma_f32_16x16x32_bf16 v[16:19], v[168:171], v[216:219], v[16:19]
  ds_read_b128 v[196:199], v243 offset:0
  v_mfma_f32_16x16x32_bf16 v[20:23], v[168:171], v[220:223], v[20:23]
  ds_read_b128 v[200:203], v243 offset:2048
  v_mfma_f32_16x16x32_bf16 v[24:27], v[168:171], v[224:227], v[24:27]
  ds_read_b128 v[204:207], v243 offset:4096
  v_mfma_f32_16x16x32_bf16 v[28:31], v[168:171], v[228:231], v[28:31]
  ds_read_b128 v[208:211], v243 offset:6144
  v_mfma_f32_16x16x32_bf16 v[128:131], v[168:171], v[232:235], v[128:131]
  ds_read_b128 v[212:215], v245 offset:0
  v_mfma_f32_16x16x32_bf16 v[32:35], v[172:175], v[216:219], v[32:35]
  ds_read_b64_tr_b16 v[140:141], v236 offset:0
  v_mfma_f32_16x16x32_bf16 v[36:39], v[172:175], v[220:223], v[36:39]
  ds_read_b64_tr_b16 v[142:143], v236 offset:2048
  v_mfma_f32_16x16x32_bf16 v[40:43], v[172:175], v[224:227], v[40:43]
  ds_read_b64_tr_b16 v[144:145], v237 offset:0
  v_mfma_f32_16x16x32_bf16 v[44:47], v[172:175], v[228:231], v[44:47]
  ds_read_b64_tr_b16 v[146:147], v237 offset:2048
  v_mfma_f32_16x16x32_bf16 v[132:135], v[172:175], v[232:235], v[132:135]
  ds_read_b64_tr_b16 v[148:149], v238 offset:0
  v_mfma_f32_16x16x32_bf16 v[48:51], v[176:179], v[216:219], v[48:51]
  ds_read_b64_tr_b16 v[150:151], v238 offset:2048
  v_mfma_f32_16x16x32_bf16 v[52:55], v[176:179], v[220:223], v[52:55]
  ds_read_b64_tr_b16 v[152:153], v239 offset:0
  v_mfma_f32_16x16x32_bf16 v[56:59], v[176:179], v[224:227], v[56:59]
  ds_read_b64_tr_b16 v[154:155], v239 offset:2048
  v_mfma_f32_16x16x32_bf16 v[60:63], v[176:179], v[228:231], v[60:63]
  ds_read_b64_tr_b16 v[156:157], v240 offset:0
  v_mfma_f32_16x16x32_bf16 v[136:139], v[176:179], v[232:235], v[136:139]
  ds_read_b64_tr_b16 v[158:159], v240 offset:2048
  v_mfma_f32_16x16x32_bf16 v[64:67], v[180:183], v[216:219], v[64:67]
  ds_read_b64_tr_b16 v[160:161], v241 offset:0
  v_mfma_f32_16x16x32_bf16 v[68:71], v[180:183], v[220:223], v[68:71]
  ds_read_b64_tr_b16 v[162:163], v241 offset:2048
  v_mfma_f32_16x16x32_bf16 v[72:75], v[180:183], v[224:227], v[72:75]
  ds_read_b64_tr_b16 v[164:165], v242 offset:0
  v_mfma_f32_16x16x32_bf16 v[76:79], v[180:183], v[228:231], v[76:79]
  ds_read_b64_tr_b16 v[166:167], v242 offset:2048
  v_mfma_f32_16x16x32_bf16 v[80:83], v[184:187], v[216:219], v[80:83]
  s_add_u32 m0, s57, 36864
  s_add_u32 s28, s54, s53
  buffer_load_dwordx4 v250, s[32:35], s28 offen lds
  s_add_u32 m0, s57, 37888
  s_add_u32 s28, s54, s53
  s_add_u32 s28, s28, 9216
  buffer_load_dwordx4 v251, s[32:35], s28 offen lds
  s_cmp_lg_u32 s25, 0
  s_cbranch_scc1 k1c_17
  s_mov_b32 m0, 102400
  s_add_u32 s28, s54, s56
  buffer_load_dwordx4 v250, s[32:35], s28 offen lds
  k1c_17:
  v_mfma_f32_16x16x32_bf16 v[84:87], v[184:187], v[220:223], v[84:87]
  v_mfma_f32_16x16x32_bf16 v[88:91], v[184:187], v[224:227], v[88:91]
  v_mfma_f32_16x16x32_bf16 v[92:95], v[184:187], v[228:231], v[92:95]
  v_mfma_f32_16x16x32_bf16 v[96:99], v[188:191], v[216:219], v[96:99]
  v_mfma_f32_16x16x32_bf16 v[100:103], v[188:191], v[220:223], v[100:103]
  v_mfma_f32_16x16x32_bf16 v[104:107], v[188:191], v[224:227], v[104:107]
  v_mfma_f32_16x16x32_bf16 v[108:111], v[188:191], v[228:231], v[108:111]
  v_mfma_f32_16x16x32_bf16 v[112:115], v[192:195], v[216:219], v[112:115]
  v_mfma_f32_16x16x32_bf16 v[116:119], v[192:195], v[220:223], v[116:119]
  v_mfma_f32_16x16x32_bf16 v[120:123], v[192:195], v[224:227], v[120:123]
  v_mfma_f32_16x16x32_bf16 v[124:127], v[192:195], v[228:231], v[124:127]
  s_waitcnt vmcnt(4) lgkmcnt(0)
  s_barrier
  v_mfma_f32_16x16x32_bf16 v[16:19], v[140:143], v[196:199], v[16:19]
  ds_read_b128 v[216:219], v244 offset:0
  v_mfma_f32_16x16x32_bf16 v[20:23], v[140:143], v[200:203], v[20:23]
  ds_read_b128 v[220:223], v244 offset:2048
  v_mfma_f32_16x16x32_bf16 v[24:27], v[140:143], v[204:207], v[24:27]
  ds_read_b128 v[224:227], v244 offset:4096
  v_mfma_f32_16x16x32_bf16 v[28:31], v[140:143], v[208:211], v[28:31]
  ds_read_b128 v[228:231], v244 offset:6144
  v_mfma_f32_16x16x32_bf16 v[128:131], v[140:143], v[212:215], v[128:131]
  ds_read_b128 v[232:235], v246 offset:0
  v_mfma_f32_16x16x32_bf16 v[32:35], v[144:147], v[196:199], v[32:35]
  ds_read_b64_tr_b16 v[168:169], v236 offset:16384
  v_mfma_f32_16x16x32_bf16 v[36:39], v[144:147], v[200:203], v[36:39]
  ds_read_b64_tr_b16 v[170:171], v236 offset:18432
  v_mfma_f32_16x16x32_bf16 v[40:43], v[144:147], v[204:207], v[40:43]
  ds_read_b64_tr_b16 v[172:173], v237 offset:16384
  v_mfma_f32_16x16x32_bf16 v[44:47], v[144:147], v[208:211], v[44:47]
  ds_read_b64_tr_b16 v[174:175], v237 offset:18432
  v_mfma_f32_16x16x32_bf16 v[132:135], v[144:147], v[212:215], v[132:135]
  ds_read_b64_tr_b16 v[176:177], v238 offset:16384
  v_mfma_f32_16x16x32_bf16 v[48:51], v[148:151], v[196:199], v[48:51]
  ds_read_b64_tr_b16 v[178:179], v238 offset:18432
  v_mfma_f32_16x16x32_bf16 v[52:55], v[148:151], v[200:203], v[52:55]
  ds_read_b64_tr_b16 v[180:181], v239 offset:16384
  v_mfma_f32_16x16x32_bf16 v[56:59], v[148:151], v[204:207], v[56:59]
  ds_read_b64_tr_b16 v[182:183], v239 offset:18432
  v_mfma_f32_16x16x32_bf16 v[60:63], v[148:151], v[208:211], v[60:63]
  ds_read_b64_tr_b16 v[184:185], v240 offset:16384
  v_mfma_f32_16x16x32_bf16 v[136:139], v[148:151], v[212:215], v[136:139]
  ds_read_b64_tr_b16 v[186:187], v240 offset:18432
  v_mfma_f32_16x16x32_bf16 v[64:67], v[152:155], v[196:199], v[64:67]
  ds_read_b64_tr_b16 v[188:189], v241 offset:16384
  v_mfma_f32_16x16x32_bf16 v[68:71], v[152:155], v[200:203], v[68:71]
  ds_read_b64_tr_b16 v[190:191], v241 offset:18432
  v_mfma_f32_16x16x32_bf16 v[72:75], v[152:155], v[204:207], v[72:75]
  ds_read_b64_tr_b16 v[192:193], v242 offset:16384
  v_mfma_f32_16x16x32_bf16 v[76:79], v[152:155], v[208:211], v[76:79]
  ds_read_b64_tr_b16 v[194:195], v242 offset:18432
  v_mfma_f32_16x16x32_bf16 v[80:83], v[156:159], v[196:199], v[80:83]
  s_add_u32 m0, s57, 45056
  s_add_u32 s28, s54, s53
  s_add_u32 s28, s28, 73728
  buffer_load_dwordx4 v250, s[32:35], s28 offen lds
  s_add_u32 m0, s57, 46080
  s_add_u32 s28, s54, s53
  s_add_u32 s28, s28, 82944
  buffer_load_dwordx4 v251, s[32:35], s28 offen lds
  s_cmp_lg_u32 s25, 0
  s_cbranch_scc1 k1c_18
  s_mov_b32 m0, 103424
  s_add_u32 s28, s54, s56
  s_add_u32 s28, s28, 9216
  buffer_load_dwordx4 v251, s[32:35], s28 offen lds
  k1c_18:
  s_add_u32 s54, s54, 128
  s_cmp_eq_u32 s54, 1152
  s_cselect_b32 s54, 0, s54
  v_mfma_f32_16x16x32_bf16 v[84:87], v[156:159], v[200:203], v[84:87]
  v_mfma_f32_16x16x32_bf16 v[88:91], v[156:159], v[204:207], v[88:91]
  v_mfma_f32_16x16x32_bf16 v[92:95], v[156:159], v[208:211], v[92:95]
  v_mfma_f32_16x16x32_bf16 v[96:99], v[160:163], v[196:199], v[96:99]
  v_mfma_f32_16x16x32_bf16 v[100:103], v[160:163], v[200:203], v[100:103]
  v_mfma_f32_16x16x32_bf16 v[104:107], v[160:163], v[204:207], v[104:107]
  v_mfma_f32_16x16x32_bf16 v[108:111], v[160:163], v[208:211], v[108:111]
  v_mfma_f32_16x16x32_bf16 v[112:115], v[164:167], v[196:199], v[112:115]
  v_mfma_f32_16x16x32_bf16 v[116:119], v[164:167], v[200:203], v[116:119]
  v_mfma_f32_16x16x32_bf16 v[120:123], v[164:167], v[204:207], v[120:123]
  v_mfma_f32_16x16x32_bf16 v[124:127], v[164:167], v[208:211], v[124:127]
  s_waitcnt vmcnt(4) lgkmcnt(0)
  s_barrier
  v_mfma_f32_16x16x32_bf16 v[16:19], v[168:171], v[216:219], v[16:19]
  ds_read_b128 v[196:199], v243 offset:18432
  v_mfma_f32_16x16x32_bf16 v[20:23], v[168:171], v[220:223], v[20:23]
  ds_read_b128 v[200:203], v243 offset:20480
  v_mfma_f32_16x16x32_bf16 v[24:27], v[168:171], v[224:227], v[24:27]
  ds_read_b128 v[204:207], v243 offset:22528
  v_mfma_f32_16x16x32_bf16 v[28:31], v[168:171], v[228:231], v[28:31]
  ds_read_b128 v[208:211], v243 offset:24576
  v_mfma_f32_16x16x32_bf16 v[128:131], v[168:171], v[232:235], v[128:131]
  ds_read_b128 v[212:215], v245 offset:18432
  v_mfma_f32_16x16x32_bf16 v[32:35], v[172:175], v[216:219], v[32:35]
  ds_read_b64_tr_b16 v[140:141], v236 offset:32768
  v_mfma_f32_16x16x32_bf16 v[36:39], v[172:175], v[220:223], v[36:39]
  ds_read_b64_tr_b16 v[142:143], v236 offset:34816
  v_mfma_f32_16x16x32_bf16 v[40:43], v[172:175], v[224:227], v[40:43]
  ds_read_b64_tr_b16 v[144:145], v237 offset:32768
  v_mfma_f32_16x16x32_bf16 v[44:47], v[172:175], v[228:231], v[44:47]
  ds_read_b64_tr_b16 v[146:147], v237 offset:34816
  v_mfma_f32_16x16x32_bf16 v[132:135], v[172:175], v[232:235], v[132:135]
  ds_read_b64_tr_b16 v[148:149], v238 offset:32768
  v_mfma_f32_16x16x32_bf16 v[48:51], v[176:179], v[216:219], v[48:51]
  ds_read_b64_tr_b16 v[150:151], v238 offset:34816
  v_mfma_f32_16x16x32_bf16 v[52:55], v[176:179], v[220:223], v[52:55]
  ds_read_b64_tr_b16 v[152:153], v239 offset:32768
  v_mfma_f32_16x16x32_bf16 v[56:59], v[176:179], v[224:227], v[56:59]
  ds_read_b64_tr_b16 v[154:155], v239 offset:34816
  v_mfma_f32_16x16x32_bf16 v[60:63], v[176:179], v[228:231], v[60:63]
  ds_read_b64_tr_b16 v[156:157], v240 offset:32768
  v_mfma_f32_16x16x32_bf16 v[136:139], v[176:179], v[232:235], v[136:139]
  ds_read_b64_tr_b16 v[158:159], v240 offset:34816
  v_mfma_f32_16x16x32_bf16 v[64:67], v[180:183], v[216:219], v[64:67]
  ds_read_b64_tr_b16 v[160:161], v241 offset:32768
  v_mfma_f32_16x16x32_bf16 v[68:71], v[180:183], v[220:223], v[68:71]
  ds_read_b64_tr_b16 v[162:163], v241 offset:34816
  v_mfma_f32_16x16x32_bf16 v[72:75], v[180:183], v[224:227], v[72:75]
  ds_read_b64_tr_b16 v[164:165], v242 offset:32768
  v_mfma_f32_16x16x32_bf16 v[76:79], v[180:183], v[228:231], v[76:79]
  ds_read_b64_tr_b16 v[166:167], v242 offset:34816
  v_mfma_f32_16x16x32_bf16 v[80:83], v[184:187], v[216:219], v[80:83]
  v_mfma_f32_16x16x32_bf16 v[84:87], v[184:187], v[220:223], v[84:87]
  v_mfma_f32_16x16x32_bf16 v[88:91], v[184:187], v[224:227], v[88:91]
  v_mfma_f32_16x16x32_bf16 v[92:95], v[184:187], v[228:231], v[92:95]
  v_mfma_f32_16x16x32_bf16 v[96:99], v[188:191], v[216:219], v[96:99]
  v_mfma_f32_16x16x32_bf16 v[100:103], v[188:191], v[220:223], v[100:103]
  v_mfma_f32_16x16x32_bf16 v[104:107], v[188:191], v[224:227], v[104:107]
  v_mfma_f32_16x16x32_bf16 v[108:111], v[188:191], v[228:231], v[108:111]
  v_mfma_f32_16x16x32_bf16 v[112:115], v[192:195], v[216:219], v[112:115]
  v_mfma_f32_16x16x32_bf16 v[116:119], v[192:195], v[220:223], v[116:119]
  v_mfma_f32_16x16x32_bf16 v[120:123], v[192:195], v[224:227], v[120:123]
  v_mfma_f32_16x16x32_bf16 v[124:127], v[192:195], v[228:231], v[124:127]
  s_waitcnt vmcnt(2) lgkmcnt(0)
  s_barrier
  v_mfma_f32_16x16x32_bf16 v[16:19], v[140:143], v[196:199], v[16:19]
  ds_read_b128 v[216:219], v244 offset:18432
  v_mfma_f32_16x16x32_bf16 v[20:23], v[140:143], v[200:203], v[20:23]
  ds_read_b128 v[220:223], v244 offset:20480
  v_mfma_f32_16x16x32_bf16 v[24:27], v[140:143], v[204:207], v[24:27]
  ds_read_b128 v[224:227], v244 offset:22528
  v_mfma_f32_16x16x32_bf16 v[28:31], v[140:143], v[208:211], v[28:31]
  ds_read_b128 v[228:231], v244 offset:24576
  v_mfma_f32_16x16x32_bf16 v[128:131], v[140:143], v[212:215], v[128:131]
  ds_read_b128 v[232:235], v246 offset:18432
  v_mfma_f32_16x16x32_bf16 v[32:35], v[144:147], v[196:199], v[32:35]
  ds_read_b64_tr_b16 v[168:169], v236 offset:49152
  v_mfma_f32_16x16x32_bf16 v[36:39], v[144:147], v[200:203], v[36:39]
  ds_read_b64_tr_b16 v[170:171], v236 offset:51200
  v_mfma_f32_16x16x32_bf16 v[40:43], v[144:147], v[204:207], v[40:43]
  ds_read_b64_tr_b16 v[172:173], v237 offset:49152
  v_mfma_f32_16x16x32_bf16 v[44:47], v[144:147], v[208:211], v[44:47]
  ds_read_b64_tr_b16 v[174:175], v237 offset:51200
  v_mfma_f32_16x16x32_bf16 v[132:135], v[144:147], v[212:215], v[132:135]
  ds_read_b64_tr_b16 v[176:177], v238 offset:49152
  v_mfma_f32_16x16x32_bf16 v[48:51], v[148:151], v[196:199], v[48:51]
  ds_read_b64_tr_b16 v[178:179], v238 offset:51200
  v_mfma_f32_16x16x32_bf16 v[52:55], v[148:151], v[200:203], v[52:55]
  ds_read_b64_tr_b16 v[180:181], v239 offset:49152
  v_mfma_f32_16x16x32_bf16 v[56:59], v[148:151], v[204:207], v[56:59]
  ds_read_b64_tr_b16 v[182:183], v239 offset:51200
  v_mfma_f32_16x16x32_bf16 v[60:63], v[148:151], v[208:211], v[60:63]
  ds_read_b64_tr_b16 v[184:185], v240 offset:49152
  v_mfma_f32_16x16x32_bf16 v[136:139], v[148:151], v[212:215], v[136:139]
  ds_read_b64_tr_b16 v[186:187], v240 offset:51200
  v_mfma_f32_16x16x32_bf16 v[64:67], v[152:155], v[196:199], v[64:67]
  ds_read_b64_tr_b16 v[188:189], v241 offset:49152
  v_mfma_f32_16x16x32_bf16 v[68:71], v[152:155], v[200:203], v[68:71]
  ds_read_b64_tr_b16 v[190:191], v241 offset:51200
  v_mfma_f32_16x16x32_bf16 v[72:75], v[152:155], v[204:207], v[72:75]
  ds_read_b64_tr_b16 v[192:193], v242 offset:49152
  v_mfma_f32_16x16x32_bf16 v[76:79], v[152:155], v[208:211], v[76:79]
  ds_read_b64_tr_b16 v[194:195], v242 offset:51200
  v_mfma_f32_16x16x32_bf16 v[80:83], v[156:159], v[196:199], v[80:83]
  v_mfma_f32_16x16x32_bf16 v[84:87], v[156:159], v[200:203], v[84:87]
  v_mfma_f32_16x16x32_bf16 v[88:91], v[156:159], v[204:207], v[88:91]
  v_mfma_f32_16x16x32_bf16 v[92:95], v[156:159], v[208:211], v[92:95]
  v_mfma_f32_16x16x32_bf16 v[96:99], v[160:163], v[196:199], v[96:99]
  v_mfma_f32_16x16x32_bf16 v[100:103], v[160:163], v[200:203], v[100:103]
  v_mfma_f32_16x16x32_bf16 v[104:107], v[160:163], v[204:207], v[104:107]
  v_mfma_f32_16x16x32_bf16 v[108:111], v[160:163], v[208:211], v[108:111]
  v_mfma_f32_16x16x32_bf16 v[112:115], v[164:167], v[196:199], v[112:115]
  v_mfma_f32_16x16x32_bf16 v[116:119], v[164:167], v[200:203], v[116:119]
  v_mfma_f32_16x16x32_bf16 v[120:123], v[164:167], v[204:207], v[120:123]
  v_mfma_f32_16x16x32_bf16 v[124:127], v[164:167], v[208:211], v[124:127]
  s_waitcnt vmcnt(0) lgkmcnt(0)
  s_barrier
  v_mfma_f32_16x16x32_bf16 v[16:19], v[168:171], v[216:219], v[16:19]
  ds_read_b128 v[196:199], v243 offset:36864
  v_mfma_f32_16x16x32_bf16 v[20:23], v[168:171], v[220:223], v[20:23]
  ds_read_b128 v[200:203], v243 offset:38912
  v_mfma_f32_16x16x32_bf16 v[24:27], v[168:171], v[224:227], v[24:27]
  ds_read_b128 v[204:207], v243 offset:40960
  v_mfma_f32_16x16x32_bf16 v[28:31], v[168:171], v[228:231], v[28:31]
  ds_read_b128 v[208:211], v243 offset:43008
  v_mfma_f32_16x16x32_bf16 v[128:131], v[168:171], v[232:235], v[128:131]
  ds_read_b128 v[212:215], v245 offset:36864
  v_mfma_f32_16x16x32_bf16 v[32:35], v[172:175], v[216:219], v[32:35]
  ds_read_b64_tr_b16 v[140:141], v236 offset:0
  v_mfma_f32_16x16x32_bf16 v[36:39], v[172:175], v[220:223], v[36:39]
  ds_read_b64_tr_b16 v[142:143], v236 offset:2048
  v_mfma_f32_16x16x32_bf16 v[40:43], v[172:175], v[224:227], v[40:43]
  ds_read_b64_tr_b16 v[144:145], v237 offset:0
  v_mfma_f32_16x16x32_bf16 v[44:47], v[172:175], v[228:231], v[44:47]
  ds_read_b64_tr_b16 v[146:147], v237 offset:2048
  v_mfma_f32_16x16x32_bf16 v[132:135], v[172:175], v[232:235], v[132:135]
  ds_read_b64_tr_b16 v[148:149], v238 offset:0
  v_mfma_f32_16x16x32_bf16 v[48:51], v[176:179], v[216:219], v[48:51]
  ds_read_b64_tr_b16 v[150:151], v238 offset:2048
  v_mfma_f32_16x16x32_bf16 v[52:55], v[176:179], v[220:223], v[52:55]
  ds_read_b64_tr_b16 v[152:153], v239 offset:0
  v_mfma_f32_16x16x32_bf16 v[56:59], v[176:179], v[224:227], v[56:59]
  ds_read_b64_tr_b16 v[154:155], v239 offset:2048
  v_mfma_f32_16x16x32_bf16 v[60:63], v[176:179], v[228:231], v[60:63]
  ds_read_b64_tr_b16 v[156:157], v240 offset:0
  v_mfma_f32_16x16x32_bf16 v[136:139], v[176:179], v[232:235], v[136:139]
  ds_read_b64_tr_b16 v[158:159], v240 offset:2048
  v_mfma_f32_16x16x32_bf16 v[64:67], v[180:183], v[216:219], v[64:67]
  ds_read_b64_tr_b16 v[160:161], v241 offset:0
  v_mfma_f32_16x16x32_bf16 v[68:71], v[180:183], v[220:223], v[68:71]
  ds_read_b64_tr_b16 v[162:163], v241 offset:2048
  v_mfma_f32_16x16x32_bf16 v[72:75], v[180:183], v[224:227], v[72:75]
  ds_read_b64_tr_b16 v[164:165], v242 offset:0
  v_mfma_f32_16x16x32_bf16 v[76:79], v[180:183], v[228:231], v[76:79]
  ds_read_b64_tr_b16 v[166:167], v242 offset:2048
  v_mfma_f32_16x16x32_bf16 v[80:83], v[184:187], v[216:219], v[80:83]
  v_mfma_f32_16x16x32_bf16 v[84:87], v[184:187], v[220:223], v[84:87]
  v_mfma_f32_16x16x32_bf16 v[88:91], v[184:187], v[224:227], v[88:91]
  v_mfma_f32_16x16x32_bf16 v[92:95], v[184:187], v[228:231], v[92:95]
  v_mfma_f32_16x16x32_bf16 v[96:99], v[188:191], v[216:219], v[96:99]
  v_mfma_f32_16x16x32_bf16 v[100:103], v[188:191], v[220:223], v[100:103]
  v_mfma_f32_16x16x32_bf16 v[104:107], v[188:191], v[224:227], v[104:107]
  v_mfma_f32_16x16x32_bf16 v[108:111], v[188:191], v[228:231], v[108:111]
  v_mfma_f32_16x16x32_bf16 v[112:115], v[192:195], v[216:219], v[112:115]
  v_mfma_f32_16x16x32_bf16 v[116:119], v[192:195], v[220:223], v[116:119]
  v_mfma_f32_16x16x32_bf16 v[120:123], v[192:195], v[224:227], v[120:123]
  v_mfma_f32_16x16x32_bf16 v[124:127], v[192:195], v[228:231], v[124:127]
  s_waitcnt vmcnt(0) lgkmcnt(0)
  s_barrier
  v_mfma_f32_16x16x32_bf16 v[16:19], v[140:143], v[196:199], v[16:19]
  ds_read_b128 v[216:219], v244 offset:36864
  v_mfma_f32_16x16x32_bf16 v[20:23], v[140:143], v[200:203], v[20:23]
  ds_read_b128 v[220:223], v244 offset:38912
  v_mfma_f32_16x16x32_bf16 v[24:27], v[140:143], v[204:207], v[24:27]
  ds_read_b128 v[224:227], v244 offset:40960
  v_mfma_f32_16x16x32_bf16 v[28:31], v[140:143], v[208:211], v[28:31]
  ds_read_b128 v[228:231], v244 offset:43008
  v_mfma_f32_16x16x32_bf16 v[128:131], v[140:143], v[212:215], v[128:131]
  ds_read_b128 v[232:235], v246 offset:36864
  v_mfma_f32_16x16x32_bf16 v[32:35], v[144:147], v[196:199], v[32:35]
  ds_read_b64_tr_b16 v[168:169], v236 offset:16384
  v_mfma_f32_16x16x32_bf16 v[36:39], v[144:147], v[200:203], v[36:39]
  ds_read_b64_tr_b16 v[170:171], v236 offset:18432
  v_mfma_f32_16x16x32_bf16 v[40:43], v[144:147], v[204:207], v[40:43]
  ds_read_b64_tr_b16 v[172:173], v237 offset:16384
  v_mfma_f32_16x16x32_bf16 v[44:47], v[144:147], v[208:211], v[44:47]
  ds_read_b64_tr_b16 v[174:175], v237 offset:18432
  v_mfma_f32_16x16x32_bf16 v[132:135], v[144:147], v[212:215], v[132:135]
  ds_read_b64_tr_b16 v[176:177], v238 offset:16384
  v_mfma_f32_16x16x32_bf16 v[48:51], v[148:151], v[196:199], v[48:51]
  ds_read_b64_tr_b16 v[178:179], v238 offset:18432
  v_mfma_f32_16x16x32_bf16 v[52:55], v[148:151], v[200:203], v[52:55]
  ds_read_b64_tr_b16 v[180:181], v239 offset:16384
  v_mfma_f32_16x16x32_bf16 v[56:59], v[148:151], v[204:207], v[56:59]
  ds_read_b64_tr_b16 v[182:183], v239 offset:18432
  v_mfma_f32_16x16x32_bf16 v[60:63], v[148:151], v[208:211], v[60:63]
  ds_read_b64_tr_b16 v[184:185], v240 offset:16384
  v_mfma_f32_16x16x32_bf16 v[136:139], v[148:151], v[212:215], v[136:139]
  ds_read_b64_tr_b16 v[186:187], v240 offset:18432
  v_mfma_f32_16x16x32_bf16 v[64:67], v[152:155], v[196:199], v[64:67]
  ds_read_b64_tr_b16 v[188:189], v241 offset:16384
  v_mfma_f32_16x16x32_bf16 v[68:71], v[152:155], v[200:203], v[68:71]
  ds_read_b64_tr_b16 v[190:191], v241 offset:18432
  v_mfma_f32_16x16x32_bf16 v[72:75], v[152:155], v[204:207], v[72:75]
  ds_read_b64_tr_b16 v[192:193], v242 offset:16384
  v_mfma_f32_16x16x32_bf16 v[76:79], v[152:155], v[208:211], v[76:79]
  ds_read_b64_tr_b16 v[194:195], v242 offset:18432
  v_mfma_f32_16x16x32_bf16 v[80:83], v[156:159], v[196:199], v[80:83]
  v_mfma_f32_16x16x32_bf16 v[84:87], v[156:159], v[200:203], v[84:87]
  v_mfma_f32_16x16x32_bf16 v[88:91], v[156:159], v[204:207], v[88:91]
  v_mfma_f32_16x16x32_bf16 v[92:95], v[156:159], v[208:211], v[92:95]
  v_mfma_f32_16x16x32_bf16 v[96:99], v[160:163], v[196:199], v[96:99]
  v_mfma_f32_16x16x32_bf16 v[100:103], v[160:163], v[200:203], v[100:103]
  v_mfma_f32_16x16x32_bf16 v[104:107], v[160:163], v[204:207], v[104:107]
  v_mfma_f32_16x16x32_bf16 v[108:111], v[160:163], v[208:211], v[108:111]
  v_mfma_f32_16x16x32_bf16 v[112:115], v[164:167], v[196:199], v[112:115]
  v_mfma_f32_16x16x32_bf16 v[116:119], v[164:167], v[200:203], v[116:119]
  v_mfma_f32_16x16x32_bf16 v[120:123], v[164:167], v[204:207], v[120:123]
  v_mfma_f32_16x16x32_bf16 v[124:127], v[164:167], v[208:211], v[124:127]
  s_waitcnt vmcnt(0) lgkmcnt(0)
  s_barrier
  v_mfma_f32_16x16x32_bf16 v[16:19], v[168:171], v[216:219], v[16:19]
  v_mfma_f32_16x16x32_bf16 v[20:23], v[168:171], v[220:223], v[20:23]
  v_mfma_f32_16x16x32_bf16 v[24:27], v[168:171], v[224:227], v[24:27]
  v_mfma_f32_16x16x32_bf16 v[28:31], v[168:171], v[228:231], v[28:31]
  v_mfma_f32_16x16x32_bf16 v[128:131], v[168:171], v[232:235], v[128:131]
  v_mfma_f32_16x16x32_bf16 v[32:35], v[172:175], v[216:219], v[32:35]
  v_mfma_f32_16x16x32_bf16 v[36:39], v[172:175], v[220:223], v[36:39]
  v_mfma_f32_16x16x32_bf16 v[40:43], v[172:175], v[224:227], v[40:43]
  v_mfma_f32_16x16x32_bf16 v[44:47], v[172:175], v[228:231], v[44:47]
  v_mfma_f32_16x16x32_bf16 v[132:135], v[172:175], v[232:235], v[132:135]
  v_mfma_f32_16x16x32_bf16 v[48:51], v[176:179], v[216:219], v[48:51]
  v_mfma_f32_16x16x32_bf16 v[52:55], v[176:179], v[220:223], v[52:55]
  v_mfma_f32_16x16x32_bf16 v[56:59], v[176:179], v[224:227], v[56:59]
  v_mfma_f32_16x16x32_bf16 v[60:63], v[176:179], v[228:231], v[60:63]
  v_mfma_f32_16x16x32_bf16 v[136:139], v[176:179], v[232:235], v[136:139]
  v_mfma_f32_16x16x32_bf16 v[64:67], v[180:183], v[216:219], v[64:67]
  v_mfma_f32_16x16x32_bf16 v[68:71], v[180:183], v[220:223], v[68:71]
  v_mfma_f32_16x16x32_bf16 v[72:75], v[180:183], v[224:227], v[72:75]
  v_mfma_f32_16x16x32_bf16 v[76:79], v[180:183], v[228:231], v[76:79]
  v_mfma_f32_16x16x32_bf16 v[80:83], v[184:187], v[216:219], v[80:83]
  v_mfma_f32_16x16x32_bf16 v[84:87], v[184:187], v[220:223], v[84:87]
  v_mfma_f32_16x16x32_bf16 v[88:91], v[184:187], v[224:227], v[88:91]
  v_mfma_f32_16x16x32_bf16 v[92:95], v[184:187], v[228:231], v[92:95]
  v_mfma_f32_16x16x32_bf16 v[96:99], v[188:191], v[216:219], v[96:99]
  v_mfma_f32_16x16x32_bf16 v[100:103], v[188:191], v[220:223], v[100:103]
  v_mfma_f32_16x16x32_bf16 v[104:107], v[188:191], v[224:227], v[104:107]
  v_mfma_f32_16x16x32_bf16 v[108:111], v[188:191], v[228:231], v[108:111]
  v_mfma_f32_16x16x32_bf16 v[112:115], v[192:195], v[216:219], v[112:115]
  v_mfma_f32_16x16x32_bf16 v[116:119], v[192:195], v[220:223], v[116:119]
  v_mfma_f32_16x16x32_bf16 v[120:123], v[192:195], v[224:227], v[120:123]
  v_mfma_f32_16x16x32_bf16 v[124:127], v[192:195], v[228:231], v[124:127]
  s_waitcnt lgkmcnt(0)
  s_barrier
  v_cvt_pk_bf16_f32 v140, v16, v17
  v_cvt_pk_bf16_f32 v141, v18, v19
  v_cvt_pk_bf16_f32 v142, v20, v21
  v_cvt_pk_bf16_f32 v143, v22, v23
  v_cvt_pk_bf16_f32 v144, v24, v25
  v_cvt_pk_bf16_f32 v145, v26, v27
  v_cvt_pk_bf16_f32 v146, v28, v29
  v_cvt_pk_bf16_f32 v147, v30, v31
  v_cvt_pk_bf16_f32 v148, v32, v33
  v_cvt_pk_bf16_f32 v149, v34, v35
  v_cvt_pk_bf16_f32 v150, v36, v37
  v_cvt_pk_bf16_f32 v151, v38, v39
  v_cvt_pk_bf16_f32 v152, v40, v41
  v_cvt_pk_bf16_f32 v153, v42, v43
  v_cvt_pk_bf16_f32 v154, v44, v45
  v_cvt_pk_bf16_f32 v155, v46, v47
  v_cvt_pk_bf16_f32 v156, v48, v49
  v_cvt_pk_bf16_f32 v157, v50, v51
  v_cvt_pk_bf16_f32 v158, v52, v53
  v_cvt_pk_bf16_f32 v159, v54, v55
  v_cvt_pk_bf16_f32 v160, v56, v57
  v_cvt_pk_bf16_f32 v161, v58, v59
  v_cvt_pk_bf16_f32 v162, v60, v61
  v_cvt_pk_bf16_f32 v163, v62, v63
  v_cvt_pk_bf16_f32 v164, v64, v65
  v_cvt_pk_bf16_f32 v165, v66, v67
  v_cvt_pk_bf16_f32 v166, v68, v69
  v_cvt_pk_bf16_f32 v167, v70, v71
  v_cvt_pk_bf16_f32 v168, v72, v73
  v_cvt_pk_bf16_f32 v169, v74, v75
  v_cvt_pk_bf16_f32 v170, v76, v77
  v_cvt_pk_bf16_f32 v171, v78, v79
  v_cvt_pk_bf16_f32 v172, v80, v81
  v_cvt_pk_bf16_f32 v173, v82, v83
  v_cvt_pk_bf16_f32 v174, v84, v85
  v_cvt_pk_bf16_f32 v175, v86, v87
  v_cvt_pk_bf16_f32 v176, v88, v89
  v_cvt_pk_bf16_f32 v177, v90, v91
  v_cvt_pk_bf16_f32 v178, v92, v93
  v_cvt_pk_bf16_f32 v179, v94, v95
  v_cvt_pk_bf16_f32 v180, v96, v97
  v_cvt_pk_bf16_f32 v181, v98, v99
  v_cvt_pk_bf16_f32 v182, v100, v101
  v_cvt_pk_bf16_f32 v183, v102, v103
  v_cvt_pk_bf16_f32 v184, v104, v105
  v_cvt_pk_bf16_f32 v185, v106, v107
  v_cvt_pk_bf16_f32 v186, v108, v109
  v_cvt_pk_bf16_f32 v187, v110, v111
  v_cvt_pk_bf16_f32 v188, v112, v113
  v_cvt_pk_bf16_f32 v189, v114, v115
  v_cvt_pk_bf16_f32 v190, v116, v117
  v_cvt_pk_bf16_f32 v191, v118, v119
  v_cvt_pk_bf16_f32 v192, v120, v121
  v_cvt_pk_bf16_f32 v193, v122, v123
  v_cvt_pk_bf16_f32 v194, v124, v125
  v_cvt_pk_bf16_f32 v195, v126, v127
  v_cvt_pk_bf16_f32 v196, v128, v129
  v_cvt_pk_bf16_f32 v197, v130, v131
  v_cvt_pk_bf16_f32 v198, v132, v133
  v_cvt_pk_bf16_f32 v199, v134, v135
  v_cvt_pk_bf16_f32 v200, v136, v137
  v_cvt_pk_bf16_f32 v201, v138, v139
  v_mul_u32_u24 v12, 496, v2
  s_mul_i32 s31, s27, 80
  v_add_u32 v12, s31, v12
  v_lshlrev_b32 v13, 3, v3
  s_lshl_b32 s30, s26, 6
  s_add_u32 s30, s30, 16
  s_mul_i32 s30, s30, 496
  s_cmp_eq_u32 s26, 0
  s_mov_b32 s28, 0x17161514
  s_mov_b32 s29, 0x2f2e2c2b
  s_cselect_b32 s28, s28, s29
  v_bfe_u32 v6, s28, v13, 8
  v_lshl_add_u32 v6, v6, 3, v12
  v_add_u32 v7, s30, v6
  ds_write_b64 v7, v[140:141] offset:0
  ds_write_b64 v7, v[142:143] offset:7936
  ds_write_b64 v7, v[144:145] offset:15872
  ds_write_b64 v7, v[146:147] offset:23808
  ds_write_b64 v6, v[196:197]
  s_cmp_eq_u32 s26, 0
  s_mov_b32 s28, 0x1c1b1a18
  s_mov_b32 s29, 0x1003130
  s_cselect_b32 s28, s28, s29
  v_bfe_u32 v6, s28, v13, 8
  v_lshl_add_u32 v6, v6, 3, v12
  v_add_u32 v7, s30, v6
  ds_write_b64 v7, v[148:149] offset:0
  ds_write_b64 v7, v[150:151] offset:7936
  ds_write_b64 v7, v[152:153] offset:15872
  ds_write_b64 v7, v[154:155] offset:23808
  ds_write_b64 v6, v[198:199]
  s_cmp_eq_u32 s26, 0
  s_mov_b32 s28, 0x2a29281d
  s_mov_b32 s29, 0x6040302
  s_cselect_b32 s28, s28, s29
  v_bfe_u32 v6, s28, v13, 8
  v_lshl_add_u32 v6, v6, 3, v12
  v_add_u32 v7, s30, v6
  ds_write_b64 v7, v[156:157] offset:0
  ds_write_b64 v7, v[158:159] offset:7936
  ds_write_b64 v7, v[160:161] offset:15872
  ds_write_b64 v7, v[162:163] offset:23808
  ds_write_b64 v6, v[200:201]
  s_cmp_eq_u32 s26, 0
  s_mov_b32 s28, 0x2f2e2c2b
  s_mov_b32 s29, 0x5090807
  s_cselect_b32 s28, s28, s29
  v_bfe_u32 v6, s28, v13, 8
  v_lshl_add_u32 v6, v6, 3, v12
  v_add_u32 v7, s30, v6
  ds_write_b64 v7, v[164:165] offset:0
  ds_write_b64 v7, v[166:167] offset:7936
  ds_write_b64 v7, v[168:169] offset:15872
  ds_write_b64 v7, v[170:171] offset:23808
  s_cmp_eq_u32 s26, 0
  s_mov_b32 s28, 0x1003130
  s_mov_b32 s29, 0x17161514
  s_cselect_b32 s28, s28, s29
  v_bfe_u32 v6, s28, v13, 8
  v_lshl_add_u32 v6, v6, 3, v12
  v_add_u32 v7, s30, v6
  ds_write_b64 v7, v[172:173] offset:0
  ds_write_b64 v7, v[174:175] offset:7936
  ds_write_b64 v7, v[176:177] offset:15872
  ds_write_b64 v7, v[178:179] offset:23808
  s_cmp_eq_u32 s26, 0
  s_mov_b32 s28, 0x6040302
  s_mov_b32 s29, 0x1c1b1a18
  s_cselect_b32 s28, s28, s29
  v_bfe_u32 v6, s28, v13, 8
  v_lshl_add_u32 v6, v6, 3, v12
  v_add_u32 v7, s30, v6
  ds_write_b64 v7, v[180:181] offset:0
  ds_write_b64 v7, v[182:183] offset:7936
  ds_write_b64 v7, v[184:185] offset:15872
  ds_write_b64 v7, v[186:187] offset:23808
  s_cmp_eq_u32 s26, 0
  s_mov_b32 s28, 0x5090807
  s_mov_b32 s29, 0x2a29281d
  s_cselect_b32 s28, s28, s29
  v_bfe_u32 v6, s28, v13, 8
  v_lshl_add_u32 v6, v6, 3, v12
  v_add_u32 v7, s30, v6
  ds_write_b64 v7, v[188:189] offset:0
  ds_write_b64 v7, v[190:191] offset:7936
  ds_write_b64 v7, v[192:193] offset:15872
  ds_write_b64 v7, v[194:195] offset:23808
k1_B_epi:
  s_cmp_lt_u32 s21, 16
  s_cselect_b32 s8, s14, s18
  s_cselect_b32 s9, s15, s19
  s_and_b32 s51, s21, 15
  s_mul_i32 s51, s51, 324
  s_mul_i32 s50, s25, 41
  s_add_u32 s51, s51, s50
  v_min_u32 v6, 40, v1
  v_add_u32 v6, s51, v6
  v_lshlrev_b32 v6, 7, v6
  s_mov_b32 s32, s8
  s_and_b32 s33, s9, 0xffff
  s_mov_b32 s34, 663552
  s_mov_b32 s35, 0x00020000
  buffer_load_dword v248, v6, s[32:35], 0 offen
  s_and_b32 s28, s25, 3
  s_lshr_b32 s29, s25, 2
  s_lshl_b32 s29, s29, 6
  v_add_u32 v12, s29, v1
  v_add_u32 v6, 2, v12
  v_mul_u32_u24 v6, 496, v6
  s_lshr_b32 s30, s28, 1
  s_mul_i32 s30, s30, 80
  s_and_b32 s31, s28, 1
  s_mul_i32 s50, s31, 48
  s_add_u32 s50, s50, s30
  v_add_u32 v10, s50, v6
  s_lshl_b32 s50, s31, 2
  s_add_u32 s50, s50, s30
  s_add_u32 s50, s50, 32
  v_add_u32 v11, s50, v6
  v_mul_u32_u24 v13, 144, v12
  s_mul_i32 s50, s28, 36
  s_add_u32 s50, s50, 73728
  v_add_u32 v13, s50, v13
  v_add_u32 v12, s48, v12
  v_cmp_le_u32 s[66:67], 2, v12
  v_cmp_le_u32 s[68:69], 4, v12
  v_cmp_le_u32 s[70:71], 6, v12
  v_cmp_le_u32 s[72:73], 8, v12
  v_cmp_le_u32 s[74:75], 10, v12
  v_cmp_le_u32 s[76:77], 12, v12
  v_cmp_le_u32 s[78:79], 14, v12
  s_waitcnt lgkmcnt(0)
  s_barrier
  ds_read_b128 v[16:19], v10 offset:6944
  ds_read_b128 v[20:23], v10 offset:6960
  ds_read_b32 v24, v11 offset:6944
  ds_read_b128 v[26:29], v10 offset:7104
  ds_read_b128 v[30:33], v10 offset:7120
  ds_read_b32 v34, v11 offset:7104
  ds_read_b128 v[36:39], v10 offset:6112
  ds_read_b128 v[40:43], v10 offset:6128
  ds_read_b32 v44, v11 offset:6112
  ds_read_b128 v[46:49], v10 offset:5120
  ds_read_b128 v[50:53], v10 offset:5136
  ds_read_b32 v54, v11 offset:5120
  ds_read_b128 v[56:59], v10 offset:4128
  ds_read_b128 v[60:63], v10 offset:4144
  ds_read_b32 v64, v11 offset:4128
  ds_read_b128 v[66:69], v10 offset:3136
  ds_read_b128 v[70:73], v10 offset:3152
  ds_read_b32 v74, v11 offset:3136
  ds_read_b128 v[76:79], v10 offset:2144
  ds_read_b128 v[80:83], v10 offset:2160
  ds_read_b32 v84, v11 offset:2144
  ds_read_b128 v[86:89], v10 offset:1152
  ds_read_b128 v[90:93], v10 offset:1168
  ds_read_b32 v94, v11 offset:1152
  ds_read_b128 v[96:99], v10 offset:160
  ds_read_b128 v[100:103], v10 offset:176
  ds_read_b32 v104, v11 offset:160
  v_mov_b32 v186, 0
  v_mov_b32 v187, 0
  v_mov_b32 v188, 0
  v_mov_b32 v189, 0
  v_mov_b32 v190, 0
  v_mov_b32 v191, 0
  v_mov_b32 v192, 0
  v_mov_b32 v193, 0
  s_waitcnt lgkmcnt(12)
  ds_read_b128 v[106:109], v10 offset:7264
  ds_read_b128 v[110:113], v10 offset:7280
  ds_read_b32 v114, v11 offset:7264
  ds_read_b128 v[116:119], v10 offset:6272
  ds_read_b128 v[120:123], v10 offset:6288
  ds_read_b32 v124, v11 offset:6272
  ds_read_b128 v[126:129], v10 offset:5280
  ds_read_b128 v[130:133], v10 offset:5296
  ds_read_b32 v134, v11 offset:5280
  ds_read_b128 v[136:139], v10 offset:4288
  ds_read_b128 v[140:143], v10 offset:4304
  ds_read_b32 v144, v11 offset:4288
  v_dot2c_f32_bf16 v186, v16, v26
  v_dot2c_f32_bf16 v187, v16, v36
  v_dot2c_f32_bf16 v188, v16, v46
  v_dot2c_f32_bf16 v189, v16, v56
  v_dot2c_f32_bf16 v186, v17, v27
  v_dot2c_f32_bf16 v187, v17, v37
  v_dot2c_f32_bf16 v188, v17, v47
  v_dot2c_f32_bf16 v189, v17, v57
  v_dot2c_f32_bf16 v186, v18, v28
  v_dot2c_f32_bf16 v187, v18, v38
  v_dot2c_f32_bf16 v188, v18, v48
  v_dot2c_f32_bf16 v189, v18, v58
  v_dot2c_f32_bf16 v186, v19, v29
  v_dot2c_f32_bf16 v187, v19, v39
  v_dot2c_f32_bf16 v188, v19, v49
  v_dot2c_f32_bf16 v189, v19, v59
  v_dot2c_f32_bf16 v186, v20, v30
  v_dot2c_f32_bf16 v187, v20, v40
  v_dot2c_f32_bf16 v188, v20, v50
  v_dot2c_f32_bf16 v189, v20, v60
  v_dot2c_f32_bf16 v186, v21, v31
  v_dot2c_f32_bf16 v187, v21, v41
  v_dot2c_f32_bf16 v188, v21, v51
  v_dot2c_f32_bf16 v189, v21, v61
  v_dot2c_f32_bf16 v186, v22, v32
  v_dot2c_f32_bf16 v187, v22, v42
  v_dot2c_f32_bf16 v188, v22, v52
  v_dot2c_f32_bf16 v189, v22, v62
  v_dot2c_f32_bf16 v186, v23, v33
  v_dot2c_f32_bf16 v187, v23, v43
  v_dot2c_f32_bf16 v188, v23, v53
  v_dot2c_f32_bf16 v189, v23, v63
  v_dot2c_f32_bf16 v186, v24, v34
  v_dot2c_f32_bf16 v187, v24, v44
  v_dot2c_f32_bf16 v188, v24, v54
  v_dot2c_f32_bf16 v189, v24, v64
  s_waitcnt lgkmcnt(12)
  ds_read_b128 v[146:149], v10 offset:3296
  ds_read_b128 v[150:153], v10 offset:3312
  ds_read_b32 v154, v11 offset:3296
  ds_read_b128 v[156:159], v10 offset:2304
  ds_read_b128 v[160:163], v10 offset:2320
  ds_read_b32 v164, v11 offset:2304
  ds_read_b128 v[166:169], v10 offset:1312
  ds_read_b128 v[170:173], v10 offset:1328
  ds_read_b32 v174, v11 offset:1312
  ds_read_b128 v[176:179], v10 offset:320
  ds_read_b128 v[180:183], v10 offset:336
  ds_read_b32 v184, v11 offset:320
  v_dot2c_f32_bf16 v190, v16, v66
  v_dot2c_f32_bf16 v191, v16, v76
  v_dot2c_f32_bf16 v192, v16, v86
  v_dot2c_f32_bf16 v193, v16, v96
  v_dot2c_f32_bf16 v190, v17, v67
  v_dot2c_f32_bf16 v191, v17, v77
  v_dot2c_f32_bf16 v192, v17, v87
  v_dot2c_f32_bf16 v193, v17, v97
  v_dot2c_f32_bf16 v190, v18, v68
  v_dot2c_f32_bf16 v191, v18, v78
  v_dot2c_f32_bf16 v192, v18, v88
  v_dot2c_f32_bf16 v193, v18, v98
  v_dot2c_f32_bf16 v190, v19, v69
  v_dot2c_f32_bf16 v191, v19, v79
  v_dot2c_f32_bf16 v192, v19, v89
  v_dot2c_f32_bf16 v193, v19, v99
  v_dot2c_f32_bf16 v190, v20, v70
  v_dot2c_f32_bf16 v191, v20, v80
  v_dot2c_f32_bf16 v192, v20, v90
  v_dot2c_f32_bf16 v193, v20, v100
  v_dot2c_f32_bf16 v190, v21, v71
  v_dot2c_f32_bf16 v191, v21, v81
  v_dot2c_f32_bf16 v192, v21, v91
  v_dot2c_f32_bf16 v193, v21, v101
  v_dot2c_f32_bf16 v190, v22, v72
  v_dot2c_f32_bf16 v191, v22, v82
  v_dot2c_f32_bf16 v192, v22, v92
  v_dot2c_f32_bf16 v193, v22, v102
  v_dot2c_f32_bf16 v190, v23, v73
  v_dot2c_f32_bf16 v191, v23, v83
  v_dot2c_f32_bf16 v192, v23, v93
  v_dot2c_f32_bf16 v193, v23, v103
  v_dot2c_f32_bf16 v190, v24, v74
  v_dot2c_f32_bf16 v191, v24, v84
  v_dot2c_f32_bf16 v192, v24, v94
  v_dot2c_f32_bf16 v193, v24, v104
  v_mov_b32 v6, 0xf149f2ca
  s_nop 2
  v_cndmask_b32 v187, v6, v187, s[66:67]
  v_cndmask_b32 v188, v6, v188, s[68:69]
  v_cndmask_b32 v189, v6, v189, s[70:71]
  v_cndmask_b32 v190, v6, v190, s[72:73]
  v_cndmask_b32 v191, v6, v191, s[74:75]
  v_cndmask_b32 v192, v6, v192, s[76:77]
  v_cndmask_b32 v193, v6, v193, s[78:79]
  v_max3_f32 v6, v186, v187, v188
  v_max3_f32 v6, v6, v189, v190
  v_max3_f32 v6, v6, v191, v192
  v_max_f32 v6, v6, v193
  s_mov_b32 s30, 0x3eae1a93
  v_mul_f32 v6, s30, v6
  v_fma_f32 v186, v186, s30, -v6
  v_fma_f32 v187, v187, s30, -v6
  v_fma_f32 v188, v188, s30, -v6
  v_fma_f32 v189, v189, s30, -v6
  v_fma_f32 v190, v190, s30, -v6
  v_fma_f32 v191, v191, s30, -v6
  v_fma_f32 v192, v192, s30, -v6
  v_fma_f32 v193, v193, s30, -v6
  v_exp_f32 v186, v186
  v_exp_f32 v187, v187
  v_exp_f32 v188, v188
  v_exp_f32 v189, v189
  v_exp_f32 v190, v190
  v_exp_f32 v191, v191
  v_exp_f32 v192, v192
  v_exp_f32 v193, v193
  s_nop 0
  v_add_f32 v6, v186, v187
  v_add_f32 v6, v6, v188
  v_add_f32 v6, v6, v189
  v_add_f32 v6, v6, v190
  v_add_f32 v6, v6, v191
  v_add_f32 v6, v6, v192
  v_add_f32 v6, v6, v193
  v_rcp_f32 v6, v6
  v_mov_b32 v26, 0
  v_mov_b32 v27, 0
  v_mov_b32 v28, 0
  v_mov_b32 v29, 0
  v_mov_b32 v30, 0
  v_mov_b32 v31, 0
  v_mov_b32 v32, 0
  v_mov_b32 v33, 0
  v_mov_b32 v34, 0
  v_mov_b32 v35, 0
  v_mov_b32 v36, 0
  v_mov_b32 v37, 0
  v_mov_b32 v38, 0
  v_mov_b32 v39, 0
  v_mov_b32 v40, 0
  v_mov_b32 v41, 0
  v_mov_b32 v42, 0
  v_mov_b32 v43, 0
  v_mul_f32 v186, v186, v6
  v_mul_f32 v187, v187, v6
  v_mul_f32 v188, v188, v6
  v_mul_f32 v189, v189, v6
  v_mul_f32 v190, v190, v6
  v_mul_f32 v191, v191, v6
  v_mul_f32 v192, v192, v6
  v_mul_f32 v193, v193, v6
  v_cvt_pk_bf16_f32 v46, v186, 0
  v_cvt_pk_bf16_f32 v54, 0, v186
  v_cvt_pk_bf16_f32 v47, v187, 0
  v_cvt_pk_bf16_f32 v55, 0, v187
  v_cvt_pk_bf16_f32 v48, v188, 0
  v_cvt_pk_bf16_f32 v56, 0, v188
  v_cvt_pk_bf16_f32 v49, v189, 0
  v_cvt_pk_bf16_f32 v57, 0, v189
  v_cvt_pk_bf16_f32 v50, v190, 0
  v_cvt_pk_bf16_f32 v58, 0, v190
  v_cvt_pk_bf16_f32 v51, v191, 0
  v_cvt_pk_bf16_f32 v59, 0, v191
  v_cvt_pk_bf16_f32 v52, v192, 0
  v_cvt_pk_bf16_f32 v60, 0, v192
  v_cvt_pk_bf16_f32 v53, v193, 0
  v_cvt_pk_bf16_f32 v61, 0, v193
  s_waitcnt lgkmcnt(0)
  v_dot2c_f32_bf16 v26, v46, v106
  v_dot2c_f32_bf16 v27, v54, v106
  v_dot2c_f32_bf16 v28, v46, v107
  v_dot2c_f32_bf16 v29, v54, v107
  v_dot2c_f32_bf16 v30, v46, v108
  v_dot2c_f32_bf16 v31, v54, v108
  v_dot2c_f32_bf16 v32, v46, v109
  v_dot2c_f32_bf16 v33, v54, v109
  v_dot2c_f32_bf16 v34, v46, v110
  v_dot2c_f32_bf16 v35, v54, v110
  v_dot2c_f32_bf16 v36, v46, v111
  v_dot2c_f32_bf16 v37, v54, v111
  v_dot2c_f32_bf16 v38, v46, v112
  v_dot2c_f32_bf16 v39, v54, v112
  v_dot2c_f32_bf16 v40, v46, v113
  v_dot2c_f32_bf16 v41, v54, v113
  v_dot2c_f32_bf16 v42, v46, v114
  v_dot2c_f32_bf16 v43, v54, v114
  v_dot2c_f32_bf16 v26, v47, v116
  v_dot2c_f32_bf16 v27, v55, v116
  v_dot2c_f32_bf16 v28, v47, v117
  v_dot2c_f32_bf16 v29, v55, v117
  v_dot2c_f32_bf16 v30, v47, v118
  v_dot2c_f32_bf16 v31, v55, v118
  v_dot2c_f32_bf16 v32, v47, v119
  v_dot2c_f32_bf16 v33, v55, v119
  v_dot2c_f32_bf16 v34, v47, v120
  v_dot2c_f32_bf16 v35, v55, v120
  v_dot2c_f32_bf16 v36, v47, v121
  v_dot2c_f32_bf16 v37, v55, v121
  v_dot2c_f32_bf16 v38, v47, v122
  v_dot2c_f32_bf16 v39, v55, v122
  v_dot2c_f32_bf16 v40, v47, v123
  v_dot2c_f32_bf16 v41, v55, v123
  v_dot2c_f32_bf16 v42, v47, v124
  v_dot2c_f32_bf16 v43, v55, v124
  v_dot2c_f32_bf16 v26, v48, v126
  v_dot2c_f32_bf16 v27, v56, v126
  v_dot2c_f32_bf16 v28, v48, v127
  v_dot2c_f32_bf16 v29, v56, v127
  v_dot2c_f32_bf16 v30, v48, v128
  v_dot2c_f32_bf16 v31, v56, v128
  v_dot2c_f32_bf16 v32, v48, v129
  v_dot2c_f32_bf16 v33, v56, v129
  v_dot2c_f32_bf16 v34, v48, v130
  v_dot2c_f32_bf16 v35, v56, v130
  v_dot2c_f32_bf16 v36, v48, v131
  v_dot2c_f32_bf16 v37, v56, v131
  v_dot2c_f32_bf16 v38, v48, v132
  v_dot2c_f32_bf16 v39, v56, v132
  v_dot2c_f32_bf16 v40, v48, v133
  v_dot2c_f32_bf16 v41, v56, v133
  v_dot2c_f32_bf16 v42, v48, v134
  v_dot2c_f32_bf16 v43, v56, v134
  v_dot2c_f32_bf16 v26, v49, v136
  v_dot2c_f32_bf16 v27, v57, v136
  v_dot2c_f32_bf16 v28, v49, v137
  v_dot2c_f32_bf16 v29, v57, v137
  v_dot2c_f32_bf16 v30, v49, v138
  v_dot2c_f32_bf16 v31, v57, v138
  v_dot2c_f32_bf16 v32, v49, v139
  v_dot2c_f32_bf16 v33, v57, v139
  v_dot2c_f32_bf16 v34, v49, v140
  v_dot2c_f32_bf16 v35, v57, v140
  v_dot2c_f32_bf16 v36, v49, v141
  v_dot2c_f32_bf16 v37, v57, v141
  v_dot2c_f32_bf16 v38, v49, v142
  v_dot2c_f32_bf16 v39, v57, v142
  v_dot2c_f32_bf16 v40, v49, v143
  v_dot2c_f32_bf16 v41, v57, v143
  v_dot2c_f32_bf16 v42, v49, v144
  v_dot2c_f32_bf16 v43, v57, v144
  v_dot2c_f32_bf16 v26, v50, v146
  v_dot2c_f32_bf16 v27, v58, v146
  v_dot2c_f32_bf16 v28, v50, v147
  v_dot2c_f32_bf16 v29, v58, v147
  v_dot2c_f32_bf16 v30, v50, v148
  v_dot2c_f32_bf16 v31, v58, v148
  v_dot2c_f32_bf16 v32, v50, v149
  v_dot2c_f32_bf16 v33, v58, v149
  v_dot2c_f32_bf16 v34, v50, v150
  v_dot2c_f32_bf16 v35, v58, v150
  v_dot2c_f32_bf16 v36, v50, v151
  v_dot2c_f32_bf16 v37, v58, v151
  v_dot2c_f32_bf16 v38, v50, v152
  v_dot2c_f32_bf16 v39, v58, v152
  v_dot2c_f32_bf16 v40, v50, v153
  v_dot2c_f32_bf16 v41, v58, v153
  v_dot2c_f32_bf16 v42, v50, v154
  v_dot2c_f32_bf16 v43, v58, v154
  v_dot2c_f32_bf16 v26, v51, v156
  v_dot2c_f32_bf16 v27, v59, v156
  v_dot2c_f32_bf16 v28, v51, v157
  v_dot2c_f32_bf16 v29, v59, v157
  v_dot2c_f32_bf16 v30, v51, v158
  v_dot2c_f32_bf16 v31, v59, v158
  v_dot2c_f32_bf16 v32, v51, v159
  v_dot2c_f32_bf16 v33, v59, v159
  v_dot2c_f32_bf16 v34, v51, v160
  v_dot2c_f32_bf16 v35, v59, v160
  v_dot2c_f32_bf16 v36, v51, v161
  v_dot2c_f32_bf16 v37, v59, v161
  v_dot2c_f32_bf16 v38, v51, v162
  v_dot2c_f32_bf16 v39, v59, v162
  v_dot2c_f32_bf16 v40, v51, v163
  v_dot2c_f32_bf16 v41, v59, v163
  v_dot2c_f32_bf16 v42, v51, v164
  v_dot2c_f32_bf16 v43, v59, v164
  v_dot2c_f32_bf16 v26, v52, v166
  v_dot2c_f32_bf16 v27, v60, v166
  v_dot2c_f32_bf16 v28, v52, v167
  v_dot2c_f32_bf16 v29, v60, v167
  v_dot2c_f32_bf16 v30, v52, v168
  v_dot2c_f32_bf16 v31, v60, v168
  v_dot2c_f32_bf16 v32, v52, v169
  v_dot2c_f32_bf16 v33, v60, v169
  v_dot2c_f32_bf16 v34, v52, v170
  v_dot2c_f32_bf16 v35, v60, v170
  v_dot2c_f32_bf16 v36, v52, v171
  v_dot2c_f32_bf16 v37, v60, v171
  v_dot2c_f32_bf16 v38, v52, v172
  v_dot2c_f32_bf16 v39, v60, v172
  v_dot2c_f32_bf16 v40, v52, v173
  v_dot2c_f32_bf16 v41, v60, v173
  v_dot2c_f32_bf16 v42, v52, v174
  v_dot2c_f32_bf16 v43, v60, v174
  v_dot2c_f32_bf16 v26, v53, v176
  v_dot2c_f32_bf16 v27, v61, v176
  v_dot2c_f32_bf16 v28, v53, v177
  v_dot2c_f32_bf16 v29, v61, v177
  v_dot2c_f32_bf16 v30, v53, v178
  v_dot2c_f32_bf16 v31, v61, v178
  v_dot2c_f32_bf16 v32, v53, v179
  v_dot2c_f32_bf16 v33, v61, v179
  v_dot2c_f32_bf16 v34, v53, v180
  v_dot2c_f32_bf16 v35, v61, v180
  v_dot2c_f32_bf16 v36, v53, v181
  v_dot2c_f32_bf16 v37, v61, v181
  v_dot2c_f32_bf16 v38, v53, v182
  v_dot2c_f32_bf16 v39, v61, v182
  v_dot2c_f32_bf16 v40, v53, v183
  v_dot2c_f32_bf16 v41, v61, v183
  v_dot2c_f32_bf16 v42, v53, v184
  v_dot2c_f32_bf16 v43, v61, v184
  s_nop 2
  v_cvt_pk_bf16_f32 v16, v26, v27
  v_cvt_pk_bf16_f32 v17, v28, v29
  v_cvt_pk_bf16_f32 v18, v30, v31
  v_cvt_pk_bf16_f32 v19, v32, v33
  v_cvt_pk_bf16_f32 v20, v34, v35
  v_cvt_pk_bf16_f32 v21, v36, v37
  v_cvt_pk_bf16_f32 v22, v38, v39
  v_cvt_pk_bf16_f32 v23, v40, v41
  v_cvt_pk_bf16_f32 v24, v42, v43
  s_lshl_b32 s50, s31, 2
  v_add_u32 v6, s50, v13
  ds_write_b64 v6, v[16:17] offset:0
  ds_write_b64 v6, v[18:19] offset:8
  ds_write_b64 v6, v[20:21] offset:16
  ds_write_b64 v6, v[22:23] offset:24
  s_xor_b32 s31, s31, 1
  s_lshl_b32 s31, s31, 5
  v_add_u32 v7, s31, v13
  ds_write_b32 v7, v24
  s_lshl_b32 s28, s25, 4
  v_add_u32 v6, s28, v2
  v_mul_u32_u24 v6, 144, v6
  v_lshl_add_u32 v6, v3, 4, v6
  v_add_u32 v6, 73728, v6
  v_lshlrev_b32 v7, 4, v1
  v_cmp_eq_u32 vcc, 0, v3
  v_mov_b32 v8, 0x80000000
  s_lshl_b32 s28, s23, 3
  s_add_u32 s28, s28, s25
  v_cndmask_b32 v8, v8, v7, vcc
  s_mul_i32 s28, s28, 72
  s_mul_i32 s29, s24, 9
  s_add_u32 s28, s28, s29
  s_lshl_b32 s28, s28, 8
  s_add_u32 s28, s28, 4718592
  s_waitcnt lgkmcnt(0)
  s_barrier
  ds_read_b128 v[26:29], v6 offset:0
  ds_read_b128 v[30:33], v6 offset:64
  ds_read_b128 v[34:37], v6 offset:128
  s_waitcnt lgkmcnt(2)
  buffer_store_dwordx4 v[26:29], v7, s[40:43], s28 offen offset:0
  s_waitcnt lgkmcnt(1)
  buffer_store_dwordx4 v[30:33], v7, s[40:43], s28 offen offset:1024
  s_waitcnt lgkmcnt(0)
  buffer_store_dwordx4 v[34:37], v8, s[40:43], s28 offen offset:2048
  s_endpgm
k1_end:
  s_endpgm
.globl k2_kernel
.p2align 8
.type k2_kernel,@function
k2_kernel:
  s_cmp_ge_u32 s2, 256
  s_cbranch_scc1 k2_end
  s_load_dwordx2 s[4:5], s[0:1], 24
  s_load_dwordx4 s[8:11], s[0:1], 48
  s_load_dwordx2 s[12:13], s[0:1], 72
  s_and_b32 s20, s2, 7
  s_lshr_b32 s21, s2, 3
  v_lshrrev_b32 v6, 6, v0
  v_and_b32 v1, 63, v0
  v_readfirstlane_b32 s22, v6
  v_and_b32 v2, 15, v0
  v_lshrrev_b32 v3, 4, v1
  v_bfe_u32 v4, v0, 2, 2
  v_and_b32 v5, 3, v0
  s_mul_i32 s40, s20, 28
  s_add_u32 s40, s40, s21
  s_cmp_lt_u32 s21, 28
  s_cselect_b32 s40, s40, 255
  s_mul_i32 s41, s40, 6554
  s_lshr_b32 s41, s41, 16
  s_mul_i32 s42, s41, 10
  s_sub_u32 s42, s40, s42
  s_mul_i32 s43, s41, 6
  s_add_u32 s43, s43, s22
  s_lshl_b32 s44, s41, 1
  s_add_u32 s44, s44, s42
  s_mul_i32 s16, s44, 7282
  s_lshr_b32 s16, s16, 16
  s_mul_i32 s16, s16, 9
  s_sub_u32 s44, s44, s16
  v_lshlrev_b32 v14, 4, v1
  v_and_b32 v6, 1, v3
  v_lshlrev_b32 v6, 1, v6
  v_and_b32 v7, 7, v1
  v_xor_b32 v6, v6, v7
  v_lshrrev_b32 v7, 3, v1
  v_mul_u32_u24 v7, 1152, v7
  v_lshl_add_u32 v16, v6, 4, v7
  v_xor_b32 v17, 64, v16
  s_lshl_b32 s45, s42, 7
  s_mov_b32 s46, 2359296
  s_movk_i32 s16, 2176
  s_cmp_eq_u32 s42, 9
  s_cselect_b32 s47, s16, s45
  s_cselect_b32 s45, 1024, s45
  s_cselect_b32 s46, 4718592, s46
  s_and_b32 s48, s22, 3
  s_lshr_b32 s16, s21, 3
  s_lshl_b32 s17, s20, 2
  s_add_u32 s16, s16, s17
  s_and_b32 s17, s21, 7
  s_lshl_b32 s49, s16, 2
  s_add_u32 s49, s49, s48
  s_lshl_b32 s50, s16, 1
  s_add_u32 s50, s50, s17
  s_mul_i32 s16, s50, 7282
  s_lshr_b32 s16, s16, 16
  s_mul_i32 s16, s16, 9
  s_sub_u32 s50, s50, s16
  s_lshl_b32 s51, s17, 7
  s_add_u32 s52, s51, 1152
  s_lshl_b32 s53, s21, 2
  s_add_u32 s53, s53, s48
  s_mul_i32 s53, s53, 72
  s_mul_i32 s16, s20, 9
  s_add_u32 s53, s53, s16
  s_lshl_b32 s53, s53, 8
  v_and_b32 v7, 255, v0
  v_lshlrev_b32 v18, 4, v7
  v_add_u32 v19, 4096, v18
  v_cmp_gt_u32 vcc, 86, v7
  v_mov_b32 v6, 0x80000000
  s_mul_i32 s54, s20, 5472
  v_cndmask_b32 v19, v6, v19, vcc
  s_add_u32 s54, s54, 7077888
  s_and_b32 s55, s21, 15
  s_mul_i32 s55, s55, 43776
  s_waitcnt lgkmcnt(0)
  s_mov_b32 s24, s12
  s_and_b32 s25, s13, 0xffff
  s_mov_b32 s26, 8388608
  s_mov_b32 s27, 0x00020000
  s_mov_b32 s28, s8
  s_and_b32 s29, s9, 0xffff
  s_mov_b32 s30, 663552
  s_mov_b32 s31, 0x00020000
  s_mov_b32 s32, s10
  s_and_b32 s33, s11, 0xffff
  s_mov_b32 s34, 4718592
  s_mov_b32 s35, 0x00020000
  s_cmp_eq_u32 s42, 9
  s_cselect_b32 s4, s8, s4
  s_cselect_b32 s5, s9, s5
  s_mov_b32 s36, s4
  s_and_b32 s37, s5, 0xffff
  s_mov_b32 s38, 663552
  s_mov_b32 s39, 0x00020000
  s_mov_b32 s58, 0x00003f80
  s_mov_b32 s59, 0x3f800000
  s_cmp_ge_u32 s22, 4
  s_cbranch_scc1 k2_X
  s_add_u32 s16, s53, 0
  v_lshlrev_b32 v6, 4, v2
  buffer_load_dwordx4 v[152:155], v14, s[24:27], s16 offen offset:0
  buffer_load_dwordx4 v[156:159], v14, s[24:27], s16 offen offset:1024
  buffer_load_dwordx4 v[160:163], v6, s[24:27], s16 offen offset:2048
  s_mul_i32 s16, s20, 15360
  s_add_u32 s16, s16, 7798784
  buffer_load_dwordx4 v[164:167], v14, s[24:27], s16 offen offset:0
  buffer_load_dwordx4 v[168:171], v14, s[24:27], s16 offen offset:1024
  buffer_load_dwordx4 v[172:175], v14, s[24:27], s16 offen offset:2048
  buffer_load_dwordx4 v[176:179], v14, s[24:27], s16 offen offset:3072
  s_add_u32 s16, s16, 4096
  buffer_load_dwordx4 v[180:183], v14, s[24:27], s16 offen offset:0
  buffer_load_dwordx4 v[184:187], v14, s[24:27], s16 offen offset:1024
  buffer_load_dwordx4 v[188:191], v14, s[24:27], s16 offen offset:2048
  buffer_load_dwordx4 v[192:195], v14, s[24:27], s16 offen offset:3072
  s_add_u32 s16, s16, 4096
  buffer_load_dwordx4 v[196:199], v14, s[24:27], s16 offen offset:0
  buffer_load_dwordx4 v[200:203], v14, s[24:27], s16 offen offset:1024
  buffer_load_dwordx4 v[204:207], v14, s[24:27], s16 offen offset:2048
  buffer_load_dwordx4 v[208:211], v14, s[24:27], s16 offen offset:3072
  s_add_u32 s16, s16, 4096
  buffer_load_dwordx4 v[212:215], v14, s[24:27], s16 offen offset:0
  buffer_load_dwordx4 v[216:219], v14, s[24:27], s16 offen offset:1024
  buffer_load_dwordx4 v[220:223], v14, s[24:27], s16 offen offset:2048
  s_cmp_ge_u32 s22, 2
  s_cbranch_scc1 k2_A23
  s_add_u32 s17, s54, s55
  buffer_load_dwordx4 v[88:91], v19, s[24:27], s17 offen
  s_add_u32 s55, s55, 43776
  s_cmp_eq_u32 s55, 700416
  s_cselect_b32 s55, 0, s55
  s_add_u32 s17, s54, s55
  buffer_load_dwordx4 v[92:95], v19, s[24:27], s17 offen
  s_add_u32 s55, s55, 43776
  s_cmp_eq_u32 s55, 700416
  s_cselect_b32 s55, 0, s55
  s_add_u32 s17, s54, s55
  buffer_load_dwordx4 v[96:99], v19, s[24:27], s17 offen
  s_add_u32 s55, s55, 43776
  s_cmp_eq_u32 s55, 700416
  s_cselect_b32 s55, 0, s55
  s_add_u32 s17, s54, s55
  buffer_load_dwordx4 v[100:103], v19, s[24:27], s17 offen
  s_add_u32 s55, s55, 43776
  s_cmp_eq_u32 s55, 700416
  s_cselect_b32 s55, 0, s55
  s_add_u32 s17, s54, s55
  buffer_load_dwordx4 v[104:107], v19, s[24:27], s17 offen
  s_add_u32 s55, s55, 43776
  s_cmp_eq_u32 s55, 700416
  s_cselect_b32 s55, 0, s55
  s_add_u32 s17, s54, s55
  buffer_load_dwordx4 v[108:111], v19, s[24:27], s17 offen
  s_add_u32 s55, s55, 43776
  s_cmp_eq_u32 s55, 700416
  s_cselect_b32 s55, 0, s55
  s_add_u32 s17, s54, s55
  buffer_load_dwordx4 v[112:115], v19, s[24:27], s17 offen
  s_add_u32 s55, s55, 43776
  s_cmp_eq_u32 s55, 700416
  s_cselect_b32 s55, 0, s55
  s_add_u32 s17, s54, s55
  buffer_load_dwordx4 v[116:119], v19, s[24:27], s17 offen
  s_add_u32 s55, s55, 43776
  s_cmp_eq_u32 s55, 700416
  s_cselect_b32 s55, 0, s55
  s_add_u32 s17, s54, s55
  buffer_load_dwordx4 v[120:123], v19, s[24:27], s17 offen
  s_add_u32 s55, s55, 43776
  s_cmp_eq_u32 s55, 700416
  s_cselect_b32 s55, 0, s55
  s_add_u32 s17, s54, s55
  buffer_load_dwordx4 v[124:127], v19, s[24:27], s17 offen
  s_add_u32 s55, s55, 43776
  s_cmp_eq_u32 s55, 700416
  s_cselect_b32 s55, 0, s55
  s_add_u32 s17, s54, s55
  buffer_load_dwordx4 v[128:131], v19, s[24:27], s17 offen
  s_add_u32 s55, s55, 43776
  s_cmp_eq_u32 s55, 700416
  s_cselect_b32 s55, 0, s55
  s_add_u32 s17, s54, s55
  buffer_load_dwordx4 v[132:135], v19, s[24:27], s17 offen
  s_add_u32 s55, s55, 43776
  s_cmp_eq_u32 s55, 700416
  s_cselect_b32 s55, 0, s55
  s_add_u32 s17, s54, s55
  buffer_load_dwordx4 v[136:139], v19, s[24:27], s17 offen
  s_add_u32 s55, s55, 43776
  s_cmp_eq_u32 s55, 700416
  s_cselect_b32 s55, 0, s55
  s_add_u32 s17, s54, s55
  buffer_load_dwordx4 v[140:143], v19, s[24:27], s17 offen
  s_add_u32 s55, s55, 43776
  s_cmp_eq_u32 s55, 700416
  s_cselect_b32 s55, 0, s55
  s_add_u32 s17, s54, s55
  buffer_load_dwordx4 v[144:147], v19, s[24:27], s17 offen
  s_add_u32 s55, s55, 43776
  s_cmp_eq_u32 s55, 700416
  s_cselect_b32 s55, 0, s55
  s_add_u32 s17, s54, s55
  buffer_load_dwordx4 v[148:151], v19, s[24:27], s17 offen
  s_add_u32 s55, s55, 43776
  s_cmp_eq_u32 s55, 700416
  s_cselect_b32 s55, 0, s55
  v_and_b32 v6, 255, v0
  v_lshlrev_b32 v6, 1, v6
  v_add_u32 v6, 512, v6
  v_mul_u32_u24 v7, 6133, v6
  v_lshrrev_b32 v7, 20, v7
  v_mul_u32_u24 v8, 171, v7
  v_sub_u32 v8, v6, v8
  v_mul_u32_u24 v9, 7282, v8
  v_lshrrev_b32 v9, 16, v9
  v_mul_u32_u24 v10, 9, v9
  v_sub_u32 v10, v8, v10
  v_mul_u32_u24 v7, 20, v7
  v_add_u32 v7, v7, v9
  v_mul_u32_u24 v7, 80, v7
  v_lshl_add_u32 v22, v10, 3, v7
  v_cmp_gt_u32 vcc, 684, v6
  v_mov_b32 v8, 7936
  s_nop 1
  v_cndmask_b32 v22, v8, v22, vcc
  v_add_u32 v22, 129024, v22
  v_and_b32 v6, 255, v0
  v_lshlrev_b32 v6, 1, v6
  v_add_u32 v6, 513, v6
  v_mul_u32_u24 v7, 6133, v6
  v_lshrrev_b32 v7, 20, v7
  v_mul_u32_u24 v8, 171, v7
  v_sub_u32 v8, v6, v8
  v_mul_u32_u24 v9, 7282, v8
  v_lshrrev_b32 v9, 16, v9
  v_mul_u32_u24 v10, 9, v9
  v_sub_u32 v10, v8, v10
  v_mul_u32_u24 v7, 20, v7
  v_add_u32 v7, v7, v9
  v_mul_u32_u24 v7, 80, v7
  v_lshl_add_u32 v23, v10, 3, v7
  v_cmp_gt_u32 vcc, 684, v6
  v_mov_b32 v8, 7936
  s_nop 1
  v_cndmask_b32 v23, v8, v23, vcc
  v_add_u32 v23, 129024, v23
  s_waitcnt vmcnt(16)
k2_A23:
  s_mov_b32 s60, 0x3fb8aa3b
  s_mov_b32 s61, 0x3fb8aa3b
  s_cmp_lt_u32 s22, 2
  s_cbranch_scc1 k2_A01
  s_waitcnt vmcnt(0)
k2_A01:
  v_mfma_f32_16x16x32_bf16 v[224:227], v[164:167], v[152:155], 0
  v_mfma_f32_16x16x32_bf16 v[224:227], v[168:171], v[156:159], v[224:227]
  v_mfma_f32_16x16x32_bf16 v[224:227], v[172:175], v[160:163], v[224:227]
  v_mfma_f32_16x16x32_bf16 v[228:231], v[176:179], v[152:155], 0
  v_mfma_f32_16x16x32_bf16 v[228:231], v[180:183], v[156:159], v[228:231]
  v_mfma_f32_16x16x32_bf16 v[228:231], v[184:187], v[160:163], v[228:231]
  v_mfma_f32_16x16x32_bf16 v[232:235], v[188:191], v[152:155], 0
  v_mfma_f32_16x16x32_bf16 v[232:235], v[192:195], v[156:159], v[232:235]
  v_mfma_f32_16x16x32_bf16 v[232:235], v[196:199], v[160:163], v[232:235]
  v_mfma_f32_16x16x32_bf16 v[236:239], v[200:203], v[152:155], 0
  v_mfma_f32_16x16x32_bf16 v[236:239], v[204:207], v[156:159], v[236:239]
  v_mfma_f32_16x16x32_bf16 v[236:239], v[208:211], v[160:163], v[236:239]
  v_mfma_f32_16x16x32_bf16 v[240:243], v[212:215], v[152:155], 0
  v_mfma_f32_16x16x32_bf16 v[240:243], v[216:219], v[156:159], v[240:243]
  v_mfma_f32_16x16x32_bf16 v[240:243], v[220:223], v[160:163], v[240:243]
  s_nop 7
  v_max3_f32 v6, v224, v225, v226
  v_min3_f32 v7, v224, v225, v226
  v_max3_f32 v6, v6, v227, v228
  v_min3_f32 v7, v7, v227, v228
  v_max3_f32 v6, v6, v229, v230
  v_min3_f32 v7, v7, v229, v230
  v_max3_f32 v6, v6, v231, v232
  v_min3_f32 v7, v7, v231, v232
  v_max3_f32 v6, v6, v233, v234
  v_min3_f32 v7, v7, v233, v234
  v_max3_f32 v6, v6, v235, v236
  v_min3_f32 v7, v7, v235, v236
  v_max3_f32 v6, v6, v237, v238
  v_min3_f32 v7, v7, v237, v238
  v_max3_f32 v6, v6, v239, v240
  v_min3_f32 v7, v7, v239, v240
  v_max_f32 v6, v6, v241
  v_min_f32 v7, v7, v241
  v_mul_f32 v8, s60, v6
  v_mul_f32 v10, s60, v7
  v_pk_fma_f32 v[164:165], v[224:225], s[60:61], v[8:9] op_sel_hi:[1,1,0] neg_lo:[0,0,1] neg_hi:[0,0,1]
  v_pk_fma_f32 v[182:183], v[224:225], s[60:61], v[10:11] op_sel_hi:[1,1,0] neg_lo:[1,0,0] neg_hi:[1,0,0]
  v_pk_fma_f32 v[166:167], v[226:227], s[60:61], v[8:9] op_sel_hi:[1,1,0] neg_lo:[0,0,1] neg_hi:[0,0,1]
  v_pk_fma_f32 v[184:185], v[226:227], s[60:61], v[10:11] op_sel_hi:[1,1,0] neg_lo:[1,0,0] neg_hi:[1,0,0]
  v_pk_fma_f32 v[168:169], v[228:229], s[60:61], v[8:9] op_sel_hi:[1,1,0] neg_lo:[0,0,1] neg_hi:[0,0,1]
  v_pk_fma_f32 v[186:187], v[228:229], s[60:61], v[10:11] op_sel_hi:[1,1,0] neg_lo:[1,0,0] neg_hi:[1,0,0]
  v_pk_fma_f32 v[170:171], v[230:231], s[60:61], v[8:9] op_sel_hi:[1,1,0] neg_lo:[0,0,1] neg_hi:[0,0,1]
  v_pk_fma_f32 v[188:189], v[230:231], s[60:61], v[10:11] op_sel_hi:[1,1,0] neg_lo:[1,0,0] neg_hi:[1,0,0]
  v_pk_fma_f32 v[172:173], v[232:233], s[60:61], v[8:9] op_sel_hi:[1,1,0] neg_lo:[0,0,1] neg_hi:[0,0,1]
  v_pk_fma_f32 v[190:191], v[232:233], s[60:61], v[10:11] op_sel_hi:[1,1,0] neg_lo:[1,0,0] neg_hi:[1,0,0]
  v_pk_fma_f32 v[174:175], v[234:235], s[60:61], v[8:9] op_sel_hi:[1,1,0] neg_lo:[0,0,1] neg_hi:[0,0,1]
  v_pk_fma_f32 v[192:193], v[234:235], s[60:61], v[10:11] op_sel_hi:[1,1,0] neg_lo:[1,0,0] neg_hi:[1,0,0]
  v_pk_fma_f32 v[176:177], v[236:237], s[60:61], v[8:9] op_sel_hi:[1,1,0] neg_lo:[0,0,1] neg_hi:[0,0,1]
  v_pk_fma_f32 v[194:195], v[236:237], s[60:61], v[10:11] op_sel_hi:[1,1,0] neg_lo:[1,0,0] neg_hi:[1,0,0]
  v_pk_fma_f32 v[178:179], v[238:239], s[60:61], v[8:9] op_sel_hi:[1,1,0] neg_lo:[0,0,1] neg_hi:[0,0,1]
  v_pk_fma_f32 v[196:197], v[238:239], s[60:61], v[10:11] op_sel_hi:[1,1,0] neg_lo:[1,0,0] neg_hi:[1,0,0]
  v_pk_fma_f32 v[180:181], v[240:241], s[60:61], v[8:9] op_sel_hi:[1,1,0] neg_lo:[0,0,1] neg_hi:[0,0,1]
  v_pk_fma_f32 v[198:199], v[240:241], s[60:61], v[10:11] op_sel_hi:[1,1,0] neg_lo:[1,0,0] neg_hi:[1,0,0]
  v_exp_f32 v164, v164
  v_exp_f32 v182, v182
  v_exp_f32 v165, v165
  v_exp_f32 v183, v183
  v_exp_f32 v166, v166
  v_exp_f32 v184, v184
  v_exp_f32 v167, v167
  v_exp_f32 v185, v185
  v_exp_f32 v168, v168
  v_exp_f32 v186, v186
  v_exp_f32 v169, v169
  v_exp_f32 v187, v187
  v_exp_f32 v170, v170
  v_exp_f32 v188, v188
  v_exp_f32 v171, v171
  v_exp_f32 v189, v189
  v_exp_f32 v172, v172
  v_exp_f32 v190, v190
  v_exp_f32 v173, v173
  v_exp_f32 v191, v191
  v_exp_f32 v174, v174
  v_exp_f32 v192, v192
  v_exp_f32 v175, v175
  v_exp_f32 v193, v193
  v_exp_f32 v176, v176
  v_exp_f32 v194, v194
  v_exp_f32 v177, v177
  v_exp_f32 v195, v195
  v_exp_f32 v178, v178
  v_exp_f32 v196, v196
  v_exp_f32 v179, v179
  v_exp_f32 v197, v197
  v_exp_f32 v180, v180
  v_exp_f32 v198, v198
  v_exp_f32 v181, v181
  v_exp_f32 v199, v199
  v_pk_add_f32 v[8:9], v[164:165], v[166:167]
  v_pk_add_f32 v[10:11], v[182:183], v[184:185]
  v_pk_add_f32 v[8:9], v[8:9], v[168:169]
  v_pk_add_f32 v[10:11], v[10:11], v[186:187]
  v_pk_add_f32 v[8:9], v[8:9], v[170:171]
  v_pk_add_f32 v[10:11], v[10:11], v[188:189]
  v_pk_add_f32 v[8:9], v[8:9], v[172:173]
  v_pk_add_f32 v[10:11], v[10:11], v[190:191]
  v_pk_add_f32 v[8:9], v[8:9], v[174:175]
  v_pk_add_f32 v[10:11], v[10:11], v[192:193]
  v_pk_add_f32 v[8:9], v[8:9], v[176:177]
  v_pk_add_f32 v[10:11], v[10:11], v[194:195]
  v_pk_add_f32 v[8:9], v[8:9], v[178:179]
  v_pk_add_f32 v[10:11], v[10:11], v[196:197]
  v_pk_add_f32 v[8:9], v[8:9], v[180:181]
  v_pk_add_f32 v[10:11], v[10:11], v[198:199]
  v_add_f32 v8, v8, v9
  v_add_f32 v10, v10, v11
  v_rcp_f32 v8, v8
  v_rcp_f32 v10, v10
  s_nop 0
  v_pk_mul_f32 v[164:165], v[164:165], v[8:9] op_sel_hi:[1,0]
  v_pk_mul_f32 v[182:183], v[182:183], v[10:11] op_sel_hi:[1,0]
  v_pk_mul_f32 v[166:167], v[166:167], v[8:9] op_sel_hi:[1,0]
  v_pk_mul_f32 v[184:185], v[184:185], v[10:11] op_sel_hi:[1,0]
  v_pk_mul_f32 v[168:169], v[168:169], v[8:9] op_sel_hi:[1,0]
  v_pk_mul_f32 v[186:187], v[186:187], v[10:11] op_sel_hi:[1,0]
  v_pk_mul_f32 v[170:171], v[170:171], v[8:9] op_sel_hi:[1,0]
  v_pk_mul_f32 v[188:189], v[188:189], v[10:11] op_sel_hi:[1,0]
  v_pk_mul_f32 v[172:173], v[172:173], v[8:9] op_sel_hi:[1,0]
  v_pk_mul_f32 v[190:191], v[190:191], v[10:11] op_sel_hi:[1,0]
  v_pk_mul_f32 v[174:175], v[174:175], v[8:9] op_sel_hi:[1,0]
  v_pk_mul_f32 v[192:193], v[192:193], v[10:11] op_sel_hi:[1,0]
  v_pk_mul_f32 v[176:177], v[176:177], v[8:9] op_sel_hi:[1,0]
  v_pk_mul_f32 v[194:195], v[194:195], v[10:11] op_sel_hi:[1,0]
  v_pk_mul_f32 v[178:179], v[178:179], v[8:9] op_sel_hi:[1,0]
  v_pk_mul_f32 v[196:197], v[196:197], v[10:11] op_sel_hi:[1,0]
  v_pk_mul_f32 v[180:181], v[180:181], v[8:9] op_sel_hi:[1,0]
  v_pk_mul_f32 v[198:199], v[198:199], v[10:11] op_sel_hi:[1,0]
  v_cvt_pk_bf16_f32 v200, v164, v165
  v_cvt_pk_bf16_f32 v209, v182, v183
  v_cvt_pk_bf16_f32 v201, v166, v167
  v_cvt_pk_bf16_f32 v210, v184, v185
  v_cvt_pk_bf16_f32 v202, v168, v169
  v_cvt_pk_bf16_f32 v211, v186, v187
  v_cvt_pk_bf16_f32 v203, v170, v171
  v_cvt_pk_bf16_f32 v212, v188, v189
  v_cvt_pk_bf16_f32 v204, v172, v173
  v_cvt_pk_bf16_f32 v213, v190, v191
  v_cvt_pk_bf16_f32 v205, v174, v175
  v_cvt_pk_bf16_f32 v214, v192, v193
  v_cvt_pk_bf16_f32 v206, v176, v177
  v_cvt_pk_bf16_f32 v215, v194, v195
  v_cvt_pk_bf16_f32 v207, v178, v179
  v_cvt_pk_bf16_f32 v216, v196, v197
  v_cvt_pk_bf16_f32 v208, v180, v181
  v_cvt_pk_bf16_f32 v217, v198, v199
  v_mov_b32 v218, 0
  v_mov_b32 v219, 0
  v_lshrrev_b32 v6, 2, v2
  v_cmp_eq_u32 vcc, v6, v3
  v_mul_u32_u24 v7, 20, v6
  v_and_b32 v8, 3, v2
  v_add_u32 v7, v7, v8
  v_mul_u32_u24 v7, 80, v7
  v_add_u32 v7, 129024, v7
  v_mov_b32 v8, 135424
  v_cndmask_b32 v7, v8, v7, vcc
  s_lshl_b32 s16, s22, 4
  v_add_u32 v8, s16, v2
  v_mul_u32_u24 v8, 144, v8
  v_add_u32 v8, 137024, v8
  v_mul_u32_u24 v9, 36, v3
  v_add_u32 v9, v9, v8
  v_lshl_add_u32 v8, v3, 4, v8
  v_cmp_eq_u32 vcc, 0, v3
  v_mov_b32 v10, 0x80000000
  s_add_u32 s53, s53, 2359296
  v_cndmask_b32 v10, v10, v14, vcc
  s_cmp_ge_u32 s22, 2
  s_cbranch_scc1 k2_Anr
  s_waitcnt vmcnt(0)
  v_mov_b32 v24, 0
  v_mov_b32 v25, 0
  v_mov_b32 v26, 0
  v_mov_b32 v27, 0
  v_mov_b32 v28, 0
  v_mov_b32 v29, 0
  v_mov_b32 v30, 0
  v_mov_b32 v31, 0
  v_dot2c_f32_bf16 v24, s58, v88
  v_dot2c_f32_bf16 v25, s59, v88
  v_dot2c_f32_bf16 v26, s58, v89
  v_dot2c_f32_bf16 v27, s59, v89
  v_dot2c_f32_bf16 v28, s58, v90
  v_dot2c_f32_bf16 v29, s59, v90
  v_dot2c_f32_bf16 v30, s58, v91
  v_dot2c_f32_bf16 v31, s59, v91
  v_dot2c_f32_bf16 v24, s58, v92
  v_dot2c_f32_bf16 v25, s59, v92
  v_dot2c_f32_bf16 v26, s58, v93
  v_dot2c_f32_bf16 v27, s59, v93
  v_dot2c_f32_bf16 v28, s58, v94
  v_dot2c_f32_bf16 v29, s59, v94
  v_dot2c_f32_bf16 v30, s58, v95
  v_dot2c_f32_bf16 v31, s59, v95
  v_dot2c_f32_bf16 v24, s58, v96
  v_dot2c_f32_bf16 v25, s59, v96
  v_dot2c_f32_bf16 v26, s58, v97
  v_dot2c_f32_bf16 v27, s59, v97
  v_dot2c_f32_bf16 v28, s58, v98
  v_dot2c_f32_bf16 v29, s59, v98
  v_dot2c_f32_bf16 v30, s58, v99
  v_dot2c_f32_bf16 v31, s59, v99
  v_dot2c_f32_bf16 v24, s58, v100
  v_dot2c_f32_bf16 v25, s59, v100
  v_dot2c_f32_bf16 v26, s58, v101
  v_dot2c_f32_bf16 v27, s59, v101
  v_dot2c_f32_bf16 v28, s58, v102
  v_dot2c_f32_bf16 v29, s59, v102
  v_dot2c_f32_bf16 v30, s58, v103
  v_dot2c_f32_bf16 v31, s59, v103
  v_dot2c_f32_bf16 v24, s58, v104
  v_dot2c_f32_bf16 v25, s59, v104
  v_dot2c_f32_bf16 v26, s58, v105
  v_dot2c_f32_bf16 v27, s59, v105
  v_dot2c_f32_bf16 v28, s58, v106
  v_dot2c_f32_bf16 v29, s59, v106
  v_dot2c_f32_bf16 v30, s58, v107
  v_dot2c_f32_bf16 v31, s59, v107
  v_dot2c_f32_bf16 v24, s58, v108
  v_dot2c_f32_bf16 v25, s59, v108
  v_dot2c_f32_bf16 v26, s58, v109
  v_dot2c_f32_bf16 v27, s59, v109
  v_dot2c_f32_bf16 v28, s58, v110
  v_dot2c_f32_bf16 v29, s59, v110
  v_dot2c_f32_bf16 v30, s58, v111
  v_dot2c_f32_bf16 v31, s59, v111
  v_dot2c_f32_bf16 v24, s58, v112
  v_dot2c_f32_bf16 v25, s59, v112
  v_dot2c_f32_bf16 v26, s58, v113
  v_dot2c_f32_bf16 v27, s59, v113
  v_dot2c_f32_bf16 v28, s58, v114
  v_dot2c_f32_bf16 v29, s59, v114
  v_dot2c_f32_bf16 v30, s58, v115
  v_dot2c_f32_bf16 v31, s59, v115
  v_dot2c_f32_bf16 v24, s58, v116
  v_dot2c_f32_bf16 v25, s59, v116
  v_dot2c_f32_bf16 v26, s58, v117
  v_dot2c_f32_bf16 v27, s59, v117
  v_dot2c_f32_bf16 v28, s58, v118
  v_dot2c_f32_bf16 v29, s59, v118
  v_dot2c_f32_bf16 v30, s58, v119
  v_dot2c_f32_bf16 v31, s59, v119
  v_dot2c_f32_bf16 v24, s58, v120
  v_dot2c_f32_bf16 v25, s59, v120
  v_dot2c_f32_bf16 v26, s58, v121
  v_dot2c_f32_bf16 v27, s59, v121
  v_dot2c_f32_bf16 v28, s58, v122
  v_dot2c_f32_bf16 v29, s59, v122
  v_dot2c_f32_bf16 v30, s58, v123
  v_dot2c_f32_bf16 v31, s59, v123
  v_dot2c_f32_bf16 v24, s58, v124
  v_dot2c_f32_bf16 v25, s59, v124
  v_dot2c_f32_bf16 v26, s58, v125
  v_dot2c_f32_bf16 v27, s59, v125
  v_dot2c_f32_bf16 v28, s58, v126
  v_dot2c_f32_bf16 v29, s59, v126
  v_dot2c_f32_bf16 v30, s58, v127
  v_dot2c_f32_bf16 v31, s59, v127
  v_dot2c_f32_bf16 v24, s58, v128
  v_dot2c_f32_bf16 v25, s59, v128
  v_dot2c_f32_bf16 v26, s58, v129
  v_dot2c_f32_bf16 v27, s59, v129
  v_dot2c_f32_bf16 v28, s58, v130
  v_dot2c_f32_bf16 v29, s59, v130
  v_dot2c_f32_bf16 v30, s58, v131
  v_dot2c_f32_bf16 v31, s59, v131
  v_dot2c_f32_bf16 v24, s58, v132
  v_dot2c_f32_bf16 v25, s59, v132
  v_dot2c_f32_bf16 v26, s58, v133
  v_dot2c_f32_bf16 v27, s59, v133
  v_dot2c_f32_bf16 v28, s58, v134
  v_dot2c_f32_bf16 v29, s59, v134
  v_dot2c_f32_bf16 v30, s58, v135
  v_dot2c_f32_bf16 v31, s59, v135
  v_dot2c_f32_bf16 v24, s58, v136
  v_dot2c_f32_bf16 v25, s59, v136
  v_dot2c_f32_bf16 v26, s58, v137
  v_dot2c_f32_bf16 v27, s59, v137
  v_dot2c_f32_bf16 v28, s58, v138
  v_dot2c_f32_bf16 v29, s59, v138
  v_dot2c_f32_bf16 v30, s58, v139
  v_dot2c_f32_bf16 v31, s59, v139
  v_dot2c_f32_bf16 v24, s58, v140
  v_dot2c_f32_bf16 v25, s59, v140
  v_dot2c_f32_bf16 v26, s58, v141
  v_dot2c_f32_bf16 v27, s59, v141
  v_dot2c_f32_bf16 v28, s58, v142
  v_dot2c_f32_bf16 v29, s59, v142
  v_dot2c_f32_bf16 v30, s58, v143
  v_dot2c_f32_bf16 v31, s59, v143
  v_dot2c_f32_bf16 v24, s58, v144
  v_dot2c_f32_bf16 v25, s59, v144
  v_dot2c_f32_bf16 v26, s58, v145
  v_dot2c_f32_bf16 v27, s59, v145
  v_dot2c_f32_bf16 v28, s58, v146
  v_dot2c_f32_bf16 v29, s59, v146
  v_dot2c_f32_bf16 v30, s58, v147
  v_dot2c_f32_bf16 v31, s59, v147
  v_dot2c_f32_bf16 v24, s58, v148
  v_dot2c_f32_bf16 v25, s59, v148
  v_dot2c_f32_bf16 v26, s58, v149
  v_dot2c_f32_bf16 v27, s59, v149
  v_dot2c_f32_bf16 v28, s58, v150
  v_dot2c_f32_bf16 v29, s59, v150
  v_dot2c_f32_bf16 v30, s58, v151
  v_dot2c_f32_bf16 v31, s59, v151
  s_nop 2
  v_cvt_pk_bf16_f32 v88, v24, v25
  v_cvt_pk_bf16_f32 v89, v26, v27
  v_cvt_pk_bf16_f32 v90, v28, v29
  v_cvt_pk_bf16_f32 v91, v30, v31
  ds_write_b64 v22, v[88:89]
  ds_write_b64 v23, v[90:91]
  s_waitcnt lgkmcnt(0)
k2_Anr:
  s_barrier
  ds_read_b128 v[24:27], v7 offset:0
  ds_read_b128 v[28:31], v7 offset:16
  ds_read_b128 v[32:35], v7 offset:32
  ds_read_b128 v[36:39], v7 offset:48
  ds_read_b128 v[40:43], v7 offset:64
  ds_read_b128 v[44:47], v7 offset:320
  ds_read_b128 v[48:51], v7 offset:336
  ds_read_b128 v[52:55], v7 offset:352
  ds_read_b128 v[56:59], v7 offset:368
  ds_read_b128 v[60:63], v7 offset:384
  ds_read_b128 v[64:67], v7 offset:640
  ds_read_b128 v[68:71], v7 offset:656
  ds_read_b128 v[72:75], v7 offset:672
  ds_read_b128 v[76:79], v7 offset:688
  ds_read_b128 v[80:83], v7 offset:704
  ds_read_b128 v[84:87], v7 offset:960
  ds_read_b128 v[88:91], v7 offset:976
  ds_read_b128 v[92:95], v7 offset:992
  ds_read_b128 v[96:99], v7 offset:1008
  ds_read_b128 v[100:103], v7 offset:1024
  ds_read_b128 v[104:107], v7 offset:1280
  ds_read_b128 v[108:111], v7 offset:1296
  ds_read_b128 v[112:115], v7 offset:1312
  ds_read_b128 v[116:119], v7 offset:1328
  ds_read_b128 v[120:123], v7 offset:1344
  s_waitcnt lgkmcnt(15)
  v_mfma_f32_16x16x32_bf16 v[224:227], v[24:27], v[200:203], 0
  v_mfma_f32_16x16x32_bf16 v[224:227], v[28:31], v[204:207], v[224:227]
  v_mfma_f32_16x16x32_bf16 v[224:227], v[32:35], v[208:211], v[224:227]
  v_mfma_f32_16x16x32_bf16 v[224:227], v[36:39], v[212:215], v[224:227]
  v_mfma_f32_16x16x32_bf16 v[224:227], v[40:43], v[216:219], v[224:227]
  s_waitcnt lgkmcnt(15)
  v_mfma_f32_16x16x32_bf16 v[228:231], v[44:47], v[200:203], 0
  v_mfma_f32_16x16x32_bf16 v[228:231], v[48:51], v[204:207], v[228:231]
  v_mfma_f32_16x16x32_bf16 v[228:231], v[52:55], v[208:211], v[228:231]
  v_mfma_f32_16x16x32_bf16 v[228:231], v[56:59], v[212:215], v[228:231]
  v_mfma_f32_16x16x32_bf16 v[228:231], v[60:63], v[216:219], v[228:231]
  s_waitcnt lgkmcnt(10)
  v_mfma_f32_16x16x32_bf16 v[232:235], v[64:67], v[200:203], 0
  v_mfma_f32_16x16x32_bf16 v[232:235], v[68:71], v[204:207], v[232:235]
  v_mfma_f32_16x16x32_bf16 v[232:235], v[72:75], v[208:211], v[232:235]
  v_mfma_f32_16x16x32_bf16 v[232:235], v[76:79], v[212:215], v[232:235]
  v_mfma_f32_16x16x32_bf16 v[232:235], v[80:83], v[216:219], v[232:235]
  s_waitcnt lgkmcnt(5)
  v_mfma_f32_16x16x32_bf16 v[236:239], v[84:87], v[200:203], 0
  v_mfma_f32_16x16x32_bf16 v[236:239], v[88:91], v[204:207], v[236:239]
  v_mfma_f32_16x16x32_bf16 v[236:239], v[92:95], v[208:211], v[236:239]
  v_mfma_f32_16x16x32_bf16 v[236:239], v[96:99], v[212:215], v[236:239]
  v_mfma_f32_16x16x32_bf16 v[236:239], v[100:103], v[216:219], v[236:239]
  s_waitcnt lgkmcnt(0)
  v_mfma_f32_16x16x32_bf16 v[240:243], v[104:107], v[200:203], 0
  v_mfma_f32_16x16x32_bf16 v[240:243], v[108:111], v[204:207], v[240:243]
  v_mfma_f32_16x16x32_bf16 v[240:243], v[112:115], v[208:211], v[240:243]
  v_mfma_f32_16x16x32_bf16 v[240:243], v[116:119], v[212:215], v[240:243]
  v_mfma_f32_16x16x32_bf16 v[240:243], v[120:123], v[216:219], v[240:243]
  s_nop 7
  s_nop 3
  v_add_f32 v6, 0x358637bd, v242
  v_rcp_f32 v6, v6
  s_nop 0
  v_pk_mul_f32 v[224:225], v[224:225], v[6:7] op_sel_hi:[1,0]
  v_pk_mul_f32 v[226:227], v[226:227], v[6:7] op_sel_hi:[1,0]
  v_pk_mul_f32 v[228:229], v[228:229], v[6:7] op_sel_hi:[1,0]
  v_pk_mul_f32 v[230:231], v[230:231], v[6:7] op_sel_hi:[1,0]
  v_pk_mul_f32 v[232:233], v[232:233], v[6:7] op_sel_hi:[1,0]
  v_pk_mul_f32 v[234:235], v[234:235], v[6:7] op_sel_hi:[1,0]
  v_pk_mul_f32 v[236:237], v[236:237], v[6:7] op_sel_hi:[1,0]
  v_pk_mul_f32 v[238:239], v[238:239], v[6:7] op_sel_hi:[1,0]
  v_pk_mul_f32 v[240:241], v[240:241], v[6:7] op_sel_hi:[1,0]
  v_cvt_pk_bf16_f32 v164, v224, v225
  v_cvt_pk_bf16_f32 v165, v226, v227
  v_cvt_pk_bf16_f32 v166, v228, v229
  v_cvt_pk_bf16_f32 v167, v230, v231
  v_cvt_pk_bf16_f32 v168, v232, v233
  v_cvt_pk_bf16_f32 v169, v234, v235
  v_cvt_pk_bf16_f32 v170, v236, v237
  v_cvt_pk_bf16_f32 v171, v238, v239
  v_cvt_pk_bf16_f32 v172, v240, v241
  ds_write2_b32 v9, v164, v165 offset0:0 offset1:1
  ds_write2_b32 v9, v166, v167 offset0:2 offset1:3
  ds_write2_b32 v9, v168, v169 offset0:4 offset1:5
  ds_write2_b32 v9, v170, v171 offset0:6 offset1:7
  ds_write_b32 v9, v172 offset:32
  s_waitcnt lgkmcnt(0)
  ds_read_b128 v[176:179], v8 offset:0
  ds_read_b128 v[180:183], v8 offset:64
  ds_read_b128 v[184:187], v8 offset:128
  s_waitcnt lgkmcnt(2)
  buffer_store_dwordx4 v[176:179], v14, s[24:27], s53 offen offset:0 sc1
  s_waitcnt lgkmcnt(1)
  buffer_store_dwordx4 v[180:183], v14, s[24:27], s53 offen offset:1024 sc1
  s_waitcnt lgkmcnt(0)
  buffer_store_dwordx4 v[184:187], v10, s[24:27], s53 offen offset:2048 sc1
  v_cmp_eq_u32 vcc, 0, v1
  v_mov_b32 v11, 0x80000000
  v_mov_b32 v12, 1
  s_lshl_b32 s53, s21, 7
  s_lshl_b32 s17, s20, 4
  s_add_u32 s53, s53, s17
  s_lshl_b32 s17, s22, 2
  s_add_u32 s53, s53, s17
  s_add_u32 s53, s53, 7929856
  v_cndmask_b32 v11, v11, 0, vcc
  s_waitcnt vmcnt(0)
  buffer_store_dword v12, v11, s[24:27], s53 offen sc1
  s_barrier
  s_cmp_lg_u32 s22, 0
  s_cbranch_scc1 k2_Aw2
  s_cmp_ge_u32 s40, 220
  s_cbranch_scc1 k2_P2
  s_cmp_eq_u32 s42, 9
  s_cbranch_scc1 k2_P2
  s_mul_i32 s16, s41, 96
  s_add_u32 s17, s16, 95
  s_min_u32 s17, s17, 2047
  s_lshr_b32 s16, s16, 6
  s_lshr_b32 s17, s17, 6
  s_lshl_b32 s16, s16, 7
  s_lshl_b32 s17, s17, 7
  v_and_b32 v6, 31, v1
  v_lshlrev_b32 v6, 2, v6
  v_cmp_gt_u32 vcc, 32, v1
  v_mov_b32 v7, s16
  v_mov_b32 v8, s17
  v_cndmask_b32 v7, v8, v7, vcc
  v_add_u32 v6, v6, v7
  s_mov_b32 s16, 7929856
  s_mov_b32 s56, 0
k2_poll:
  s_sleep 4
  buffer_load_dword v7, v6, s[24:27], s16 offen sc1
  s_waitcnt vmcnt(0)
  v_cmp_ne_u32 vcc, 1, v7
  s_add_u32 s56, s56, 1
  s_cmp_ge_u32 s56, 100000
  s_cbranch_scc1 k2_P2
  s_cbranch_vccnz k2_poll
  s_branch k2_P2
k2_Aw2:
  s_cmp_ge_u32 s40, 220
  s_cbranch_scc1 k2_P2
  s_add_u32 s56, s22, -1
k2_w2l:
  s_lshr_b32 s16, s56, 2
  s_add_u32 s16, s16, s44
  s_sub_u32 s17, s16, 9
  s_cmp_ge_u32 s16, 9
  s_cselect_b32 s16, s17, s16
  s_lshl_b32 s16, s16, 2
  s_and_b32 s17, s56, 3
  s_add_u32 s16, s16, s17
  s_mul_i32 s16, s16, 18432
  s_add_u32 s16, s16, s45
  s_lshl_b32 s17, s56, 11
  s_add_u32 m0, s17, 73728
  s_add_u32 s56, s56, 3
  buffer_load_dwordx4 v16, s[36:39], s16 offen lds
  s_add_u32 m0, s17, 74752
  s_add_u32 s16, s16, 9216
  buffer_load_dwordx4 v17, s[36:39], s16 offen lds
  s_cmp_lt_u32 s56, 36
  s_cbranch_scc1 k2_w2l
  s_branch k2_P2
k2_X:
  s_add_u32 s17, s54, s55
  buffer_load_dwordx4 v[24:27], v18, s[24:27], s17 offen
  s_add_u32 s55, s55, 43776
  s_cmp_eq_u32 s55, 700416
  s_cselect_b32 s55, 0, s55
  s_add_u32 s17, s54, s55
  buffer_load_dwordx4 v[28:31], v18, s[24:27], s17 offen
  s_add_u32 s55, s55, 43776
  s_cmp_eq_u32 s55, 700416
  s_cselect_b32 s55, 0, s55
  s_add_u32 s17, s54, s55
  buffer_load_dwordx4 v[32:35], v18, s[24:27], s17 offen
  s_add_u32 s55, s55, 43776
  s_cmp_eq_u32 s55, 700416
  s_cselect_b32 s55, 0, s55
  s_add_u32 s17, s54, s55
  buffer_load_dwordx4 v[36:39], v18, s[24:27], s17 offen
  s_add_u32 s55, s55, 43776
  s_cmp_eq_u32 s55, 700416
  s_cselect_b32 s55, 0, s55
  s_add_u32 s17, s54, s55
  buffer_load_dwordx4 v[40:43], v18, s[24:27], s17 offen
  s_add_u32 s55, s55, 43776
  s_cmp_eq_u32 s55, 700416
  s_cselect_b32 s55, 0, s55
  s_add_u32 s17, s54, s55
  buffer_load_dwordx4 v[44:47], v18, s[24:27], s17 offen
  s_add_u32 s55, s55, 43776
  s_cmp_eq_u32 s55, 700416
  s_cselect_b32 s55, 0, s55
  s_add_u32 s17, s54, s55
  buffer_load_dwordx4 v[48:51], v18, s[24:27], s17 offen
  s_add_u32 s55, s55, 43776
  s_cmp_eq_u32 s55, 700416
  s_cselect_b32 s55, 0, s55
  s_add_u32 s17, s54, s55
  buffer_load_dwordx4 v[52:55], v18, s[24:27], s17 offen
  s_add_u32 s55, s55, 43776
  s_cmp_eq_u32 s55, 700416
  s_cselect_b32 s55, 0, s55
  s_add_u32 s17, s54, s55
  buffer_load_dwordx4 v[56:59], v18, s[24:27], s17 offen
  s_add_u32 s55, s55, 43776
  s_cmp_eq_u32 s55, 700416
  s_cselect_b32 s55, 0, s55
  s_add_u32 s17, s54, s55
  buffer_load_dwordx4 v[60:63], v18, s[24:27], s17 offen
  s_add_u32 s55, s55, 43776
  s_cmp_eq_u32 s55, 700416
  s_cselect_b32 s55, 0, s55
  s_add_u32 s17, s54, s55
  buffer_load_dwordx4 v[64:67], v18, s[24:27], s17 offen
  s_add_u32 s55, s55, 43776
  s_cmp_eq_u32 s55, 700416
  s_cselect_b32 s55, 0, s55
  s_add_u32 s17, s54, s55
  buffer_load_dwordx4 v[68:71], v18, s[24:27], s17 offen
  s_add_u32 s55, s55, 43776
  s_cmp_eq_u32 s55, 700416
  s_cselect_b32 s55, 0, s55
  s_add_u32 s17, s54, s55
  buffer_load_dwordx4 v[72:75], v18, s[24:27], s17 offen
  s_add_u32 s55, s55, 43776
  s_cmp_eq_u32 s55, 700416
  s_cselect_b32 s55, 0, s55
  s_add_u32 s17, s54, s55
  buffer_load_dwordx4 v[76:79], v18, s[24:27], s17 offen
  s_add_u32 s55, s55, 43776
  s_cmp_eq_u32 s55, 700416
  s_cselect_b32 s55, 0, s55
  s_add_u32 s17, s54, s55
  buffer_load_dwordx4 v[80:83], v18, s[24:27], s17 offen
  s_add_u32 s55, s55, 43776
  s_cmp_eq_u32 s55, 700416
  s_cselect_b32 s55, 0, s55
  s_add_u32 s17, s54, s55
  buffer_load_dwordx4 v[84:87], v18, s[24:27], s17 offen
  s_add_u32 s55, s55, 43776
  s_cmp_eq_u32 s55, 700416
  s_cselect_b32 s55, 0, s55
  v_and_b32 v6, 255, v0
  v_mov_b32 v172, 0
  v_mov_b32 v173, 0
  v_mov_b32 v174, 0
  v_mov_b32 v175, 0
  v_min_u32 v7, 79, v6
  v_mul_u32_u24 v7, 80, v7
  v_add_u32 v7, 129096, v7
  ds_write_b64 v7, v[172:173]
  v_min_u32 v7, 95, v6
  v_lshlrev_b32 v7, 4, v7
  v_add_u32 v7, 135424, v7
  ds_write_b128 v7, v[172:175]
  v_and_b32 v6, 255, v0
  v_lshlrev_b32 v6, 1, v6
  v_mul_u32_u24 v7, 6133, v6
  v_lshrrev_b32 v7, 20, v7
  v_mul_u32_u24 v8, 171, v7
  v_sub_u32 v8, v6, v8
  v_mul_u32_u24 v9, 7282, v8
  v_lshrrev_b32 v9, 16, v9
  v_mul_u32_u24 v10, 9, v9
  v_sub_u32 v10, v8, v10
  v_mul_u32_u24 v7, 20, v7
  v_add_u32 v7, v7, v9
  v_mul_u32_u24 v7, 80, v7
  v_lshl_add_u32 v20, v10, 3, v7
  v_add_u32 v20, 129024, v20
  v_and_b32 v6, 255, v0
  v_lshlrev_b32 v6, 1, v6
  v_add_u32 v6, 1, v6
  v_mul_u32_u24 v7, 6133, v6
  v_lshrrev_b32 v7, 20, v7
  v_mul_u32_u24 v8, 171, v7
  v_sub_u32 v8, v6, v8
  v_mul_u32_u24 v9, 7282, v8
  v_lshrrev_b32 v9, 16, v9
  v_mul_u32_u24 v10, 9, v9
  v_sub_u32 v10, v8, v10
  v_mul_u32_u24 v7, 20, v7
  v_add_u32 v7, v7, v9
  v_mul_u32_u24 v7, 80, v7
  v_lshl_add_u32 v21, v10, 3, v7
  v_add_u32 v21, 129024, v21
  s_mul_i32 s62, s49, 18432
  s_add_u32 s62, s62, 4718592
  s_lshl_b32 s63, s50, 11
  s_mov_b32 s56, s48
  s_lshr_b32 s16, s56, 2
  s_add_u32 s16, s16, s50
  s_sub_u32 s17, s16, 9
  s_cmp_ge_u32 s16, 9
  s_cselect_b32 s16, s17, s16
  s_lshl_b32 s16, s16, 2
  s_and_b32 s17, s56, 3
  s_add_u32 s16, s16, s17
  s_mul_i32 s16, s16, 18432
  s_add_u32 s16, s16, s51
  s_lshl_b32 s17, s56, 11
  s_mov_b32 m0, s17
  s_add_u32 s56, s56, 4
  buffer_load_dwordx4 v16, s[28:31], s16 offen lds
  s_add_u32 m0, s17, 1024
  s_add_u32 s16, s16, 9216
  buffer_load_dwordx4 v17, s[28:31], s16 offen lds
  s_lshr_b32 s16, s56, 2
  s_add_u32 s16, s16, s50
  s_sub_u32 s17, s16, 9
  s_cmp_ge_u32 s16, 9
  s_cselect_b32 s16, s17, s16
  s_lshl_b32 s16, s16, 2
  s_and_b32 s17, s56, 3
  s_add_u32 s16, s16, s17
  s_mul_i32 s16, s16, 18432
  s_add_u32 s16, s16, s51
  s_lshl_b32 s17, s56, 11
  s_mov_b32 m0, s17
  s_add_u32 s56, s56, 4
  buffer_load_dwordx4 v16, s[28:31], s16 offen lds
  s_add_u32 m0, s17, 1024
  s_add_u32 s16, s16, 9216
  buffer_load_dwordx4 v17, s[28:31], s16 offen lds
  s_lshr_b32 s16, s56, 2
  s_add_u32 s16, s16, s50
  s_sub_u32 s17, s16, 9
  s_cmp_ge_u32 s16, 9
  s_cselect_b32 s16, s17, s16
  s_lshl_b32 s16, s16, 2
  s_and_b32 s17, s56, 3
  s_add_u32 s16, s16, s17
  s_mul_i32 s16, s16, 18432
  s_add_u32 s16, s16, s51
  s_lshl_b32 s17, s56, 11
  s_mov_b32 m0, s17
  s_add_u32 s56, s56, 4
  buffer_load_dwordx4 v16, s[28:31], s16 offen lds
  s_add_u32 m0, s17, 1024
  s_add_u32 s16, s16, 9216
  buffer_load_dwordx4 v17, s[28:31], s16 offen lds
  s_lshr_b32 s16, s56, 2
  s_add_u32 s16, s16, s50
  s_sub_u32 s17, s16, 9
  s_cmp_ge_u32 s16, 9
  s_cselect_b32 s16, s17, s16
  s_lshl_b32 s16, s16, 2
  s_and_b32 s17, s56, 3
  s_add_u32 s16, s16, s17
  s_mul_i32 s16, s16, 18432
  s_add_u32 s16, s16, s51
  s_lshl_b32 s17, s56, 11
  s_mov_b32 m0, s17
  s_add_u32 s56, s56, 4
  buffer_load_dwordx4 v16, s[28:31], s16 offen lds
  s_add_u32 m0, s17, 1024
  s_add_u32 s16, s16, 9216
  buffer_load_dwordx4 v17, s[28:31], s16 offen lds
  s_lshr_b32 s16, s56, 2
  s_add_u32 s16, s16, s50
  s_sub_u32 s17, s16, 9
  s_cmp_ge_u32 s16, 9
  s_cselect_b32 s16, s17, s16
  s_lshl_b32 s16, s16, 2
  s_and_b32 s17, s56, 3
  s_add_u32 s16, s16, s17
  s_mul_i32 s16, s16, 18432
  s_add_u32 s16, s16, s51
  s_lshl_b32 s17, s56, 11
  s_mov_b32 m0, s17
  s_add_u32 s56, s56, 4
  buffer_load_dwordx4 v16, s[28:31], s16 offen lds
  s_add_u32 m0, s17, 1024
  s_add_u32 s16, s16, 9216
  buffer_load_dwordx4 v17, s[28:31], s16 offen lds
  s_lshr_b32 s16, s56, 2
  s_add_u32 s16, s16, s50
  s_sub_u32 s17, s16, 9
  s_cmp_ge_u32 s16, 9
  s_cselect_b32 s16, s17, s16
  s_lshl_b32 s16, s16, 2
  s_and_b32 s17, s56, 3
  s_add_u32 s16, s16, s17
  s_mul_i32 s16, s16, 18432
  s_add_u32 s16, s16, s51
  s_lshl_b32 s17, s56, 11
  s_mov_b32 m0, s17
  s_add_u32 s56, s56, 4
  buffer_load_dwordx4 v16, s[28:31], s16 offen lds
  s_add_u32 m0, s17, 1024
  s_add_u32 s16, s16, 9216
  buffer_load_dwordx4 v17, s[28:31], s16 offen lds
  s_lshr_b32 s16, s56, 2
  s_add_u32 s16, s16, s50
  s_sub_u32 s17, s16, 9
  s_cmp_ge_u32 s16, 9
  s_cselect_b32 s16, s17, s16
  s_lshl_b32 s16, s16, 2
  s_and_b32 s17, s56, 3
  s_add_u32 s16, s16, s17
  s_mul_i32 s16, s16, 18432
  s_add_u32 s16, s16, s51
  s_lshl_b32 s17, s56, 11
  s_mov_b32 m0, s17
  s_add_u32 s56, s56, 4
  buffer_load_dwordx4 v16, s[28:31], s16 offen lds
  s_add_u32 m0, s17, 1024
  s_add_u32 s16, s16, 9216
  buffer_load_dwordx4 v17, s[28:31], s16 offen lds
  s_lshr_b32 s16, s56, 2
  s_add_u32 s16, s16, s50
  s_sub_u32 s17, s16, 9
  s_cmp_ge_u32 s16, 9
  s_cselect_b32 s16, s17, s16
  s_lshl_b32 s16, s16, 2
  s_and_b32 s17, s56, 3
  s_add_u32 s16, s16, s17
  s_mul_i32 s16, s16, 18432
  s_add_u32 s16, s16, s51
  s_lshl_b32 s17, s56, 11
  s_mov_b32 m0, s17
  s_add_u32 s56, s56, 4
  buffer_load_dwordx4 v16, s[28:31], s16 offen lds
  s_add_u32 m0, s17, 1024
  s_add_u32 s16, s16, 9216
  buffer_load_dwordx4 v17, s[28:31], s16 offen lds
  s_lshr_b32 s16, s56, 2
  s_add_u32 s16, s16, s50
  s_sub_u32 s17, s16, 9
  s_cmp_ge_u32 s16, 9
  s_cselect_b32 s16, s17, s16
  s_lshl_b32 s16, s16, 2
  s_and_b32 s17, s56, 3
  s_add_u32 s16, s16, s17
  s_mul_i32 s16, s16, 18432
  s_add_u32 s16, s16, s51
  s_lshl_b32 s17, s56, 11
  s_mov_b32 m0, s17
  s_add_u32 s56, s56, 4
  buffer_load_dwordx4 v16, s[28:31], s16 offen lds
  s_add_u32 m0, s17, 1024
  s_add_u32 s16, s16, 9216
  buffer_load_dwordx4 v17, s[28:31], s16 offen lds
  s_waitcnt vmcnt(18)
  v_mov_b32 v88, 0
  v_mov_b32 v89, 0
  v_mov_b32 v90, 0
  v_mov_b32 v91, 0
  v_mov_b32 v92, 0
  v_mov_b32 v93, 0
  v_mov_b32 v94, 0
  v_mov_b32 v95, 0
  v_dot2c_f32_bf16 v88, s58, v24
  v_dot2c_f32_bf16 v89, s59, v24
  v_dot2c_f32_bf16 v90, s58, v25
  v_dot2c_f32_bf16 v91, s59, v25
  v_dot2c_f32_bf16 v92, s58, v26
  v_dot2c_f32_bf16 v93, s59, v26
  v_dot2c_f32_bf16 v94, s58, v27
  v_dot2c_f32_bf16 v95, s59, v27
  v_dot2c_f32_bf16 v88, s58, v28
  v_dot2c_f32_bf16 v89, s59, v28
  v_dot2c_f32_bf16 v90, s58, v29
  v_dot2c_f32_bf16 v91, s59, v29
  v_dot2c_f32_bf16 v92, s58, v30
  v_dot2c_f32_bf16 v93, s59, v30
  v_dot2c_f32_bf16 v94, s58, v31
  v_dot2c_f32_bf16 v95, s59, v31
  v_dot2c_f32_bf16 v88, s58, v32
  v_dot2c_f32_bf16 v89, s59, v32
  v_dot2c_f32_bf16 v90, s58, v33
  v_dot2c_f32_bf16 v91, s59, v33
  v_dot2c_f32_bf16 v92, s58, v34
  v_dot2c_f32_bf16 v93, s59, v34
  v_dot2c_f32_bf16 v94, s58, v35
  v_dot2c_f32_bf16 v95, s59, v35
  v_dot2c_f32_bf16 v88, s58, v36
  v_dot2c_f32_bf16 v89, s59, v36
  v_dot2c_f32_bf16 v90, s58, v37
  v_dot2c_f32_bf16 v91, s59, v37
  v_dot2c_f32_bf16 v92, s58, v38
  v_dot2c_f32_bf16 v93, s59, v38
  v_dot2c_f32_bf16 v94, s58, v39
  v_dot2c_f32_bf16 v95, s59, v39
  v_dot2c_f32_bf16 v88, s58, v40
  v_dot2c_f32_bf16 v89, s59, v40
  v_dot2c_f32_bf16 v90, s58, v41
  v_dot2c_f32_bf16 v91, s59, v41
  v_dot2c_f32_bf16 v92, s58, v42
  v_dot2c_f32_bf16 v93, s59, v42
  v_dot2c_f32_bf16 v94, s58, v43
  v_dot2c_f32_bf16 v95, s59, v43
  v_dot2c_f32_bf16 v88, s58, v44
  v_dot2c_f32_bf16 v89, s59, v44
  v_dot2c_f32_bf16 v90, s58, v45
  v_dot2c_f32_bf16 v91, s59, v45
  v_dot2c_f32_bf16 v92, s58, v46
  v_dot2c_f32_bf16 v93, s59, v46
  v_dot2c_f32_bf16 v94, s58, v47
  v_dot2c_f32_bf16 v95, s59, v47
  v_dot2c_f32_bf16 v88, s58, v48
  v_dot2c_f32_bf16 v89, s59, v48
  v_dot2c_f32_bf16 v90, s58, v49
  v_dot2c_f32_bf16 v91, s59, v49
  v_dot2c_f32_bf16 v92, s58, v50
  v_dot2c_f32_bf16 v93, s59, v50
  v_dot2c_f32_bf16 v94, s58, v51
  v_dot2c_f32_bf16 v95, s59, v51
  v_dot2c_f32_bf16 v88, s58, v52
  v_dot2c_f32_bf16 v89, s59, v52
  v_dot2c_f32_bf16 v90, s58, v53
  v_dot2c_f32_bf16 v91, s59, v53
  v_dot2c_f32_bf16 v92, s58, v54
  v_dot2c_f32_bf16 v93, s59, v54
  v_dot2c_f32_bf16 v94, s58, v55
  v_dot2c_f32_bf16 v95, s59, v55
  v_dot2c_f32_bf16 v88, s58, v56
  v_dot2c_f32_bf16 v89, s59, v56
  v_dot2c_f32_bf16 v90, s58, v57
  v_dot2c_f32_bf16 v91, s59, v57
  v_dot2c_f32_bf16 v92, s58, v58
  v_dot2c_f32_bf16 v93, s59, v58
  v_dot2c_f32_bf16 v94, s58, v59
  v_dot2c_f32_bf16 v95, s59, v59
  v_dot2c_f32_bf16 v88, s58, v60
  v_dot2c_f32_bf16 v89, s59, v60
  v_dot2c_f32_bf16 v90, s58, v61
  v_dot2c_f32_bf16 v91, s59, v61
  v_dot2c_f32_bf16 v92, s58, v62
  v_dot2c_f32_bf16 v93, s59, v62
  v_dot2c_f32_bf16 v94, s58, v63
  v_dot2c_f32_bf16 v95, s59, v63
  v_dot2c_f32_bf16 v88, s58, v64
  v_dot2c_f32_bf16 v89, s59, v64
  v_dot2c_f32_bf16 v90, s58, v65
  v_dot2c_f32_bf16 v91, s59, v65
  v_dot2c_f32_bf16 v92, s58, v66
  v_dot2c_f32_bf16 v93, s59, v66
  v_dot2c_f32_bf16 v94, s58, v67
  v_dot2c_f32_bf16 v95, s59, v67
  v_dot2c_f32_bf16 v88, s58, v68
  v_dot2c_f32_bf16 v89, s59, v68
  v_dot2c_f32_bf16 v90, s58, v69
  v_dot2c_f32_bf16 v91, s59, v69
  v_dot2c_f32_bf16 v92, s58, v70
  v_dot2c_f32_bf16 v93, s59, v70
  v_dot2c_f32_bf16 v94, s58, v71
  v_dot2c_f32_bf16 v95, s59, v71
  v_dot2c_f32_bf16 v88, s58, v72
  v_dot2c_f32_bf16 v89, s59, v72
  v_dot2c_f32_bf16 v90, s58, v73
  v_dot2c_f32_bf16 v91, s59, v73
  v_dot2c_f32_bf16 v92, s58, v74
  v_dot2c_f32_bf16 v93, s59, v74
  v_dot2c_f32_bf16 v94, s58, v75
  v_dot2c_f32_bf16 v95, s59, v75
  v_dot2c_f32_bf16 v88, s58, v76
  v_dot2c_f32_bf16 v89, s59, v76
  v_dot2c_f32_bf16 v90, s58, v77
  v_dot2c_f32_bf16 v91, s59, v77
  v_dot2c_f32_bf16 v92, s58, v78
  v_dot2c_f32_bf16 v93, s59, v78
  v_dot2c_f32_bf16 v94, s58, v79
  v_dot2c_f32_bf16 v95, s59, v79
  v_dot2c_f32_bf16 v88, s58, v80
  v_dot2c_f32_bf16 v89, s59, v80
  v_dot2c_f32_bf16 v90, s58, v81
  v_dot2c_f32_bf16 v91, s59, v81
  v_dot2c_f32_bf16 v92, s58, v82
  v_dot2c_f32_bf16 v93, s59, v82
  v_dot2c_f32_bf16 v94, s58, v83
  v_dot2c_f32_bf16 v95, s59, v83
  v_dot2c_f32_bf16 v88, s58, v84
  v_dot2c_f32_bf16 v89, s59, v84
  v_dot2c_f32_bf16 v90, s58, v85
  v_dot2c_f32_bf16 v91, s59, v85
  v_dot2c_f32_bf16 v92, s58, v86
  v_dot2c_f32_bf16 v93, s59, v86
  v_dot2c_f32_bf16 v94, s58, v87
  v_dot2c_f32_bf16 v95, s59, v87
  s_nop 2
  v_cvt_pk_bf16_f32 v24, v88, v89
  v_cvt_pk_bf16_f32 v25, v90, v91
  v_cvt_pk_bf16_f32 v26, v92, v93
  v_cvt_pk_bf16_f32 v27, v94, v95
  ds_write_b64 v20, v[24:25]
  ds_write_b64 v21, v[26:27]
  s_waitcnt lgkmcnt(0)
  s_barrier
  s_add_u32 s64, s62, s63
  buffer_load_dwordx4 v[152:155], v14, s[24:27], s64 offen offset:0
  buffer_load_dwordx4 v[156:159], v14, s[24:27], s64 offen offset:1024
  s_add_u32 s63, s63, 2048
  s_cmp_eq_u32 s63, 18432
  s_cselect_b32 s63, 0, s63
  s_add_u32 s64, s62, s63
  buffer_load_dwordx4 v[160:163], v14, s[24:27], s64 offen offset:0
  buffer_load_dwordx4 v[164:167], v14, s[24:27], s64 offen offset:1024
  s_add_u32 s63, s63, 2048
  s_cmp_eq_u32 s63, 18432
  s_cselect_b32 s63, 0, s63
  s_add_u32 s64, s62, s63
  buffer_load_dwordx4 v[168:171], v14, s[24:27], s64 offen offset:0
  buffer_load_dwordx4 v[172:175], v14, s[24:27], s64 offen offset:1024
  s_add_u32 s63, s63, 2048
  s_cmp_eq_u32 s63, 18432
  s_cselect_b32 s63, 0, s63
  s_add_u32 s64, s62, s63
  buffer_load_dwordx4 v[176:179], v14, s[24:27], s64 offen offset:0
  buffer_load_dwordx4 v[180:183], v14, s[24:27], s64 offen offset:1024
  s_add_u32 s63, s63, 2048
  s_cmp_eq_u32 s63, 18432
  s_cselect_b32 s63, 0, s63
  s_add_u32 s64, s62, s63
  buffer_load_dwordx4 v[184:187], v14, s[24:27], s64 offen offset:0
  buffer_load_dwordx4 v[188:191], v14, s[24:27], s64 offen offset:1024
  s_add_u32 s63, s63, 2048
  s_cmp_eq_u32 s63, 18432
  s_cselect_b32 s63, 0, s63
  s_add_u32 s64, s62, s63
  buffer_load_dwordx4 v[192:195], v14, s[24:27], s64 offen offset:0
  buffer_load_dwordx4 v[196:199], v14, s[24:27], s64 offen offset:1024
  s_add_u32 s63, s63, 2048
  s_cmp_eq_u32 s63, 18432
  s_cselect_b32 s63, 0, s63
  s_add_u32 s64, s62, s63
  buffer_load_dwordx4 v[200:203], v14, s[24:27], s64 offen offset:0
  buffer_load_dwordx4 v[204:207], v14, s[24:27], s64 offen offset:1024
  s_add_u32 s63, s63, 2048
  s_cmp_eq_u32 s63, 18432
  s_cselect_b32 s63, 0, s63
  s_add_u32 s64, s62, s63
  buffer_load_dwordx4 v[208:211], v14, s[24:27], s64 offen offset:0
  buffer_load_dwordx4 v[212:215], v14, s[24:27], s64 offen offset:1024
  s_add_u32 s63, s63, 2048
  s_cmp_eq_u32 s63, 18432
  s_cselect_b32 s63, 0, s63
  s_add_u32 s64, s62, s63
  buffer_load_dwordx4 v[216:219], v14, s[24:27], s64 offen offset:0
  buffer_load_dwordx4 v[220:223], v14, s[24:27], s64 offen offset:1024
  s_add_u32 s63, s63, 2048
  s_cmp_eq_u32 s63, 18432
  s_cselect_b32 s63, 0, s63
  s_mov_b32 s56, s48
  v_lshl_add_u32 v6, v3, 3, v4
  v_lshlrev_b32 v6, 7, v6
  v_lshl_add_u32 v6, v5, 3, v6
  v_lshrrev_b32 v7, 1, v4
  v_and_b32 v8, 1, v3
  v_lshl_add_u32 v7, v8, 1, v7
  v_lshl_add_u32 v240, v7, 5, v6
  v_xor_b32 v241, 32, v240
  v_xor_b32 v242, 64, v240
  v_xor_b32 v243, 96, v240
  s_waitcnt vmcnt(18)
  s_barrier
  ds_read_b64_tr_b16 v[24:25], v240 offset:0
  ds_read_b64_tr_b16 v[26:27], v240 offset:512
  ds_read_b64_tr_b16 v[28:29], v241 offset:0
  ds_read_b64_tr_b16 v[30:31], v241 offset:512
  ds_read_b64_tr_b16 v[32:33], v242 offset:0
  ds_read_b64_tr_b16 v[34:35], v242 offset:512
  ds_read_b64_tr_b16 v[36:37], v243 offset:0
  ds_read_b64_tr_b16 v[38:39], v243 offset:512
  ds_read_b64_tr_b16 v[40:41], v240 offset:4096
  ds_read_b64_tr_b16 v[42:43], v240 offset:4608
  ds_read_b64_tr_b16 v[44:45], v241 offset:4096
  ds_read_b64_tr_b16 v[46:47], v241 offset:4608
  ds_read_b64_tr_b16 v[48:49], v242 offset:4096
  ds_read_b64_tr_b16 v[50:51], v242 offset:4608
  ds_read_b64_tr_b16 v[52:53], v243 offset:4096
  ds_read_b64_tr_b16 v[54:55], v243 offset:4608
  s_waitcnt vmcnt(17) lgkmcnt(8)
  v_mfma_f32_16x16x32_bf16 v[224:227], v[24:27], v[152:155], 0
  ds_read_b64_tr_b16 v[56:57], v240 offset:8192
  ds_read_b64_tr_b16 v[58:59], v240 offset:8704
  v_mfma_f32_16x16x32_bf16 v[228:231], v[28:31], v[152:155], 0
  ds_read_b64_tr_b16 v[60:61], v241 offset:8192
  ds_read_b64_tr_b16 v[62:63], v241 offset:8704
  v_mfma_f32_16x16x32_bf16 v[232:235], v[32:35], v[152:155], 0
  ds_read_b64_tr_b16 v[64:65], v242 offset:8192
  ds_read_b64_tr_b16 v[66:67], v242 offset:8704
  v_mfma_f32_16x16x32_bf16 v[236:239], v[36:39], v[152:155], 0
  ds_read_b64_tr_b16 v[68:69], v243 offset:8192
  ds_read_b64_tr_b16 v[70:71], v243 offset:8704
  s_waitcnt vmcnt(16) lgkmcnt(8)
  v_mfma_f32_16x16x32_bf16 v[224:227], v[40:43], v[156:159], v[224:227]
  ds_read_b64_tr_b16 v[24:25], v240 offset:12288
  ds_read_b64_tr_b16 v[26:27], v240 offset:12800
  v_mfma_f32_16x16x32_bf16 v[228:231], v[44:47], v[156:159], v[228:231]
  ds_read_b64_tr_b16 v[28:29], v241 offset:12288
  ds_read_b64_tr_b16 v[30:31], v241 offset:12800
  v_mfma_f32_16x16x32_bf16 v[232:235], v[48:51], v[156:159], v[232:235]
  ds_read_b64_tr_b16 v[32:33], v242 offset:12288
  ds_read_b64_tr_b16 v[34:35], v242 offset:12800
  v_mfma_f32_16x16x32_bf16 v[236:239], v[52:55], v[156:159], v[236:239]
  ds_read_b64_tr_b16 v[36:37], v243 offset:12288
  ds_read_b64_tr_b16 v[38:39], v243 offset:12800
  s_waitcnt vmcnt(15) lgkmcnt(8)
  v_mfma_f32_16x16x32_bf16 v[224:227], v[56:59], v[160:163], v[224:227]
  ds_read_b64_tr_b16 v[40:41], v240 offset:16384
  ds_read_b64_tr_b16 v[42:43], v240 offset:16896
  v_mfma_f32_16x16x32_bf16 v[228:231], v[60:63], v[160:163], v[228:231]
  ds_read_b64_tr_b16 v[44:45], v241 offset:16384
  ds_read_b64_tr_b16 v[46:47], v241 offset:16896
  v_mfma_f32_16x16x32_bf16 v[232:235], v[64:67], v[160:163], v[232:235]
  ds_read_b64_tr_b16 v[48:49], v242 offset:16384
  ds_read_b64_tr_b16 v[50:51], v242 offset:16896
  v_mfma_f32_16x16x32_bf16 v[236:239], v[68:71], v[160:163], v[236:239]
  ds_read_b64_tr_b16 v[52:53], v243 offset:16384
  ds_read_b64_tr_b16 v[54:55], v243 offset:16896
  s_waitcnt vmcnt(14) lgkmcnt(8)
  v_mfma_f32_16x16x32_bf16 v[224:227], v[24:27], v[164:167], v[224:227]
  ds_read_b64_tr_b16 v[56:57], v240 offset:20480
  ds_read_b64_tr_b16 v[58:59], v240 offset:20992
  v_mfma_f32_16x16x32_bf16 v[228:231], v[28:31], v[164:167], v[228:231]
  ds_read_b64_tr_b16 v[60:61], v241 offset:20480
  ds_read_b64_tr_b16 v[62:63], v241 offset:20992
  v_mfma_f32_16x16x32_bf16 v[232:235], v[32:35], v[164:167], v[232:235]
  ds_read_b64_tr_b16 v[64:65], v242 offset:20480
  ds_read_b64_tr_b16 v[66:67], v242 offset:20992
  v_mfma_f32_16x16x32_bf16 v[236:239], v[36:39], v[164:167], v[236:239]
  ds_read_b64_tr_b16 v[68:69], v243 offset:20480
  ds_read_b64_tr_b16 v[70:71], v243 offset:20992
  s_waitcnt vmcnt(13) lgkmcnt(8)
  v_mfma_f32_16x16x32_bf16 v[224:227], v[40:43], v[168:171], v[224:227]
  ds_read_b64_tr_b16 v[24:25], v240 offset:24576
  ds_read_b64_tr_b16 v[26:27], v240 offset:25088
  v_mfma_f32_16x16x32_bf16 v[228:231], v[44:47], v[168:171], v[228:231]
  ds_read_b64_tr_b16 v[28:29], v241 offset:24576
  ds_read_b64_tr_b16 v[30:31], v241 offset:25088
  v_mfma_f32_16x16x32_bf16 v[232:235], v[48:51], v[168:171], v[232:235]
  ds_read_b64_tr_b16 v[32:33], v242 offset:24576
  ds_read_b64_tr_b16 v[34:35], v242 offset:25088
  v_mfma_f32_16x16x32_bf16 v[236:239], v[52:55], v[168:171], v[236:239]
  ds_read_b64_tr_b16 v[36:37], v243 offset:24576
  ds_read_b64_tr_b16 v[38:39], v243 offset:25088
  s_waitcnt vmcnt(12) lgkmcnt(8)
  v_mfma_f32_16x16x32_bf16 v[224:227], v[56:59], v[172:175], v[224:227]
  ds_read_b64_tr_b16 v[40:41], v240 offset:28672
  ds_read_b64_tr_b16 v[42:43], v240 offset:29184
  v_mfma_f32_16x16x32_bf16 v[228:231], v[60:63], v[172:175], v[228:231]
  ds_read_b64_tr_b16 v[44:45], v241 offset:28672
  ds_read_b64_tr_b16 v[46:47], v241 offset:29184
  v_mfma_f32_16x16x32_bf16 v[232:235], v[64:67], v[172:175], v[232:235]
  ds_read_b64_tr_b16 v[48:49], v242 offset:28672
  ds_read_b64_tr_b16 v[50:51], v242 offset:29184
  v_mfma_f32_16x16x32_bf16 v[236:239], v[68:71], v[172:175], v[236:239]
  ds_read_b64_tr_b16 v[52:53], v243 offset:28672
  ds_read_b64_tr_b16 v[54:55], v243 offset:29184
  s_waitcnt vmcnt(11) lgkmcnt(8)
  v_mfma_f32_16x16x32_bf16 v[224:227], v[24:27], v[176:179], v[224:227]
  ds_read_b64_tr_b16 v[56:57], v240 offset:32768
  ds_read_b64_tr_b16 v[58:59], v240 offset:33280
  v_mfma_f32_16x16x32_bf16 v[228:231], v[28:31], v[176:179], v[228:231]
  ds_read_b64_tr_b16 v[60:61], v241 offset:32768
  ds_read_b64_tr_b16 v[62:63], v241 offset:33280
  v_mfma_f32_16x16x32_bf16 v[232:235], v[32:35], v[176:179], v[232:235]
  ds_read_b64_tr_b16 v[64:65], v242 offset:32768
  ds_read_b64_tr_b16 v[66:67], v242 offset:33280
  v_mfma_f32_16x16x32_bf16 v[236:239], v[36:39], v[176:179], v[236:239]
  ds_read_b64_tr_b16 v[68:69], v243 offset:32768
  ds_read_b64_tr_b16 v[70:71], v243 offset:33280
  s_waitcnt vmcnt(10) lgkmcnt(8)
  v_mfma_f32_16x16x32_bf16 v[224:227], v[40:43], v[180:183], v[224:227]
  ds_read_b64_tr_b16 v[24:25], v240 offset:36864
  ds_read_b64_tr_b16 v[26:27], v240 offset:37376
  v_mfma_f32_16x16x32_bf16 v[228:231], v[44:47], v[180:183], v[228:231]
  ds_read_b64_tr_b16 v[28:29], v241 offset:36864
  ds_read_b64_tr_b16 v[30:31], v241 offset:37376
  v_mfma_f32_16x16x32_bf16 v[232:235], v[48:51], v[180:183], v[232:235]
  ds_read_b64_tr_b16 v[32:33], v242 offset:36864
  ds_read_b64_tr_b16 v[34:35], v242 offset:37376
  v_mfma_f32_16x16x32_bf16 v[236:239], v[52:55], v[180:183], v[236:239]
  ds_read_b64_tr_b16 v[36:37], v243 offset:36864
  ds_read_b64_tr_b16 v[38:39], v243 offset:37376
  s_waitcnt vmcnt(9) lgkmcnt(8)
  v_mfma_f32_16x16x32_bf16 v[224:227], v[56:59], v[184:187], v[224:227]
  ds_read_b64_tr_b16 v[40:41], v240 offset:40960
  ds_read_b64_tr_b16 v[42:43], v240 offset:41472
  v_mfma_f32_16x16x32_bf16 v[228:231], v[60:63], v[184:187], v[228:231]
  ds_read_b64_tr_b16 v[44:45], v241 offset:40960
  ds_read_b64_tr_b16 v[46:47], v241 offset:41472
  v_mfma_f32_16x16x32_bf16 v[232:235], v[64:67], v[184:187], v[232:235]
  ds_read_b64_tr_b16 v[48:49], v242 offset:40960
  ds_read_b64_tr_b16 v[50:51], v242 offset:41472
  v_mfma_f32_16x16x32_bf16 v[236:239], v[68:71], v[184:187], v[236:239]
  ds_read_b64_tr_b16 v[52:53], v243 offset:40960
  ds_read_b64_tr_b16 v[54:55], v243 offset:41472
  s_waitcnt vmcnt(8) lgkmcnt(8)
  v_mfma_f32_16x16x32_bf16 v[224:227], v[24:27], v[188:191], v[224:227]
  ds_read_b64_tr_b16 v[56:57], v240 offset:45056
  ds_read_b64_tr_b16 v[58:59], v240 offset:45568
  v_mfma_f32_16x16x32_bf16 v[228:231], v[28:31], v[188:191], v[228:231]
  ds_read_b64_tr_b16 v[60:61], v241 offset:45056
  ds_read_b64_tr_b16 v[62:63], v241 offset:45568
  v_mfma_f32_16x16x32_bf16 v[232:235], v[32:35], v[188:191], v[232:235]
  ds_read_b64_tr_b16 v[64:65], v242 offset:45056
  ds_read_b64_tr_b16 v[66:67], v242 offset:45568
  v_mfma_f32_16x16x32_bf16 v[236:239], v[36:39], v[188:191], v[236:239]
  ds_read_b64_tr_b16 v[68:69], v243 offset:45056
  ds_read_b64_tr_b16 v[70:71], v243 offset:45568
  s_waitcnt vmcnt(7) lgkmcnt(8)
  v_mfma_f32_16x16x32_bf16 v[224:227], v[40:43], v[192:195], v[224:227]
  v_add_u32 v240, 49152, v240
  v_add_u32 v241, 49152, v241
  v_add_u32 v242, 49152, v242
  v_mfma_f32_16x16x32_bf16 v[228:231], v[44:47], v[192:195], v[228:231]
  v_add_u32 v243, 49152, v243
  ds_read_b64_tr_b16 v[24:25], v240 offset:0
  ds_read_b64_tr_b16 v[26:27], v240 offset:512
  v_mfma_f32_16x16x32_bf16 v[232:235], v[48:51], v[192:195], v[232:235]
  ds_read_b64_tr_b16 v[28:29], v241 offset:0
  ds_read_b64_tr_b16 v[30:31], v241 offset:512
  ds_read_b64_tr_b16 v[32:33], v242 offset:0
  v_mfma_f32_16x16x32_bf16 v[236:239], v[52:55], v[192:195], v[236:239]
  ds_read_b64_tr_b16 v[34:35], v242 offset:512
  ds_read_b64_tr_b16 v[36:37], v243 offset:0
  ds_read_b64_tr_b16 v[38:39], v243 offset:512
  s_waitcnt vmcnt(6) lgkmcnt(8)
  v_mfma_f32_16x16x32_bf16 v[224:227], v[56:59], v[196:199], v[224:227]
  ds_read_b64_tr_b16 v[40:41], v240 offset:4096
  ds_read_b64_tr_b16 v[42:43], v240 offset:4608
  v_mfma_f32_16x16x32_bf16 v[228:231], v[60:63], v[196:199], v[228:231]
  ds_read_b64_tr_b16 v[44:45], v241 offset:4096
  ds_read_b64_tr_b16 v[46:47], v241 offset:4608
  v_mfma_f32_16x16x32_bf16 v[232:235], v[64:67], v[196:199], v[232:235]
  ds_read_b64_tr_b16 v[48:49], v242 offset:4096
  ds_read_b64_tr_b16 v[50:51], v242 offset:4608
  v_mfma_f32_16x16x32_bf16 v[236:239], v[68:71], v[196:199], v[236:239]
  ds_read_b64_tr_b16 v[52:53], v243 offset:4096
  ds_read_b64_tr_b16 v[54:55], v243 offset:4608
  s_waitcnt vmcnt(5) lgkmcnt(8)
  v_mfma_f32_16x16x32_bf16 v[224:227], v[24:27], v[200:203], v[224:227]
  ds_read_b64_tr_b16 v[56:57], v240 offset:8192
  ds_read_b64_tr_b16 v[58:59], v240 offset:8704
  v_mfma_f32_16x16x32_bf16 v[228:231], v[28:31], v[200:203], v[228:231]
  ds_read_b64_tr_b16 v[60:61], v241 offset:8192
  ds_read_b64_tr_b16 v[62:63], v241 offset:8704
  v_mfma_f32_16x16x32_bf16 v[232:235], v[32:35], v[200:203], v[232:235]
  ds_read_b64_tr_b16 v[64:65], v242 offset:8192
  ds_read_b64_tr_b16 v[66:67], v242 offset:8704
  v_mfma_f32_16x16x32_bf16 v[236:239], v[36:39], v[200:203], v[236:239]
  ds_read_b64_tr_b16 v[68:69], v243 offset:8192
  ds_read_b64_tr_b16 v[70:71], v243 offset:8704
  s_waitcnt vmcnt(4) lgkmcnt(8)
  v_mfma_f32_16x16x32_bf16 v[224:227], v[40:43], v[204:207], v[224:227]
  ds_read_b64_tr_b16 v[24:25], v240 offset:12288
  ds_read_b64_tr_b16 v[26:27], v240 offset:12800
  v_mfma_f32_16x16x32_bf16 v[228:231], v[44:47], v[204:207], v[228:231]
  ds_read_b64_tr_b16 v[28:29], v241 offset:12288
  ds_read_b64_tr_b16 v[30:31], v241 offset:12800
  v_mfma_f32_16x16x32_bf16 v[232:235], v[48:51], v[204:207], v[232:235]
  ds_read_b64_tr_b16 v[32:33], v242 offset:12288
  ds_read_b64_tr_b16 v[34:35], v242 offset:12800
  v_mfma_f32_16x16x32_bf16 v[236:239], v[52:55], v[204:207], v[236:239]
  ds_read_b64_tr_b16 v[36:37], v243 offset:12288
  ds_read_b64_tr_b16 v[38:39], v243 offset:12800
  s_waitcnt vmcnt(3) lgkmcnt(8)
  v_mfma_f32_16x16x32_bf16 v[224:227], v[56:59], v[208:211], v[224:227]
  ds_read_b64_tr_b16 v[40:41], v240 offset:16384
  ds_read_b64_tr_b16 v[42:43], v240 offset:16896
  v_mfma_f32_16x16x32_bf16 v[228:231], v[60:63], v[208:211], v[228:231]
  ds_read_b64_tr_b16 v[44:45], v241 offset:16384
  ds_read_b64_tr_b16 v[46:47], v241 offset:16896
  v_mfma_f32_16x16x32_bf16 v[232:235], v[64:67], v[208:211], v[232:235]
  ds_read_b64_tr_b16 v[48:49], v242 offset:16384
  ds_read_b64_tr_b16 v[50:51], v242 offset:16896
  v_mfma_f32_16x16x32_bf16 v[236:239], v[68:71], v[208:211], v[236:239]
  ds_read_b64_tr_b16 v[52:53], v243 offset:16384
  ds_read_b64_tr_b16 v[54:55], v243 offset:16896
  s_waitcnt vmcnt(2) lgkmcnt(8)
  v_mfma_f32_16x16x32_bf16 v[224:227], v[24:27], v[212:215], v[224:227]
  ds_read_b64_tr_b16 v[56:57], v240 offset:20480
  ds_read_b64_tr_b16 v[58:59], v240 offset:20992
  v_mfma_f32_16x16x32_bf16 v[228:231], v[28:31], v[212:215], v[228:231]
  ds_read_b64_tr_b16 v[60:61], v241 offset:20480
  ds_read_b64_tr_b16 v[62:63], v241 offset:20992
  v_mfma_f32_16x16x32_bf16 v[232:235], v[32:35], v[212:215], v[232:235]
  ds_read_b64_tr_b16 v[64:65], v242 offset:20480
  ds_read_b64_tr_b16 v[66:67], v242 offset:20992
  v_mfma_f32_16x16x32_bf16 v[236:239], v[36:39], v[212:215], v[236:239]
  ds_read_b64_tr_b16 v[68:69], v243 offset:20480
  ds_read_b64_tr_b16 v[70:71], v243 offset:20992
  s_waitcnt vmcnt(1) lgkmcnt(8)
  v_mfma_f32_16x16x32_bf16 v[224:227], v[40:43], v[216:219], v[224:227]
  v_mfma_f32_16x16x32_bf16 v[228:231], v[44:47], v[216:219], v[228:231]
  v_mfma_f32_16x16x32_bf16 v[232:235], v[48:51], v[216:219], v[232:235]
  v_mfma_f32_16x16x32_bf16 v[236:239], v[52:55], v[216:219], v[236:239]
  s_waitcnt vmcnt(0) lgkmcnt(0)
  v_mfma_f32_16x16x32_bf16 v[224:227], v[56:59], v[220:223], v[224:227]
  v_mfma_f32_16x16x32_bf16 v[228:231], v[60:63], v[220:223], v[228:231]
  v_mfma_f32_16x16x32_bf16 v[232:235], v[64:67], v[220:223], v[232:235]
  v_mfma_f32_16x16x32_bf16 v[236:239], v[68:71], v[220:223], v[236:239]
  s_nop 7
  v_cvt_pk_bf16_f32 v24, v224, v225
  v_cvt_pk_bf16_f32 v25, v226, v227
  v_cvt_pk_bf16_f32 v26, v228, v229
  v_cvt_pk_bf16_f32 v27, v230, v231
  v_cvt_pk_bf16_f32 v28, v232, v233
  v_cvt_pk_bf16_f32 v29, v234, v235
  v_cvt_pk_bf16_f32 v30, v236, v237
  v_cvt_pk_bf16_f32 v31, v238, v239
  s_lshl_b32 s16, s22, 11
  s_add_u32 s16, s16, 147456
  v_lshrrev_b32 v6, 1, v3
  v_and_b32 v7, 7, v2
  v_xor_b32 v6, v6, v7
  v_lshlrev_b32 v6, 4, v6
  v_lshl_add_u32 v6, v2, 7, v6
  v_and_b32 v7, 1, v3
  v_lshl_add_u32 v6, v7, 3, v6
  v_add_u32 v6, s16, v6
  ds_write_b64 v6, v[24:25]
  v_xor_b32 v7, 32, v6
  ds_write_b64 v7, v[26:27]
  v_xor_b32 v7, 64, v6
  ds_write_b64 v7, v[28:29]
  v_xor_b32 v7, 96, v6
  ds_write_b64 v7, v[30:31]
  v_lshrrev_b32 v8, 3, v1
  v_and_b32 v9, 7, v1
  v_xor_b32 v10, v9, v8
  v_lshlrev_b32 v10, 4, v10
  v_lshl_add_u32 v10, v8, 7, v10
  v_add_u32 v10, s16, v10
  s_lshl_b32 s17, s49, 4
  v_add_u32 v8, s17, v8
  v_mul_u32_u24 v8, 2304, v8
  v_lshl_add_u32 v8, v9, 4, v8
  s_add_u32 s17, s52, 18432
  s_waitcnt lgkmcnt(0)
  ds_read_b128 v[32:35], v10
  ds_read_b128 v[36:39], v10 offset:1024
  s_waitcnt lgkmcnt(1)
  buffer_store_dwordx4 v[32:35], v8, s[32:35], s52 offen
  s_waitcnt lgkmcnt(0)
  buffer_store_dwordx4 v[36:39], v8, s[32:35], s17 offen
k2_P2:
  s_cmp_ge_u32 s40, 220
  s_cbranch_scc1 k2_fin
  s_waitcnt vmcnt(0)
  v_lshl_add_u32 v6, v3, 3, v4
  v_lshlrev_b32 v6, 7, v6
  v_lshl_add_u32 v6, v5, 3, v6
  v_lshrrev_b32 v7, 1, v4
  v_and_b32 v8, 1, v3
  v_lshl_add_u32 v7, v8, 1, v7
  v_lshl_add_u32 v160, v7, 5, v6
  v_add_u32 v160, 73728, v160
  v_xor_b32 v161, 32, v160
  v_xor_b32 v162, 64, v160
  v_xor_b32 v163, 96, v160
  s_mul_i32 s62, s43, 18432
  s_add_u32 s62, s62, s46
  s_lshl_b32 s63, s44, 11
  s_barrier
  s_cmp_ge_u32 s22, 6
  s_cbranch_scc1 k2_fin
  s_add_u32 s64, s62, s63
  buffer_load_dwordx4 v[24:27], v14, s[24:27], s64 offen offset:0 sc1
  buffer_load_dwordx4 v[28:31], v14, s[24:27], s64 offen offset:1024 sc1
  s_add_u32 s63, s63, 2048
  s_cmp_eq_u32 s63, 18432
  s_cselect_b32 s63, 0, s63
  s_add_u32 s64, s62, s63
  buffer_load_dwordx4 v[32:35], v14, s[24:27], s64 offen offset:0 sc1
  buffer_load_dwordx4 v[36:39], v14, s[24:27], s64 offen offset:1024 sc1
  s_add_u32 s63, s63, 2048
  s_cmp_eq_u32 s63, 18432
  s_cselect_b32 s63, 0, s63
  s_add_u32 s64, s62, s63
  buffer_load_dwordx4 v[40:43], v14, s[24:27], s64 offen offset:0 sc1
  buffer_load_dwordx4 v[44:47], v14, s[24:27], s64 offen offset:1024 sc1
  s_add_u32 s63, s63, 2048
  s_cmp_eq_u32 s63, 18432
  s_cselect_b32 s63, 0, s63
  s_add_u32 s64, s62, s63
  buffer_load_dwordx4 v[48:51], v14, s[24:27], s64 offen offset:0 sc1
  buffer_load_dwordx4 v[52:55], v14, s[24:27], s64 offen offset:1024 sc1
  s_add_u32 s63, s63, 2048
  s_cmp_eq_u32 s63, 18432
  s_cselect_b32 s63, 0, s63
  s_add_u32 s64, s62, s63
  buffer_load_dwordx4 v[56:59], v14, s[24:27], s64 offen offset:0 sc1
  buffer_load_dwordx4 v[60:63], v14, s[24:27], s64 offen offset:1024 sc1
  s_add_u32 s63, s63, 2048
  s_cmp_eq_u32 s63, 18432
  s_cselect_b32 s63, 0, s63
  s_add_u32 s64, s62, s63
  buffer_load_dwordx4 v[64:67], v14, s[24:27], s64 offen offset:0 sc1
  buffer_load_dwordx4 v[68:71], v14, s[24:27], s64 offen offset:1024 sc1
  s_add_u32 s63, s63, 2048
  s_cmp_eq_u32 s63, 18432
  s_cselect_b32 s63, 0, s63
  s_add_u32 s64, s62, s63
  buffer_load_dwordx4 v[72:75], v14, s[24:27], s64 offen offset:0 sc1
  buffer_load_dwordx4 v[76:79], v14, s[24:27], s64 offen offset:1024 sc1
  s_add_u32 s63, s63, 2048
  s_cmp_eq_u32 s63, 18432
  s_cselect_b32 s63, 0, s63
  s_add_u32 s64, s62, s63
  buffer_load_dwordx4 v[80:83], v14, s[24:27], s64 offen offset:0 sc1
  buffer_load_dwordx4 v[84:87], v14, s[24:27], s64 offen offset:1024 sc1
  s_add_u32 s63, s63, 2048
  s_cmp_eq_u32 s63, 18432
  s_cselect_b32 s63, 0, s63
  s_add_u32 s64, s62, s63
  buffer_load_dwordx4 v[88:91], v14, s[24:27], s64 offen offset:0 sc1
  buffer_load_dwordx4 v[92:95], v14, s[24:27], s64 offen offset:1024 sc1
  s_add_u32 s63, s63, 2048
  s_cmp_eq_u32 s63, 18432
  s_cselect_b32 s63, 0, s63
  ds_read_b64_tr_b16 v[112:113], v160 offset:0
  ds_read_b64_tr_b16 v[114:115], v160 offset:512
  ds_read_b64_tr_b16 v[116:117], v161 offset:0
  ds_read_b64_tr_b16 v[118:119], v161 offset:512
  ds_read_b64_tr_b16 v[120:121], v162 offset:0
  ds_read_b64_tr_b16 v[122:123], v162 offset:512
  ds_read_b64_tr_b16 v[124:125], v163 offset:0
  ds_read_b64_tr_b16 v[126:127], v163 offset:512
  ds_read_b64_tr_b16 v[128:129], v160 offset:4096
  ds_read_b64_tr_b16 v[130:131], v160 offset:4608
  ds_read_b64_tr_b16 v[132:133], v161 offset:4096
  ds_read_b64_tr_b16 v[134:135], v161 offset:4608
  ds_read_b64_tr_b16 v[136:137], v162 offset:4096
  ds_read_b64_tr_b16 v[138:139], v162 offset:4608
  ds_read_b64_tr_b16 v[140:141], v163 offset:4096
  ds_read_b64_tr_b16 v[142:143], v163 offset:4608
  s_waitcnt vmcnt(17) lgkmcnt(8)
  v_mfma_f32_16x16x32_bf16 v[96:99], v[112:115], v[24:27], 0
  ds_read_b64_tr_b16 v[144:145], v160 offset:8192
  ds_read_b64_tr_b16 v[146:147], v160 offset:8704
  v_mfma_f32_16x16x32_bf16 v[100:103], v[116:119], v[24:27], 0
  ds_read_b64_tr_b16 v[148:149], v161 offset:8192
  ds_read_b64_tr_b16 v[150:151], v161 offset:8704
  v_mfma_f32_16x16x32_bf16 v[104:107], v[120:123], v[24:27], 0
  ds_read_b64_tr_b16 v[152:153], v162 offset:8192
  ds_read_b64_tr_b16 v[154:155], v162 offset:8704
  v_mfma_f32_16x16x32_bf16 v[108:111], v[124:127], v[24:27], 0
  ds_read_b64_tr_b16 v[156:157], v163 offset:8192
  ds_read_b64_tr_b16 v[158:159], v163 offset:8704
  s_waitcnt vmcnt(16) lgkmcnt(8)
  v_mfma_f32_16x16x32_bf16 v[96:99], v[128:131], v[28:31], v[96:99]
  ds_read_b64_tr_b16 v[112:113], v160 offset:12288
  ds_read_b64_tr_b16 v[114:115], v160 offset:12800
  v_mfma_f32_16x16x32_bf16 v[100:103], v[132:135], v[28:31], v[100:103]
  ds_read_b64_tr_b16 v[116:117], v161 offset:12288
  ds_read_b64_tr_b16 v[118:119], v161 offset:12800
  v_mfma_f32_16x16x32_bf16 v[104:107], v[136:139], v[28:31], v[104:107]
  ds_read_b64_tr_b16 v[120:121], v162 offset:12288
  ds_read_b64_tr_b16 v[122:123], v162 offset:12800
  v_mfma_f32_16x16x32_bf16 v[108:111], v[140:143], v[28:31], v[108:111]
  ds_read_b64_tr_b16 v[124:125], v163 offset:12288
  ds_read_b64_tr_b16 v[126:127], v163 offset:12800
  s_waitcnt vmcnt(15) lgkmcnt(8)
  v_mfma_f32_16x16x32_bf16 v[96:99], v[144:147], v[32:35], v[96:99]
  ds_read_b64_tr_b16 v[128:129], v160 offset:16384
  ds_read_b64_tr_b16 v[130:131], v160 offset:16896
  v_mfma_f32_16x16x32_bf16 v[100:103], v[148:151], v[32:35], v[100:103]
  ds_read_b64_tr_b16 v[132:133], v161 offset:16384
  ds_read_b64_tr_b16 v[134:135], v161 offset:16896
  v_mfma_f32_16x16x32_bf16 v[104:107], v[152:155], v[32:35], v[104:107]
  ds_read_b64_tr_b16 v[136:137], v162 offset:16384
  ds_read_b64_tr_b16 v[138:139], v162 offset:16896
  v_mfma_f32_16x16x32_bf16 v[108:111], v[156:159], v[32:35], v[108:111]
  ds_read_b64_tr_b16 v[140:141], v163 offset:16384
  ds_read_b64_tr_b16 v[142:143], v163 offset:16896
  s_waitcnt vmcnt(14) lgkmcnt(8)
  v_mfma_f32_16x16x32_bf16 v[96:99], v[112:115], v[36:39], v[96:99]
  ds_read_b64_tr_b16 v[144:145], v160 offset:20480
  ds_read_b64_tr_b16 v[146:147], v160 offset:20992
  v_mfma_f32_16x16x32_bf16 v[100:103], v[116:119], v[36:39], v[100:103]
  ds_read_b64_tr_b16 v[148:149], v161 offset:20480
  ds_read_b64_tr_b16 v[150:151], v161 offset:20992
  v_mfma_f32_16x16x32_bf16 v[104:107], v[120:123], v[36:39], v[104:107]
  ds_read_b64_tr_b16 v[152:153], v162 offset:20480
  ds_read_b64_tr_b16 v[154:155], v162 offset:20992
  v_mfma_f32_16x16x32_bf16 v[108:111], v[124:127], v[36:39], v[108:111]
  ds_read_b64_tr_b16 v[156:157], v163 offset:20480
  ds_read_b64_tr_b16 v[158:159], v163 offset:20992
  s_waitcnt vmcnt(13) lgkmcnt(8)
  v_mfma_f32_16x16x32_bf16 v[96:99], v[128:131], v[40:43], v[96:99]
  ds_read_b64_tr_b16 v[112:113], v160 offset:24576
  ds_read_b64_tr_b16 v[114:115], v160 offset:25088
  v_mfma_f32_16x16x32_bf16 v[100:103], v[132:135], v[40:43], v[100:103]
  ds_read_b64_tr_b16 v[116:117], v161 offset:24576
  ds_read_b64_tr_b16 v[118:119], v161 offset:25088
  v_mfma_f32_16x16x32_bf16 v[104:107], v[136:139], v[40:43], v[104:107]
  ds_read_b64_tr_b16 v[120:121], v162 offset:24576
  ds_read_b64_tr_b16 v[122:123], v162 offset:25088
  v_mfma_f32_16x16x32_bf16 v[108:111], v[140:143], v[40:43], v[108:111]
  ds_read_b64_tr_b16 v[124:125], v163 offset:24576
  ds_read_b64_tr_b16 v[126:127], v163 offset:25088
  s_waitcnt vmcnt(12) lgkmcnt(8)
  v_mfma_f32_16x16x32_bf16 v[96:99], v[144:147], v[44:47], v[96:99]
  ds_read_b64_tr_b16 v[128:129], v160 offset:28672
  ds_read_b64_tr_b16 v[130:131], v160 offset:29184
  v_mfma_f32_16x16x32_bf16 v[100:103], v[148:151], v[44:47], v[100:103]
  ds_read_b64_tr_b16 v[132:133], v161 offset:28672
  ds_read_b64_tr_b16 v[134:135], v161 offset:29184
  v_mfma_f32_16x16x32_bf16 v[104:107], v[152:155], v[44:47], v[104:107]
  ds_read_b64_tr_b16 v[136:137], v162 offset:28672
  ds_read_b64_tr_b16 v[138:139], v162 offset:29184
  v_mfma_f32_16x16x32_bf16 v[108:111], v[156:159], v[44:47], v[108:111]
  ds_read_b64_tr_b16 v[140:141], v163 offset:28672
  ds_read_b64_tr_b16 v[142:143], v163 offset:29184
  s_waitcnt vmcnt(11) lgkmcnt(8)
  v_mfma_f32_16x16x32_bf16 v[96:99], v[112:115], v[48:51], v[96:99]
  ds_read_b64_tr_b16 v[144:145], v160 offset:32768
  ds_read_b64_tr_b16 v[146:147], v160 offset:33280
  v_mfma_f32_16x16x32_bf16 v[100:103], v[116:119], v[48:51], v[100:103]
  ds_read_b64_tr_b16 v[148:149], v161 offset:32768
  ds_read_b64_tr_b16 v[150:151], v161 offset:33280
  v_mfma_f32_16x16x32_bf16 v[104:107], v[120:123], v[48:51], v[104:107]
  ds_read_b64_tr_b16 v[152:153], v162 offset:32768
  ds_read_b64_tr_b16 v[154:155], v162 offset:33280
  v_mfma_f32_16x16x32_bf16 v[108:111], v[124:127], v[48:51], v[108:111]
  ds_read_b64_tr_b16 v[156:157], v163 offset:32768
  ds_read_b64_tr_b16 v[158:159], v163 offset:33280
  s_waitcnt vmcnt(10) lgkmcnt(8)
  v_mfma_f32_16x16x32_bf16 v[96:99], v[128:131], v[52:55], v[96:99]
  ds_read_b64_tr_b16 v[112:113], v160 offset:36864
  ds_read_b64_tr_b16 v[114:115], v160 offset:37376
  v_mfma_f32_16x16x32_bf16 v[100:103], v[132:135], v[52:55], v[100:103]
  ds_read_b64_tr_b16 v[116:117], v161 offset:36864
  ds_read_b64_tr_b16 v[118:119], v161 offset:37376
  v_mfma_f32_16x16x32_bf16 v[104:107], v[136:139], v[52:55], v[104:107]
  ds_read_b64_tr_b16 v[120:121], v162 offset:36864
  ds_read_b64_tr_b16 v[122:123], v162 offset:37376
  v_mfma_f32_16x16x32_bf16 v[108:111], v[140:143], v[52:55], v[108:111]
  ds_read_b64_tr_b16 v[124:125], v163 offset:36864
  ds_read_b64_tr_b16 v[126:127], v163 offset:37376
  s_waitcnt vmcnt(9) lgkmcnt(8)
  v_mfma_f32_16x16x32_bf16 v[96:99], v[144:147], v[56:59], v[96:99]
  ds_read_b64_tr_b16 v[128:129], v160 offset:40960
  ds_read_b64_tr_b16 v[130:131], v160 offset:41472
  v_mfma_f32_16x16x32_bf16 v[100:103], v[148:151], v[56:59], v[100:103]
  ds_read_b64_tr_b16 v[132:133], v161 offset:40960
  ds_read_b64_tr_b16 v[134:135], v161 offset:41472
  v_mfma_f32_16x16x32_bf16 v[104:107], v[152:155], v[56:59], v[104:107]
  ds_read_b64_tr_b16 v[136:137], v162 offset:40960
  ds_read_b64_tr_b16 v[138:139], v162 offset:41472
  v_mfma_f32_16x16x32_bf16 v[108:111], v[156:159], v[56:59], v[108:111]
  ds_read_b64_tr_b16 v[140:141], v163 offset:40960
  ds_read_b64_tr_b16 v[142:143], v163 offset:41472
  s_waitcnt vmcnt(8) lgkmcnt(8)
  v_mfma_f32_16x16x32_bf16 v[96:99], v[112:115], v[60:63], v[96:99]
  ds_read_b64_tr_b16 v[144:145], v160 offset:45056
  ds_read_b64_tr_b16 v[146:147], v160 offset:45568
  v_mfma_f32_16x16x32_bf16 v[100:103], v[116:119], v[60:63], v[100:103]
  ds_read_b64_tr_b16 v[148:149], v161 offset:45056
  ds_read_b64_tr_b16 v[150:151], v161 offset:45568
  v_mfma_f32_16x16x32_bf16 v[104:107], v[120:123], v[60:63], v[104:107]
  ds_read_b64_tr_b16 v[152:153], v162 offset:45056
  ds_read_b64_tr_b16 v[154:155], v162 offset:45568
  v_mfma_f32_16x16x32_bf16 v[108:111], v[124:127], v[60:63], v[108:111]
  ds_read_b64_tr_b16 v[156:157], v163 offset:45056
  ds_read_b64_tr_b16 v[158:159], v163 offset:45568
  s_waitcnt vmcnt(7) lgkmcnt(8)
  v_mfma_f32_16x16x32_bf16 v[96:99], v[128:131], v[64:67], v[96:99]
  v_add_u32 v160, 49152, v160
  v_add_u32 v161, 49152, v161
  v_add_u32 v162, 49152, v162
  v_mfma_f32_16x16x32_bf16 v[100:103], v[132:135], v[64:67], v[100:103]
  v_add_u32 v163, 49152, v163
  ds_read_b64_tr_b16 v[112:113], v160 offset:0
  ds_read_b64_tr_b16 v[114:115], v160 offset:512
  v_mfma_f32_16x16x32_bf16 v[104:107], v[136:139], v[64:67], v[104:107]
  ds_read_b64_tr_b16 v[116:117], v161 offset:0
  ds_read_b64_tr_b16 v[118:119], v161 offset:512
  ds_read_b64_tr_b16 v[120:121], v162 offset:0
  v_mfma_f32_16x16x32_bf16 v[108:111], v[140:143], v[64:67], v[108:111]
  ds_read_b64_tr_b16 v[122:123], v162 offset:512
  ds_read_b64_tr_b16 v[124:125], v163 offset:0
  ds_read_b64_tr_b16 v[126:127], v163 offset:512
  s_waitcnt vmcnt(6) lgkmcnt(8)
  v_mfma_f32_16x16x32_bf16 v[96:99], v[144:147], v[68:71], v[96:99]
  ds_read_b64_tr_b16 v[128:129], v160 offset:4096
  ds_read_b64_tr_b16 v[130:131], v160 offset:4608
  v_mfma_f32_16x16x32_bf16 v[100:103], v[148:151], v[68:71], v[100:103]
  ds_read_b64_tr_b16 v[132:133], v161 offset:4096
  ds_read_b64_tr_b16 v[134:135], v161 offset:4608
  v_mfma_f32_16x16x32_bf16 v[104:107], v[152:155], v[68:71], v[104:107]
  ds_read_b64_tr_b16 v[136:137], v162 offset:4096
  ds_read_b64_tr_b16 v[138:139], v162 offset:4608
  v_mfma_f32_16x16x32_bf16 v[108:111], v[156:159], v[68:71], v[108:111]
  ds_read_b64_tr_b16 v[140:141], v163 offset:4096
  ds_read_b64_tr_b16 v[142:143], v163 offset:4608
  s_waitcnt vmcnt(5) lgkmcnt(8)
  v_mfma_f32_16x16x32_bf16 v[96:99], v[112:115], v[72:75], v[96:99]
  ds_read_b64_tr_b16 v[144:145], v160 offset:8192
  ds_read_b64_tr_b16 v[146:147], v160 offset:8704
  v_mfma_f32_16x16x32_bf16 v[100:103], v[116:119], v[72:75], v[100:103]
  ds_read_b64_tr_b16 v[148:149], v161 offset:8192
  ds_read_b64_tr_b16 v[150:151], v161 offset:8704
  v_mfma_f32_16x16x32_bf16 v[104:107], v[120:123], v[72:75], v[104:107]
  ds_read_b64_tr_b16 v[152:153], v162 offset:8192
  ds_read_b64_tr_b16 v[154:155], v162 offset:8704
  v_mfma_f32_16x16x32_bf16 v[108:111], v[124:127], v[72:75], v[108:111]
  ds_read_b64_tr_b16 v[156:157], v163 offset:8192
  ds_read_b64_tr_b16 v[158:159], v163 offset:8704
  s_waitcnt vmcnt(4) lgkmcnt(8)
  v_mfma_f32_16x16x32_bf16 v[96:99], v[128:131], v[76:79], v[96:99]
  ds_read_b64_tr_b16 v[112:113], v160 offset:12288
  ds_read_b64_tr_b16 v[114:115], v160 offset:12800
  v_mfma_f32_16x16x32_bf16 v[100:103], v[132:135], v[76:79], v[100:103]
  ds_read_b64_tr_b16 v[116:117], v161 offset:12288
  ds_read_b64_tr_b16 v[118:119], v161 offset:12800
  v_mfma_f32_16x16x32_bf16 v[104:107], v[136:139], v[76:79], v[104:107]
  ds_read_b64_tr_b16 v[120:121], v162 offset:12288
  ds_read_b64_tr_b16 v[122:123], v162 offset:12800
  v_mfma_f32_16x16x32_bf16 v[108:111], v[140:143], v[76:79], v[108:111]
  ds_read_b64_tr_b16 v[124:125], v163 offset:12288
  ds_read_b64_tr_b16 v[126:127], v163 offset:12800
  s_waitcnt vmcnt(3) lgkmcnt(8)
  v_mfma_f32_16x16x32_bf16 v[96:99], v[144:147], v[80:83], v[96:99]
  ds_read_b64_tr_b16 v[128:129], v160 offset:16384
  ds_read_b64_tr_b16 v[130:131], v160 offset:16896
  v_mfma_f32_16x16x32_bf16 v[100:103], v[148:151], v[80:83], v[100:103]
  ds_read_b64_tr_b16 v[132:133], v161 offset:16384
  ds_read_b64_tr_b16 v[134:135], v161 offset:16896
  v_mfma_f32_16x16x32_bf16 v[104:107], v[152:155], v[80:83], v[104:107]
  ds_read_b64_tr_b16 v[136:137], v162 offset:16384
  ds_read_b64_tr_b16 v[138:139], v162 offset:16896
  v_mfma_f32_16x16x32_bf16 v[108:111], v[156:159], v[80:83], v[108:111]
  ds_read_b64_tr_b16 v[140:141], v163 offset:16384
  ds_read_b64_tr_b16 v[142:143], v163 offset:16896
  s_waitcnt vmcnt(2) lgkmcnt(8)
  v_mfma_f32_16x16x32_bf16 v[96:99], v[112:115], v[84:87], v[96:99]
  ds_read_b64_tr_b16 v[144:145], v160 offset:20480
  ds_read_b64_tr_b16 v[146:147], v160 offset:20992
  v_mfma_f32_16x16x32_bf16 v[100:103], v[116:119], v[84:87], v[100:103]
  ds_read_b64_tr_b16 v[148:149], v161 offset:20480
  ds_read_b64_tr_b16 v[150:151], v161 offset:20992
  v_mfma_f32_16x16x32_bf16 v[104:107], v[120:123], v[84:87], v[104:107]
  ds_read_b64_tr_b16 v[152:153], v162 offset:20480
  ds_read_b64_tr_b16 v[154:155], v162 offset:20992
  v_mfma_f32_16x16x32_bf16 v[108:111], v[124:127], v[84:87], v[108:111]
  ds_read_b64_tr_b16 v[156:157], v163 offset:20480
  ds_read_b64_tr_b16 v[158:159], v163 offset:20992
  s_waitcnt vmcnt(1) lgkmcnt(8)
  v_mfma_f32_16x16x32_bf16 v[96:99], v[128:131], v[88:91], v[96:99]
  v_mfma_f32_16x16x32_bf16 v[100:103], v[132:135], v[88:91], v[100:103]
  v_mfma_f32_16x16x32_bf16 v[104:107], v[136:139], v[88:91], v[104:107]
  v_mfma_f32_16x16x32_bf16 v[108:111], v[140:143], v[88:91], v[108:111]
  s_waitcnt vmcnt(0) lgkmcnt(0)
  v_mfma_f32_16x16x32_bf16 v[96:99], v[144:147], v[92:95], v[96:99]
  v_mfma_f32_16x16x32_bf16 v[100:103], v[148:151], v[92:95], v[100:103]
  v_mfma_f32_16x16x32_bf16 v[104:107], v[152:155], v[92:95], v[104:107]
  v_mfma_f32_16x16x32_bf16 v[108:111], v[156:159], v[92:95], v[108:111]
  s_nop 7
  v_cvt_pk_bf16_f32 v112, v96, v97
  v_cvt_pk_bf16_f32 v113, v98, v99
  v_cvt_pk_bf16_f32 v114, v100, v101
  v_cvt_pk_bf16_f32 v115, v102, v103
  v_cvt_pk_bf16_f32 v116, v104, v105
  v_cvt_pk_bf16_f32 v117, v106, v107
  v_cvt_pk_bf16_f32 v118, v108, v109
  v_cvt_pk_bf16_f32 v119, v110, v111
  s_lshl_b32 s16, s22, 11
  s_add_u32 s16, s16, 147456
  v_lshrrev_b32 v6, 1, v3
  v_and_b32 v7, 7, v2
  v_xor_b32 v6, v6, v7
  v_lshlrev_b32 v6, 4, v6
  v_lshl_add_u32 v6, v2, 7, v6
  v_and_b32 v7, 1, v3
  v_lshl_add_u32 v6, v7, 3, v6
  v_add_u32 v6, s16, v6
  ds_write_b64 v6, v[112:113]
  v_xor_b32 v7, 32, v6
  ds_write_b64 v7, v[114:115]
  v_xor_b32 v7, 64, v6
  ds_write_b64 v7, v[116:117]
  v_xor_b32 v7, 96, v6
  ds_write_b64 v7, v[118:119]
  v_lshrrev_b32 v8, 3, v1
  v_and_b32 v9, 7, v1
  v_xor_b32 v10, v9, v8
  v_lshlrev_b32 v10, 4, v10
  v_lshl_add_u32 v10, v8, 7, v10
  v_add_u32 v10, s16, v10
  s_lshl_b32 s17, s43, 4
  v_add_u32 v8, s17, v8
  v_mul_u32_u24 v8, 2304, v8
  v_lshl_add_u32 v8, v9, 4, v8
  s_add_u32 s17, s47, 18432
  s_waitcnt lgkmcnt(0)
  ds_read_b128 v[120:123], v10
  ds_read_b128 v[124:127], v10 offset:1024
  s_waitcnt lgkmcnt(1)
  buffer_store_dwordx4 v[120:123], v8, s[32:35], s47 offen
  s_waitcnt lgkmcnt(0)
  buffer_store_dwordx4 v[124:127], v8, s[32:35], s17 offen
k2_fin:
k2_end:
  s_endpgm
code_end:
  s_endpgm
.section .rodata,"a"
.p2align 6
.amdhsa_kernel k1_kernel
  .amdhsa_next_free_vgpr 253
  .amdhsa_next_free_sgpr 80
  .amdhsa_accum_offset 256
  .amdhsa_group_segment_fixed_size 0
  .amdhsa_kernarg_size 80
  .amdhsa_user_sgpr_count 2
  .amdhsa_user_sgpr_kernarg_segment_ptr 1
  .amdhsa_system_sgpr_workgroup_id_x 1
.end_amdhsa_kernel
.p2align 6
.amdhsa_kernel k2_kernel
  .amdhsa_next_free_vgpr 244
  .amdhsa_next_free_sgpr 65
  .amdhsa_accum_offset 244
  .amdhsa_group_segment_fixed_size 0
  .amdhsa_kernarg_size 80
  .amdhsa_user_sgpr_count 2
  .amdhsa_user_sgpr_kernarg_segment_ptr 1
  .amdhsa_system_sgpr_workgroup_id_x 1
.end_amdhsa_kernel
```
